```python
import torch

def _softmax(x, axis=-1):
    return torch.softmax(x, dim=axis)
def _gelu(x):
    return torch.nn.functional.gelu(x, approximate="tanh")
def _silu(x):
    return torch.nn.functional.silu(x)
def _sigmoid(x):
    return torch.sigmoid(x)
def _layernorm(x, axis=-1, eps=1e-5):
    m = x.mean(dim=axis, keepdim=True)
    v = x.var(dim=axis, keepdim=True, unbiased=False)
    return (x - m) / torch.sqrt(v + eps)
def _scatter_add(tgt, idx, src, axis=0):
    return tgt.clone().index_add_(axis, idx, src)
def _segment_sum(src, seg, n):
    out = torch.zeros((n,) + src.shape[1:], dtype=src.dtype)
    return out.index_add_(0, seg, src)
def _pad(x, pw):
    flat = tuple(v for pair in reversed(pw) for v in pair)
    return torch.nn.functional.pad(x, flat)

kernel_name = 'standalone__detection_seg_mask2former__vision'

def setup_inputs():

    _w = (lambda a: (lambda t: t.to(torch.bfloat16) if t.is_floating_point() else t)(torch.as_tensor(a)))
    H = W = 512
    C = 192
    Hc, Wc = H // 2, W // 2
    nh = 4
    Nq = 16
    sc = C ** -0.5
    return {
        "q": _w((lambda *s: torch.randn(*s, dtype=torch.bfloat16) * 0.4)(1, Nq, C)),
        "f_hi": _w((lambda *s: torch.randn(*s, dtype=torch.bfloat16) * 0.4)(1, H, W, C)),
        "f_lo": _w((lambda *s: torch.randn(*s, dtype=torch.bfloat16) * 0.4)(1, Hc, Wc, C)),
        "w_lat": _w((lambda *s: torch.randn(*s, dtype=torch.bfloat16) * 0.4)(C, C) * sc),
        "w_q": _w((lambda *s: torch.randn(*s, dtype=torch.bfloat16) * 3.2)(nh, C, C // nh) * sc),
        "w_k": _w((lambda *s: torch.randn(*s, dtype=torch.bfloat16) * 3.2)(nh, C, C // nh) * sc),
        "w_v": _w((lambda *s: torch.randn(*s, dtype=torch.bfloat16) * 3.2)(nh, C, C // nh) * sc),
        "w_o": _w((lambda *s: torch.randn(*s, dtype=torch.bfloat16) * 3.2)(C, C) * sc),
        "w_m": _w((lambda *s: torch.randn(*s, dtype=torch.bfloat16) * 3.2)(C, C) * sc),
    }

def reference(q, f_hi, f_lo, w_lat, w_q, w_k, w_v, w_o, w_m):
    B, Nq, C = q.shape
    _, H, W, _ = f_hi.shape
    nh = w_q.shape[0]
    dh = C // nh
    up = (lambda x, n, axis: torch.repeat_interleave(x, n, dim=axis))((lambda x, n, axis: torch.repeat_interleave(x, n, dim=axis))(f_lo, 2, axis=1), 2, axis=2)
    feat = f_hi + up @ w_lat
    feat = _layernorm(feat, axis=-1)
    kv = feat.reshape(B, H * W, C)
    m_embed = q @ w_m
    mask_bias = torch.einsum('bqc,bkc->bqk', m_embed, kv) * (C ** -0.5)
    Q = torch.einsum('bqc,hcd->bhqd', q, w_q)
    K = torch.einsum('bkc,hcd->bhkd', kv, w_k)
    V = torch.einsum('bkc,hcd->bhkd', kv, w_v)
    logits = torch.einsum('bhqd,bhkd->bhqk', Q, K) * (dh ** -0.5)
    logits = logits + mask_bias[:, None, :, :]
    attn = _softmax(logits, axis=-1)
    ctx = torch.einsum('bhqk,bhkd->bqhd', attn, V).reshape(B, Nq, C)
    return q + ctx @ w_o
```

```asm
; @launch kernel=standalone__detection_seg_mask2former__vision_kernel grid=(256,1,1) block=(256,1,1) lds=163840
; @launch kernel=m2f_combine_kernel grid=(192,1,1) block=(256,1,1) lds=11264
.amdgcn_target "amdgcn-amd-amdhsa--gfx950"
.text
.globl standalone__detection_seg_mask2former__vision_kernel
.p2align 8
.type standalone__detection_seg_mask2former__vision_kernel,@function
standalone__detection_seg_mask2former__vision_kernel:
  s_cmp_ge_u32 s2, 256
  s_cbranch_scc1 L_end
  s_load_dwordx16 s[64:79], s[0:1], 0
  s_load_dwordx8 s[80:87], s[0:1], 64
  s_getpc_b64 s[6:7]
L_pc:
  s_lshr_b32 s47, s2, 3
  s_lshl_b32 s47, s47, 11
  v_lshlrev_b32 v234, 3, v0
  v_add_u32 v234, s47, v234
  v_min_u32 v234, L_codeend-L_pc-4, v234
  v_mov_b32 v235, s7
  v_add_co_u32 v234, vcc, s6, v234
  s_nop 1
  v_addc_co_u32 v235, vcc, 0, v235, vcc
  s_mov_b32 exec_lo, 0x10001
  s_mov_b32 exec_hi, 0x10001
  global_load_dword v239, v[234:235], off
  s_mov_b64 exec, -1
  v_and_b32 v234, 0xffffff80, v234
  v_accvgpr_write_b32 a173, v234
  v_accvgpr_write_b32 a174, v235
  v_lshrrev_b32 v236, 6, v0
  v_and_b32 v228, 63, v0
  v_readfirstlane_b32 s36, v236
  v_and_b32 v229, 15, v228
  v_lshrrev_b32 v230, 4, v228
  v_lshlrev_b32 v255, 4, v228
  v_lshlrev_b32 v106, 6, v228
  v_lshrrev_b32 v231, 2, v229
  v_and_b32 v232, 3, v228
  s_mul_i32 s37, s36, 40960
  v_and_b32 v234, 1, v230
  v_lshlrev_b32 v234, 2, v234
  v_and_b32 v237, 7, v228
  v_xor_b32 v194, v234, v237
  v_lshlrev_b32 v194, 4, v194
  v_and_b32 v235, 2, v230
  v_or_b32 v234, v234, v235
  v_lshrrev_b32 v236, 3, v228
  v_and_b32 v235, 1, v236
  v_xor_b32 v234, v234, v235
  v_xor_b32 v234, v234, v237
  v_lshlrev_b32 v234, 4, v234
  v_xor_b32 v235, 48, v234
  v_mul_u32_u24 v237, 384, v236
  v_add_u32 v192, v237, v234
  v_add_u32 v193, v237, v235
  v_add_u32 v193, 3072, v193
  v_add_u32 v194, v194, v237
  v_add_u32 v251, v192, v237
  v_add_u32 v252, v193, v237
  v_add_u32 v252, 3072, v252
  s_lshr_b32 s46, s2, 3
  s_and_b32 s46, s46, 0
  s_mul_i32 s91, s2, 98304
  s_mul_i32 s92, s36, 24576
  s_add_u32 s91, s91, s92
  s_add_u32 s92, s46, 0
  s_and_b32 s92, s92, 3
  s_mul_i32 s92, s92, 6144
  s_add_u32 s38, s91, s92
  s_add_u32 s92, s46, 1
  s_and_b32 s92, s92, 3
  s_mul_i32 s92, s92, 6144
  s_add_u32 s39, s91, s92
  s_add_u32 s92, s46, 2
  s_and_b32 s92, s92, 3
  s_mul_i32 s92, s92, 6144
  s_add_u32 s3, s91, s92
  s_add_u32 s92, s46, 3
  s_and_b32 s92, s92, 3
  s_mul_i32 s92, s92, 6144
  s_add_u32 s45, s91, s92
  s_lshr_b32 s92, s2, 3
  s_mul_i32 s92, s92, 576
  s_and_b32 s91, s2, 3
  s_mul_i32 s91, s91, 18432
  s_add_u32 s91, s91, s92
  s_lshl_b32 s92, s92, 2
  s_cmp_lt_u32 s36, 2
  s_cselect_b32 s92, s92, s91
  s_cselect_b32 s48, -1, 0x1ff
  s_cselect_b32 s49, 15, 0
  s_mov_b32 s26, 73728
  s_mov_b32 s15, 0x20000
  s_mov_b32 s19, 0x20000
  s_mov_b32 s35, 0x20000
  s_mov_b32 s11, 0x20000
  s_mov_b32 s31, 0x20000
  s_mov_b32 s23, 0x20000
  s_mov_b32 s27, 0x20000
  s_mov_b32 s14, 25165824
  s_mov_b32 s18, 73728
  s_mov_b32 s34, 73728
  s_mov_b32 s10, 100663296
  s_mov_b32 s30, 3194880
  s_mov_b32 s22, 256
  s_waitcnt lgkmcnt(0)
  s_cselect_b64 s[24:25], s[70:71], s[72:73]
  s_cselect_b64 s[6:7], s[80:81], s[74:75]
  s_bitcmp1_b32 s36, 0
  s_cselect_b64 s[24:25], s[6:7], s[24:25]
  s_and_b32 s25, s25, 0xffff
  s_mov_b64 exec, s[48:49]
  buffer_load_dword v239, v106, s[24:27], s92 offen
  s_mov_b64 exec, -1
  s_mov_b32 s12, s68
  s_and_b32 s13, s69, 0xffff
  s_mov_b32 s16, s70
  s_and_b32 s17, s71, 0xffff
  s_and_b32 s47, s2, 6
  s_lshl_b32 s47, s47, 8
  s_or_b32 s47, s47, s2
  s_cmp_lt_u32 s47, 96
  s_cbranch_scc1 L_prod
  s_add_u32 m0, s37, 24576
  s_nop 0
  buffer_load_dwordx4 v192, s[12:15], s38 offen nt lds
  s_add_u32 m0, s37, 25600
  s_nop 0
  buffer_load_dwordx4 v193, s[12:15], s38 offen nt lds
  s_add_u32 m0, s37, 26496
  s_nop 0
  buffer_load_dwordx4 v192, s[12:15], s38 offen offset:128 nt lds
  s_add_u32 m0, s37, 27520
  s_nop 0
  buffer_load_dwordx4 v193, s[12:15], s38 offen offset:128 nt lds
  s_add_u32 m0, s37, 28416
  s_nop 0
  buffer_load_dwordx4 v192, s[12:15], s38 offen offset:256 nt lds
  s_add_u32 m0, s37, 29440
  s_nop 0
  buffer_load_dwordx4 v193, s[12:15], s38 offen offset:256 nt lds
  s_add_u32 m0, s37, 30720
  s_nop 0
  buffer_load_dwordx4 v192, s[12:15], s39 offen nt lds
  s_add_u32 m0, s37, 31744
  s_nop 0
  buffer_load_dwordx4 v193, s[12:15], s39 offen nt lds
  s_add_u32 m0, s37, 32640
  s_nop 0
  buffer_load_dwordx4 v192, s[12:15], s39 offen offset:128 nt lds
  s_add_u32 m0, s37, 33664
  s_nop 0
  buffer_load_dwordx4 v193, s[12:15], s39 offen offset:128 nt lds
  s_add_u32 m0, s37, 34560
  s_nop 0
  buffer_load_dwordx4 v192, s[12:15], s39 offen offset:256 nt lds
  s_add_u32 m0, s37, 35584
  s_nop 0
  buffer_load_dwordx4 v193, s[12:15], s39 offen offset:256 nt lds
  s_mov_b32 s8, s66
  s_and_b32 s9, s67, 0xffff
  s_mov_b32 s28, s86
  s_and_b32 s29, s87, 0xffff
  s_mov_b32 s20, s84
  s_and_b32 s21, s85, 0xffff
  s_mov_b32 s32, s76
  s_and_b32 s33, s77, 0xffff
  v_and_b32 v234, 2, v229
  v_lshlrev_b32 v234, 1, v234
  v_lshrrev_b32 v235, 3, v229
  v_or_b32 v234, v234, v235
  v_xor_b32 v235, v231, v235
  v_and_b32 v235, 1, v235
  v_lshlrev_b32 v235, 1, v235
  v_or_b32 v237, v234, v235
  v_and_b32 v234, 1, v229
  v_xor_b32 v237, v237, v234
  v_xor_b32 v234, v230, v237
  v_lshlrev_b32 v234, 4, v234
  v_lshlrev_b32 v235, 7, v229
  v_add_u32 v235, s37, v235
  v_add_u32 v245, v234, v235
  v_xor_b32 v246, 64, v245
  v_lshrrev_b32 v234, 1, v230
  v_xor_b32 v237, v234, v237
  v_lshl_add_u32 v237, v237, 4, v235
  v_and_b32 v236, 1, v230
  v_mul_u32_u24 v236, 6144, v236
  v_add_u32 v199, v237, v236
  v_add_u32 v203, v199, v236
  v_xor_b32 v200, 32, v199
  v_xor_b32 v204, 32, v203
  v_xor_b32 v201, 64, v199
  v_xor_b32 v205, 64, v203
  v_xor_b32 v202, 96, v199
  v_xor_b32 v206, 96, v203
  v_mul_u32_u24 v235, 3, v234
  v_and_b32 v236, 2, v231
  v_lshlrev_b32 v236, 1, v236
  v_or_b32 v235, v235, v236
  v_and_b32 v236, 1, v231
  v_xor_b32 v235, v235, v236
  v_and_b32 v236, 1, v230
  v_lshlrev_b32 v236, 1, v236
  v_lshrrev_b32 v237, 1, v232
  v_or_b32 v236, v236, v237
  v_xor_b32 v235, v235, v236
  v_lshlrev_b32 v235, 4, v235
  v_lshlrev_b32 v236, 3, v234
  v_add_u32 v236, v236, v231
  v_lshlrev_b32 v236, 7, v236
  v_add_u32 v236, v236, v235
  v_and_b32 v235, 1, v232
  v_lshl_add_u32 v236, v235, 3, v236
  v_add_u32 v247, s37, v236
  v_xor_b32 v248, 64, v247
  v_xor_b32 v249, 32, v247
  v_xor_b32 v250, 96, v247
  v_mul_u32_u24 v234, 3072, v234
  v_lshl_add_u32 v234, v231, 7, v234
  v_lshl_add_u32 v234, v235, 5, v234
  v_lshl_add_u32 v234, v237, 3, v234
  v_lshrrev_b32 v235, 1, v231
  v_lshl_add_u32 v234, v235, 6, v234
  v_and_b32 v235, 1, v230
  v_lshl_add_u32 v195, v235, 4, v234
  v_xor_b32 v196, 64, v195
  v_add_u32 v197, 81920, v195
  v_add_u32 v198, 81920, v196
  v_mov_b32 v102, 0
  v_add_u32 v103, s37, v255
  v_mov_b32 v236, 0x3f803f80
  v_mov_b32 v237, 1.0
  v_accvgpr_write_b32 a168, v236
  v_accvgpr_write_b32 a169, v236
  v_accvgpr_write_b32 a170, v236
  v_accvgpr_write_b32 a171, v236
  v_accvgpr_write_b32 a172, v237
  s_mov_b32 s48, 0xaaaaaaaa
  s_mov_b32 s49, 0xaaaaaaaa
  s_mov_b32 s50, 0xcccccccc
  s_mov_b32 s51, 0xcccccccc
  s_mov_b32 s52, 0x00f0000f
  s_mov_b32 s53, 0xf0000f00
  s_mov_b32 s54, 0xffff0000
  s_mov_b32 s55, 0xffff0000
  s_mov_b32 s88, 0x4e800000
  s_mov_b32 s89, 0xbbaaaaab
  s_mov_b32 s90, 0x3afba882
  s_mov_b32 s93, 0
  s_lshr_b32 s46, s2, 3
  s_and_b32 s46, s46, 0
  s_lshr_b32 s91, s46, 2
  s_add_u32 s92, s2, 1
  s_sub_u32 s92, s92, s91
  s_add_u32 s91, s2, s91
  s_mul_i32 s91, s91, 196608
  s_mul_i32 s92, s92, 196608
  s_lshl1_add_u32 s64, s38, s91
  s_lshl1_add_u32 s65, s38, s92
  s_lshl1_add_u32 s66, s39, s91
  s_lshl1_add_u32 s67, s39, s92
  s_lshl1_add_u32 s68, s3, s91
  s_lshl1_add_u32 s69, s3, s92
  s_lshl1_add_u32 s70, s45, s91
  s_lshl1_add_u32 s71, s45, s92
  s_mul_i32 s47, s36, 18432
  s_add_u32 m0, s37, 0
  s_nop 0
  buffer_load_dwordx4 v194, s[16:19], s47 offen lds
  s_add_u32 m0, s37, 896
  s_nop 0
  buffer_load_dwordx4 v194, s[16:19], s47 offen offset:128 lds
  s_add_u32 m0, s37, 1792
  s_nop 0
  buffer_load_dwordx4 v194, s[16:19], s47 offen offset:256 lds
  s_add_u32 s47, s47, 3072
  s_add_u32 m0, s37, 3072
  s_nop 0
  buffer_load_dwordx4 v194, s[16:19], s47 offen lds
  s_add_u32 m0, s37, 3968
  s_nop 0
  buffer_load_dwordx4 v194, s[16:19], s47 offen offset:128 lds
  s_add_u32 m0, s37, 4864
  s_nop 0
  buffer_load_dwordx4 v194, s[16:19], s47 offen offset:256 lds
  s_add_u32 s47, s47, 3072
  s_add_u32 m0, s37, 6144
  s_nop 0
  buffer_load_dwordx4 v194, s[16:19], s47 offen lds
  s_add_u32 m0, s37, 7040
  s_nop 0
  buffer_load_dwordx4 v194, s[16:19], s47 offen offset:128 lds
  s_add_u32 m0, s37, 7936
  s_nop 0
  buffer_load_dwordx4 v194, s[16:19], s47 offen offset:256 lds
  s_add_u32 s47, s47, 3072
  s_add_u32 m0, s37, 9216
  s_nop 0
  buffer_load_dwordx4 v194, s[16:19], s47 offen lds
  s_add_u32 m0, s37, 10112
  s_nop 0
  buffer_load_dwordx4 v194, s[16:19], s47 offen offset:128 lds
  s_add_u32 m0, s37, 11008
  s_nop 0
  buffer_load_dwordx4 v194, s[16:19], s47 offen offset:256 lds
  s_add_u32 s47, s47, 3072
  s_add_u32 m0, s37, 12288
  s_nop 0
  buffer_load_dwordx4 v194, s[16:19], s47 offen lds
  s_add_u32 m0, s37, 13184
  s_nop 0
  buffer_load_dwordx4 v194, s[16:19], s47 offen offset:128 lds
  s_add_u32 m0, s37, 14080
  s_nop 0
  buffer_load_dwordx4 v194, s[16:19], s47 offen offset:256 lds
  s_add_u32 s47, s47, 3072
  s_add_u32 m0, s37, 15360
  s_nop 0
  buffer_load_dwordx4 v194, s[16:19], s47 offen lds
  s_add_u32 m0, s37, 16256
  s_nop 0
  buffer_load_dwordx4 v194, s[16:19], s47 offen offset:128 lds
  s_add_u32 m0, s37, 17152
  s_nop 0
  buffer_load_dwordx4 v194, s[16:19], s47 offen offset:256 lds
  s_barrier
  s_add_u32 m0, s37, 18432
  s_nop 0
  buffer_load_dwordx4 v192, s[12:15], s3 offen nt lds
  s_add_u32 m0, s37, 19456
  s_nop 0
  buffer_load_dwordx4 v193, s[12:15], s3 offen nt lds
  s_add_u32 m0, s37, 20352
  s_nop 0
  buffer_load_dwordx4 v192, s[12:15], s3 offen offset:128 nt lds
  s_add_u32 m0, s37, 21376
  s_nop 0
  buffer_load_dwordx4 v193, s[12:15], s3 offen offset:128 nt lds
  s_add_u32 m0, s37, 22272
  s_nop 0
  buffer_load_dwordx4 v192, s[12:15], s3 offen offset:256 nt lds
  s_add_u32 m0, s37, 23296
  s_nop 0
  buffer_load_dwordx4 v193, s[12:15], s3 offen offset:256 nt lds
  s_waitcnt vmcnt(24)
  ds_read_b128 a[176:179], v199 offset:24576
  ds_read_b128 a[180:183], v200 offset:24576
  ds_read_b128 a[184:187], v201 offset:24576
  ds_read_b128 a[188:191], v202 offset:24576
  ds_read_b128 a[192:195], v199 offset:26624
  ds_read_b128 a[196:199], v200 offset:26624
  ds_read_b128 a[200:203], v201 offset:26624
  ds_read_b128 a[204:207], v202 offset:26624
  ds_read_b128 a[208:211], v199 offset:28672
  ds_read_b128 a[212:215], v200 offset:28672
  ds_read_b128 a[216:219], v201 offset:28672
  ds_read_b128 a[220:223], v202 offset:28672
  s_waitcnt vmcnt(6)
  s_barrier
  ds_read_b64_tr_b16 v[24:25], v195 offset:0
  ds_read_b64_tr_b16 v[26:27], v195 offset:512
  s_add_u32 m0, s37, 30720
  s_nop 0
  s_waitcnt lgkmcnt(2)
  buffer_load_dwordx4 v192, s[12:15], s45 offen nt lds
  s_waitcnt lgkmcnt(0)
  v_mfma_f32_32x32x16_bf16 v[152:167], v[24:27], a[176:179], 0
  ds_read_b64_tr_b16 a[96:97], v195 offset:6144
  ds_read_b64_tr_b16 a[98:99], v195 offset:6656
  s_add_u32 m0, s37, 31744
  s_nop 0
  buffer_load_dwordx4 v193, s[12:15], s45 offen nt lds
  s_waitcnt lgkmcnt(0)
  v_mfma_f32_32x32x16_bf16 v[152:167], a[96:99], a[180:183], v[152:167]
  ds_read_b64_tr_b16 v[28:29], v195 offset:12288
  ds_read_b64_tr_b16 v[30:31], v195 offset:12800
  s_add_u32 m0, s37, 32640
  s_nop 0
  buffer_load_dwordx4 v192, s[12:15], s45 offen offset:128 nt lds
  s_waitcnt lgkmcnt(0)
  v_mfma_f32_32x32x16_bf16 v[152:167], v[28:31], a[184:187], v[152:167]
  ds_read_b64_tr_b16 a[100:101], v195 offset:40960
  ds_read_b64_tr_b16 a[102:103], v195 offset:41472
  s_add_u32 m0, s37, 33664
  s_nop 0
  buffer_load_dwordx4 v193, s[12:15], s45 offen offset:128 nt lds
  s_waitcnt lgkmcnt(0)
  v_mfma_f32_32x32x16_bf16 v[152:167], a[100:103], a[188:191], v[152:167]
  ds_read_b64_tr_b16 v[32:33], v195 offset:47104
  ds_read_b64_tr_b16 v[34:35], v195 offset:47616
  s_add_u32 m0, s37, 34560
  s_nop 0
  buffer_load_dwordx4 v192, s[12:15], s45 offen offset:256 nt lds
  s_waitcnt lgkmcnt(0)
  v_mfma_f32_32x32x16_bf16 v[152:167], v[32:35], a[192:195], v[152:167]
  ds_read_b64_tr_b16 a[104:105], v195 offset:53248
  ds_read_b64_tr_b16 a[106:107], v195 offset:53760
  s_add_u32 m0, s37, 35584
  s_nop 0
  buffer_load_dwordx4 v193, s[12:15], s45 offen offset:256 nt lds
  s_waitcnt lgkmcnt(0)
  v_mfma_f32_32x32x16_bf16 v[152:167], a[104:107], a[196:199], v[152:167]
  ds_read_b64_tr_b16 v[36:37], v197 offset:0
  ds_read_b64_tr_b16 v[38:39], v197 offset:512
  s_waitcnt lgkmcnt(0)
  v_mfma_f32_32x32x16_bf16 v[152:167], v[36:39], a[200:203], v[152:167]
  ds_read_b64_tr_b16 a[108:109], v197 offset:6144
  ds_read_b64_tr_b16 a[110:111], v197 offset:6656
  s_waitcnt lgkmcnt(0)
  v_mfma_f32_32x32x16_bf16 v[152:167], a[108:111], a[204:207], v[152:167]
  ds_read_b64_tr_b16 v[40:41], v197 offset:12288
  ds_read_b64_tr_b16 v[42:43], v197 offset:12800
  s_waitcnt lgkmcnt(0)
  v_mfma_f32_32x32x16_bf16 v[152:167], v[40:43], a[208:211], v[152:167]
  ds_read_b64_tr_b16 a[112:113], v197 offset:40960
  ds_read_b64_tr_b16 a[114:115], v197 offset:41472
  s_waitcnt lgkmcnt(0)
  v_mfma_f32_32x32x16_bf16 v[152:167], a[112:115], a[212:215], v[152:167]
  ds_read_b64_tr_b16 v[44:45], v197 offset:47104
  ds_read_b64_tr_b16 v[46:47], v197 offset:47616
  s_waitcnt lgkmcnt(0)
  v_mfma_f32_32x32x16_bf16 v[152:167], v[44:47], a[216:219], v[152:167]
  ds_read_b64_tr_b16 a[116:117], v197 offset:53248
  ds_read_b64_tr_b16 a[118:119], v197 offset:53760
  s_waitcnt lgkmcnt(0)
  v_mfma_f32_32x32x16_bf16 v[152:167], a[116:119], a[220:223], v[152:167]
  ds_read_b64_tr_b16 v[48:49], v196 offset:0
  ds_read_b64_tr_b16 v[50:51], v196 offset:512
  s_nop 3
  s_waitcnt lgkmcnt(0)
  v_mfma_f32_32x32x16_bf16 v[136:151], v[48:51], a[176:179], 0
  ds_read_b64_tr_b16 a[120:121], v196 offset:6144
  ds_read_b64_tr_b16 a[122:123], v196 offset:6656
  s_nop 1
  v_cvt_pk_bf16_f32 v112, v152, v153
  v_cvt_pk_bf16_f32 v0, v160, v161
  v_cvt_pk_bf16_f32 v113, v154, v155
  v_cvt_pk_bf16_f32 v1, v162, v163
  v_cvt_pk_bf16_f32 v114, v156, v157
  v_cvt_pk_bf16_f32 v2, v164, v165
  v_cvt_pk_bf16_f32 v115, v158, v159
  v_cvt_pk_bf16_f32 v3, v166, v167
  v_permlane16_swap_b32 v112, v0
  v_permlane16_swap_b32 v113, v1
  s_waitcnt lgkmcnt(0)
  v_mfma_f32_32x32x16_bf16 v[136:151], a[120:123], a[180:183], v[136:151]
  ds_read_b64_tr_b16 v[52:53], v196 offset:12288
  ds_read_b64_tr_b16 v[54:55], v196 offset:12800
  v_permlane16_swap_b32 v114, v2
  v_permlane16_swap_b32 v115, v3
  s_waitcnt lgkmcnt(0)
  v_mfma_f32_32x32x16_bf16 v[136:151], v[52:55], a[184:187], v[136:151]
  ds_read_b64_tr_b16 a[124:125], v196 offset:40960
  ds_read_b64_tr_b16 a[126:127], v196 offset:41472
  s_waitcnt lgkmcnt(0)
  v_mfma_f32_32x32x16_bf16 v[136:151], a[124:127], a[188:191], v[136:151]
  ds_read_b64_tr_b16 v[56:57], v196 offset:47104
  ds_read_b64_tr_b16 v[58:59], v196 offset:47616
  s_waitcnt lgkmcnt(0)
  v_mfma_f32_32x32x16_bf16 v[136:151], v[56:59], a[192:195], v[136:151]
  ds_read_b64_tr_b16 a[128:129], v196 offset:53248
  ds_read_b64_tr_b16 a[130:131], v196 offset:53760
  s_waitcnt lgkmcnt(0)
  v_mfma_f32_32x32x16_bf16 v[136:151], a[128:131], a[196:199], v[136:151]
  ds_read_b64_tr_b16 v[60:61], v198 offset:0
  ds_read_b64_tr_b16 v[62:63], v198 offset:512
  s_waitcnt lgkmcnt(0)
  v_mfma_f32_32x32x16_bf16 v[136:151], v[60:63], a[200:203], v[136:151]
  ds_read_b64_tr_b16 a[132:133], v198 offset:6144
  ds_read_b64_tr_b16 a[134:135], v198 offset:6656
  s_waitcnt lgkmcnt(0)
  v_mfma_f32_32x32x16_bf16 v[136:151], a[132:135], a[204:207], v[136:151]
  ds_read_b64_tr_b16 v[64:65], v198 offset:12288
  ds_read_b64_tr_b16 v[66:67], v198 offset:12800
  s_waitcnt lgkmcnt(0)
  v_mfma_f32_32x32x16_bf16 v[136:151], v[64:67], a[208:211], v[136:151]
  ds_read_b64_tr_b16 a[136:137], v198 offset:40960
  ds_read_b64_tr_b16 a[138:139], v198 offset:41472
  v_mfma_f32_16x16x32_bf16 v[228:231], v[112:115], v[112:115], 0
  v_mfma_f32_16x16x32_bf16 v[232:235], a[168:171], v[112:115], 0
  v_mfma_f32_16x16x32_bf16 v[236:239], v[0:3], v[0:3], 0
  v_mfma_f32_16x16x32_bf16 v[224:227], a[168:171], v[0:3], 0
  s_waitcnt lgkmcnt(0)
  v_mfma_f32_32x32x16_bf16 v[136:151], a[136:139], a[212:215], v[136:151]
  ds_read_b64_tr_b16 v[68:69], v198 offset:47104
  ds_read_b64_tr_b16 v[70:71], v198 offset:47616
  s_waitcnt lgkmcnt(0)
  v_mfma_f32_32x32x16_bf16 v[136:151], v[68:71], a[216:219], v[136:151]
  ds_read_b64_tr_b16 a[140:141], v198 offset:53248
  ds_read_b64_tr_b16 a[142:143], v198 offset:53760
  s_waitcnt lgkmcnt(0)
  v_mfma_f32_32x32x16_bf16 v[136:151], a[140:143], a[220:223], v[136:151]
  ds_read_b64_tr_b16 v[24:25], v195 offset:1024
  ds_read_b64_tr_b16 v[26:27], v195 offset:1536
  s_nop 3
  s_waitcnt lgkmcnt(0)
  v_mfma_f32_32x32x16_bf16 v[152:167], v[24:27], a[176:179], 0
  ds_read_b64_tr_b16 a[0:1], v195 offset:7168
  ds_read_b64_tr_b16 a[2:3], v195 offset:7680
  s_nop 1
  v_cvt_pk_bf16_f32 v116, v136, v137
  v_cvt_pk_bf16_f32 v4, v144, v145
  v_cvt_pk_bf16_f32 v117, v138, v139
  v_cvt_pk_bf16_f32 v5, v146, v147
  v_cvt_pk_bf16_f32 v118, v140, v141
  v_cvt_pk_bf16_f32 v6, v148, v149
  v_cvt_pk_bf16_f32 v119, v142, v143
  v_cvt_pk_bf16_f32 v7, v150, v151
  v_permlane16_swap_b32 v116, v4
  v_permlane16_swap_b32 v117, v5
  s_waitcnt lgkmcnt(0)
  v_mfma_f32_32x32x16_bf16 v[152:167], a[0:3], a[180:183], v[152:167]
  ds_read_b64_tr_b16 v[28:29], v195 offset:13312
  ds_read_b64_tr_b16 v[30:31], v195 offset:13824
  v_permlane16_swap_b32 v118, v6
  v_permlane16_swap_b32 v119, v7
  s_waitcnt lgkmcnt(0)
  v_mfma_f32_32x32x16_bf16 v[152:167], v[28:31], a[184:187], v[152:167]
  ds_read_b64_tr_b16 a[24:25], v195 offset:41984
  ds_read_b64_tr_b16 a[26:27], v195 offset:42496
  s_waitcnt lgkmcnt(0)
  v_mfma_f32_32x32x16_bf16 v[152:167], a[24:27], a[188:191], v[152:167]
  ds_read_b64_tr_b16 v[32:33], v195 offset:48128
  ds_read_b64_tr_b16 v[34:35], v195 offset:48640
  s_waitcnt lgkmcnt(0)
  v_mfma_f32_32x32x16_bf16 v[152:167], v[32:35], a[192:195], v[152:167]
  ds_read_b64_tr_b16 a[48:49], v195 offset:54272
  ds_read_b64_tr_b16 a[50:51], v195 offset:54784
  s_waitcnt lgkmcnt(0)
  v_mfma_f32_32x32x16_bf16 v[152:167], a[48:51], a[196:199], v[152:167]
  ds_read_b64_tr_b16 v[36:37], v197 offset:1024
  ds_read_b64_tr_b16 v[38:39], v197 offset:1536
  s_waitcnt lgkmcnt(0)
  v_mfma_f32_32x32x16_bf16 v[152:167], v[36:39], a[200:203], v[152:167]
  ds_read_b64_tr_b16 a[72:73], v197 offset:7168
  ds_read_b64_tr_b16 a[74:75], v197 offset:7680
  s_waitcnt lgkmcnt(0)
  v_mfma_f32_32x32x16_bf16 v[152:167], a[72:75], a[204:207], v[152:167]
  ds_read_b64_tr_b16 v[40:41], v197 offset:13312
  ds_read_b64_tr_b16 v[42:43], v197 offset:13824
  s_waitcnt lgkmcnt(0)
  v_mfma_f32_32x32x16_bf16 v[152:167], v[40:43], a[208:211], v[152:167]
  ds_read_b64_tr_b16 a[4:5], v197 offset:41984
  ds_read_b64_tr_b16 a[6:7], v197 offset:42496
  v_mfma_f32_16x16x32_bf16 v[228:231], v[116:119], v[116:119], v[228:231]
  v_mfma_f32_16x16x32_bf16 v[232:235], a[168:171], v[116:119], v[232:235]
  v_mfma_f32_16x16x32_bf16 v[236:239], v[4:7], v[4:7], v[236:239]
  s_lshl_b32 s47, s36, 6
  s_mul_i32 s91, s36, 12288
  v_mfma_f32_16x16x32_bf16 v[224:227], a[168:171], v[4:7], v[224:227]
  buffer_load_dwordx4 v[108:111], v102, s[20:23], s47 offen sc1
  s_waitcnt lgkmcnt(0)
  v_mfma_f32_32x32x16_bf16 v[152:167], a[4:7], a[212:215], v[152:167]
  ds_read_b64_tr_b16 v[44:45], v197 offset:48128
  ds_read_b64_tr_b16 v[46:47], v197 offset:48640
  s_add_u32 s91, s91, 3145728
  s_add_u32 s92, s91, 4096
  s_add_u32 s46, s91, 8192
  buffer_load_dwordx2 v[104:105], v102, s[20:23], s47 offen offset:16 sc1
  s_waitcnt lgkmcnt(0)
  v_mfma_f32_32x32x16_bf16 v[152:167], v[44:47], a[216:219], v[152:167]
  ds_read_b64_tr_b16 a[28:29], v197 offset:54272
  ds_read_b64_tr_b16 a[30:31], v197 offset:54784
  buffer_load_dwordx4 v[72:75], v255, s[28:31], s91 offen
  s_waitcnt lgkmcnt(0)
  v_mfma_f32_32x32x16_bf16 v[152:167], a[28:31], a[220:223], v[152:167]
  ds_read_b64_tr_b16 v[48:49], v196 offset:1024
  ds_read_b64_tr_b16 v[50:51], v196 offset:1536
  buffer_load_dwordx4 v[168:171], v255, s[28:31], s91 offen offset:1024
  s_nop 3
  s_waitcnt lgkmcnt(0)
  v_mfma_f32_32x32x16_bf16 v[136:151], v[48:51], a[176:179], 0
  ds_read_b64_tr_b16 a[52:53], v196 offset:7168
  ds_read_b64_tr_b16 a[54:55], v196 offset:7680
  buffer_load_dwordx4 v[76:79], v255, s[28:31], s91 offen offset:2048
  v_cvt_pk_bf16_f32 v120, v152, v153
  v_cvt_pk_bf16_f32 v8, v160, v161
  v_cvt_pk_bf16_f32 v121, v154, v155
  v_cvt_pk_bf16_f32 v9, v162, v163
  v_cvt_pk_bf16_f32 v122, v156, v157
  v_cvt_pk_bf16_f32 v10, v164, v165
  v_cvt_pk_bf16_f32 v123, v158, v159
  v_cvt_pk_bf16_f32 v11, v166, v167
  v_permlane16_swap_b32 v120, v8
  v_permlane16_swap_b32 v121, v9
  v_permlane16_swap_b32 v122, v10
  s_waitcnt lgkmcnt(0)
  v_mfma_f32_32x32x16_bf16 v[136:151], a[52:55], a[180:183], v[136:151]
  ds_read_b64_tr_b16 v[52:53], v196 offset:13312
  ds_read_b64_tr_b16 v[54:55], v196 offset:13824
  buffer_load_dwordx4 v[172:175], v255, s[28:31], s91 offen offset:3072
  v_permlane16_swap_b32 v123, v11
  s_waitcnt lgkmcnt(0)
  v_mfma_f32_32x32x16_bf16 v[136:151], v[52:55], a[184:187], v[136:151]
  ds_read_b64_tr_b16 a[76:77], v196 offset:41984
  ds_read_b64_tr_b16 a[78:79], v196 offset:42496
  buffer_load_dwordx4 v[80:83], v255, s[28:31], s92 offen
  s_waitcnt lgkmcnt(0)
  v_mfma_f32_32x32x16_bf16 v[136:151], a[76:79], a[188:191], v[136:151]
  ds_read_b64_tr_b16 v[56:57], v196 offset:48128
  ds_read_b64_tr_b16 v[58:59], v196 offset:48640
  buffer_load_dwordx4 v[176:179], v255, s[28:31], s92 offen offset:1024
  s_waitcnt lgkmcnt(0)
  v_mfma_f32_32x32x16_bf16 v[136:151], v[56:59], a[192:195], v[136:151]
  ds_read_b64_tr_b16 a[8:9], v196 offset:54272
  ds_read_b64_tr_b16 a[10:11], v196 offset:54784
  buffer_load_dwordx4 v[84:87], v255, s[28:31], s92 offen offset:2048
  s_waitcnt lgkmcnt(0)
  v_mfma_f32_32x32x16_bf16 v[136:151], a[8:11], a[196:199], v[136:151]
  ds_read_b64_tr_b16 v[60:61], v198 offset:1024
  ds_read_b64_tr_b16 v[62:63], v198 offset:1536
  buffer_load_dwordx4 v[180:183], v255, s[28:31], s92 offen offset:3072
  s_waitcnt lgkmcnt(0)
  v_mfma_f32_32x32x16_bf16 v[136:151], v[60:63], a[200:203], v[136:151]
  ds_read_b64_tr_b16 a[32:33], v198 offset:7168
  ds_read_b64_tr_b16 a[34:35], v198 offset:7680
  buffer_load_dwordx4 v[88:91], v255, s[28:31], s46 offen
  s_waitcnt lgkmcnt(0)
  v_mfma_f32_32x32x16_bf16 v[136:151], a[32:35], a[204:207], v[136:151]
  ds_read_b64_tr_b16 v[64:65], v198 offset:13312
  ds_read_b64_tr_b16 v[66:67], v198 offset:13824
  buffer_load_dwordx4 v[184:187], v255, s[28:31], s46 offen offset:1024
  s_waitcnt lgkmcnt(0)
  v_mfma_f32_32x32x16_bf16 v[136:151], v[64:67], a[208:211], v[136:151]
  ds_read_b64_tr_b16 a[56:57], v198 offset:41984
  ds_read_b64_tr_b16 a[58:59], v198 offset:42496
  buffer_load_dwordx4 v[92:95], v255, s[28:31], s46 offen offset:2048
  v_mfma_f32_16x16x32_bf16 v[228:231], v[120:123], v[120:123], v[228:231]
  s_add_u32 m0, s37, 24576
  v_mfma_f32_16x16x32_bf16 v[232:235], a[168:171], v[120:123], v[232:235]
  v_mfma_f32_16x16x32_bf16 v[236:239], v[8:11], v[8:11], v[236:239]
  buffer_load_dwordx4 v[188:191], v255, s[28:31], s46 offen offset:3072
  v_mfma_f32_16x16x32_bf16 v[224:227], a[168:171], v[8:11], v[224:227]
  s_waitcnt lgkmcnt(0)
  v_mfma_f32_32x32x16_bf16 v[136:151], a[56:59], a[212:215], v[136:151]
  ds_read_b64_tr_b16 v[68:69], v198 offset:48128
  ds_read_b64_tr_b16 v[70:71], v198 offset:48640
  buffer_load_dwordx4 v251, s[8:11], s64 offen nt lds
  s_add_u32 m0, s37, 25600
  s_waitcnt lgkmcnt(0)
  v_mfma_f32_32x32x16_bf16 v[136:151], v[68:71], a[216:219], v[136:151]
  ds_read_b64_tr_b16 a[80:81], v198 offset:54272
  ds_read_b64_tr_b16 a[82:83], v198 offset:54784
  buffer_load_dwordx4 v252, s[8:11], s64 offen nt lds
  s_add_u32 m0, s37, 26496
  s_waitcnt lgkmcnt(0)
  v_mfma_f32_32x32x16_bf16 v[136:151], a[80:83], a[220:223], v[136:151]
  ds_read_b64_tr_b16 v[24:25], v195 offset:2048
  ds_read_b64_tr_b16 v[26:27], v195 offset:2560
  buffer_load_dwordx4 v251, s[8:11], s64 offen offset:128 nt lds
  s_nop 3
  s_waitcnt lgkmcnt(0)
  v_mfma_f32_32x32x16_bf16 v[152:167], v[24:27], a[176:179], 0
  ds_read_b64_tr_b16 a[12:13], v195 offset:8192
  ds_read_b64_tr_b16 a[14:15], v195 offset:8704
  s_add_u32 m0, s37, 27520
  v_cvt_pk_bf16_f32 v124, v136, v137
  buffer_load_dwordx4 v252, s[8:11], s64 offen offset:128 nt lds
  v_cvt_pk_bf16_f32 v12, v144, v145
  v_cvt_pk_bf16_f32 v125, v138, v139
  v_cvt_pk_bf16_f32 v13, v146, v147
  v_cvt_pk_bf16_f32 v126, v140, v141
  v_cvt_pk_bf16_f32 v14, v148, v149
  v_cvt_pk_bf16_f32 v127, v142, v143
  v_cvt_pk_bf16_f32 v15, v150, v151
  v_permlane16_swap_b32 v124, v12
  s_waitcnt lgkmcnt(0)
  v_mfma_f32_32x32x16_bf16 v[152:167], a[12:15], a[180:183], v[152:167]
  ds_read_b64_tr_b16 v[28:29], v195 offset:14336
  ds_read_b64_tr_b16 v[30:31], v195 offset:14848
  v_permlane16_swap_b32 v125, v13
  s_add_u32 m0, s37, 28416
  v_permlane16_swap_b32 v126, v14
  buffer_load_dwordx4 v251, s[8:11], s64 offen offset:256 nt lds
  v_permlane16_swap_b32 v127, v15
  s_waitcnt lgkmcnt(0)
  v_mfma_f32_32x32x16_bf16 v[152:167], v[28:31], a[184:187], v[152:167]
  ds_read_b64_tr_b16 a[36:37], v195 offset:43008
  ds_read_b64_tr_b16 a[38:39], v195 offset:43520
  s_add_u32 m0, s37, 29440
  s_nop 0
  buffer_load_dwordx4 v252, s[8:11], s64 offen offset:256 nt lds
  s_waitcnt lgkmcnt(0)
  v_mfma_f32_32x32x16_bf16 v[152:167], a[36:39], a[188:191], v[152:167]
  ds_read_b64_tr_b16 v[32:33], v195 offset:49152
  ds_read_b64_tr_b16 v[34:35], v195 offset:49664
  s_waitcnt lgkmcnt(0)
  v_mfma_f32_32x32x16_bf16 v[152:167], v[32:35], a[192:195], v[152:167]
  ds_read_b64_tr_b16 a[60:61], v195 offset:55296
  ds_read_b64_tr_b16 a[62:63], v195 offset:55808
  s_waitcnt lgkmcnt(0)
  v_mfma_f32_32x32x16_bf16 v[152:167], a[60:63], a[196:199], v[152:167]
  ds_read_b64_tr_b16 v[36:37], v197 offset:2048
  ds_read_b64_tr_b16 v[38:39], v197 offset:2560
  s_waitcnt lgkmcnt(0)
  v_mfma_f32_32x32x16_bf16 v[152:167], v[36:39], a[200:203], v[152:167]
  ds_read_b64_tr_b16 a[84:85], v197 offset:8192
  ds_read_b64_tr_b16 a[86:87], v197 offset:8704
  s_waitcnt lgkmcnt(0)
  v_mfma_f32_32x32x16_bf16 v[152:167], a[84:87], a[204:207], v[152:167]
  ds_read_b64_tr_b16 v[40:41], v197 offset:14336
  ds_read_b64_tr_b16 v[42:43], v197 offset:14848
  s_waitcnt lgkmcnt(0)
  v_mfma_f32_32x32x16_bf16 v[152:167], v[40:43], a[208:211], v[152:167]
  ds_read_b64_tr_b16 a[16:17], v197 offset:43008
  ds_read_b64_tr_b16 a[18:19], v197 offset:43520
  v_mfma_f32_16x16x32_bf16 v[228:231], v[124:127], v[124:127], v[228:231]
  v_mfma_f32_16x16x32_bf16 v[232:235], a[168:171], v[124:127], v[232:235]
  v_mfma_f32_16x16x32_bf16 v[236:239], v[12:15], v[12:15], v[236:239]
  v_mfma_f32_16x16x32_bf16 v[224:227], a[168:171], v[12:15], v[224:227]
  s_waitcnt lgkmcnt(0)
  v_mfma_f32_32x32x16_bf16 v[152:167], a[16:19], a[212:215], v[152:167]
  ds_read_b64_tr_b16 v[44:45], v197 offset:49152
  ds_read_b64_tr_b16 v[46:47], v197 offset:49664
  s_waitcnt lgkmcnt(0)
  v_mfma_f32_32x32x16_bf16 v[152:167], v[44:47], a[216:219], v[152:167]
  ds_read_b64_tr_b16 a[40:41], v197 offset:55296
  ds_read_b64_tr_b16 a[42:43], v197 offset:55808
  s_waitcnt lgkmcnt(0)
  v_mfma_f32_32x32x16_bf16 v[152:167], a[40:43], a[220:223], v[152:167]
  ds_read_b64_tr_b16 v[48:49], v196 offset:2048
  ds_read_b64_tr_b16 v[50:51], v196 offset:2560
  s_nop 3
  s_waitcnt lgkmcnt(0)
  v_mfma_f32_32x32x16_bf16 v[136:151], v[48:51], a[176:179], 0
  ds_read_b64_tr_b16 a[64:65], v196 offset:8192
  ds_read_b64_tr_b16 a[66:67], v196 offset:8704
  s_nop 1
  v_cvt_pk_bf16_f32 v128, v152, v153
  v_cvt_pk_bf16_f32 v16, v160, v161
  v_cvt_pk_bf16_f32 v129, v154, v155
  v_cvt_pk_bf16_f32 v17, v162, v163
  v_cvt_pk_bf16_f32 v130, v156, v157
  v_cvt_pk_bf16_f32 v18, v164, v165
  v_cvt_pk_bf16_f32 v131, v158, v159
  v_cvt_pk_bf16_f32 v19, v166, v167
  v_permlane16_swap_b32 v128, v16
  v_permlane16_swap_b32 v129, v17
  s_waitcnt lgkmcnt(0)
  v_mfma_f32_32x32x16_bf16 v[136:151], a[64:67], a[180:183], v[136:151]
  ds_read_b64_tr_b16 v[52:53], v196 offset:14336
  ds_read_b64_tr_b16 v[54:55], v196 offset:14848
  v_permlane16_swap_b32 v130, v18
  v_permlane16_swap_b32 v131, v19
  s_waitcnt lgkmcnt(0)
  v_mfma_f32_32x32x16_bf16 v[136:151], v[52:55], a[184:187], v[136:151]
  ds_read_b64_tr_b16 a[88:89], v196 offset:43008
  ds_read_b64_tr_b16 a[90:91], v196 offset:43520
  s_waitcnt lgkmcnt(0)
  v_mfma_f32_32x32x16_bf16 v[136:151], a[88:91], a[188:191], v[136:151]
  ds_read_b64_tr_b16 v[56:57], v196 offset:49152
  ds_read_b64_tr_b16 v[58:59], v196 offset:49664
  s_waitcnt lgkmcnt(0)
  v_mfma_f32_32x32x16_bf16 v[136:151], v[56:59], a[192:195], v[136:151]
  ds_read_b64_tr_b16 a[20:21], v196 offset:55296
  ds_read_b64_tr_b16 a[22:23], v196 offset:55808
  s_waitcnt lgkmcnt(0)
  v_mfma_f32_32x32x16_bf16 v[136:151], a[20:23], a[196:199], v[136:151]
  ds_read_b64_tr_b16 v[60:61], v198 offset:2048
  ds_read_b64_tr_b16 v[62:63], v198 offset:2560
  s_waitcnt lgkmcnt(0)
  v_mfma_f32_32x32x16_bf16 v[136:151], v[60:63], a[200:203], v[136:151]
  ds_read_b64_tr_b16 a[44:45], v198 offset:8192
  ds_read_b64_tr_b16 a[46:47], v198 offset:8704
  s_waitcnt lgkmcnt(0)
  v_mfma_f32_32x32x16_bf16 v[136:151], a[44:47], a[204:207], v[136:151]
  ds_read_b64_tr_b16 v[64:65], v198 offset:14336
  ds_read_b64_tr_b16 v[66:67], v198 offset:14848
  s_waitcnt lgkmcnt(0)
  v_mfma_f32_32x32x16_bf16 v[136:151], v[64:67], a[208:211], v[136:151]
  ds_read_b64_tr_b16 a[68:69], v198 offset:43008
  ds_read_b64_tr_b16 a[70:71], v198 offset:43520
  v_mfma_f32_16x16x32_bf16 v[228:231], v[128:131], v[128:131], v[228:231]
  v_mfma_f32_16x16x32_bf16 v[232:235], a[168:171], v[128:131], v[232:235]
  v_mfma_f32_16x16x32_bf16 v[236:239], v[16:19], v[16:19], v[236:239]
  v_mfma_f32_16x16x32_bf16 v[224:227], a[168:171], v[16:19], v[224:227]
  s_waitcnt lgkmcnt(0)
  v_mfma_f32_32x32x16_bf16 v[136:151], a[68:71], a[212:215], v[136:151]
  ds_read_b64_tr_b16 v[68:69], v198 offset:49152
  ds_read_b64_tr_b16 v[70:71], v198 offset:49664
  s_waitcnt lgkmcnt(0)
  v_mfma_f32_32x32x16_bf16 v[136:151], v[68:71], a[216:219], v[136:151]
  ds_read_b64_tr_b16 a[92:93], v198 offset:55296
  ds_read_b64_tr_b16 a[94:95], v198 offset:55808
  s_waitcnt lgkmcnt(0)
  v_mfma_f32_32x32x16_bf16 v[136:151], a[92:95], a[220:223], v[136:151]
  s_nop 11
  v_cvt_pk_bf16_f32 v132, v136, v137
  v_cvt_pk_bf16_f32 v20, v144, v145
  v_cvt_pk_bf16_f32 v133, v138, v139
  v_cvt_pk_bf16_f32 v21, v146, v147
  v_cvt_pk_bf16_f32 v134, v140, v141
  v_cvt_pk_bf16_f32 v22, v148, v149
  v_cvt_pk_bf16_f32 v135, v142, v143
  v_cvt_pk_bf16_f32 v23, v150, v151
  v_permlane16_swap_b32 v132, v20
  v_permlane16_swap_b32 v133, v21
  v_permlane16_swap_b32 v134, v22
  v_permlane16_swap_b32 v135, v23
  s_nop 1
  v_mfma_f32_16x16x32_bf16 v[228:231], v[132:135], v[132:135], v[228:231]
  v_mfma_f32_16x16x32_bf16 v[232:235], a[168:171], v[132:135], v[232:235]
  v_mfma_f32_16x16x32_bf16 v[236:239], v[20:23], v[20:23], v[236:239]
  v_mfma_f32_16x16x32_bf16 v[224:227], a[168:171], v[20:23], v[224:227]
  s_nop 4
  v_cndmask_b32 v240, v228, v229, s[48:49]
  v_cndmask_b32 v243, v230, v231, s[48:49]
  v_cndmask_b32 v240, v240, v243, s[50:51]
  v_add_f32 v240, s90, v240
  v_cndmask_b32 v96, v236, v237, s[48:49]
  v_cndmask_b32 v243, v238, v239, s[48:49]
  v_mov_b32 v241, v232
  v_cndmask_b32 v96, v96, v243, s[50:51]
  v_add_f32 v96, s90, v96
  v_mov_b32 v97, v224
  s_waitcnt vmcnt(20)
  ds_read_b128 a[224:227], v203 offset:18432
  ds_read_b128 a[228:231], v204 offset:18432
  ds_read_b128 a[232:235], v205 offset:18432
  ds_read_b128 a[236:239], v206 offset:18432
  ds_read_b128 a[240:243], v203 offset:20480
  ds_read_b128 a[244:247], v204 offset:20480
  ds_read_b128 a[248:251], v205 offset:20480
  ds_read_b128 a[252:255], v206 offset:20480
  ds_read_b128 a[144:147], v203 offset:22528
  ds_read_b128 a[148:151], v204 offset:22528
  ds_read_b128 a[152:155], v205 offset:22528
  ds_read_b128 a[156:159], v206 offset:22528
  s_waitcnt lgkmcnt(0)
L_join:
  ds_read_b64_tr_b16 a[176:177], v195 offset:0
  ds_read_b64_tr_b16 a[178:179], v195 offset:512
  ds_read_b64_tr_b16 a[180:181], v195 offset:12288
  ds_read_b64_tr_b16 a[182:183], v195 offset:12800
  ds_read_b64_tr_b16 a[184:185], v195 offset:47104
  ds_read_b64_tr_b16 a[186:187], v195 offset:47616
  s_mul_i32 s40, s36, 18432
  s_mul_i32 s41, s36, 18432
  s_mul_i32 s42, s36, 18432
  s_add_u32 s40, s40, 0
  s_add_u32 s41, s41, 6144
  s_add_u32 s42, s42, 12288
  ds_read_b64_tr_b16 a[188:189], v197 offset:0
  ds_read_b64_tr_b16 a[190:191], v197 offset:512
  ds_read_b64_tr_b16 a[192:193], v197 offset:12288
  ds_read_b64_tr_b16 a[194:195], v197 offset:12800
  ds_read_b64_tr_b16 a[196:197], v197 offset:47104
  ds_read_b64_tr_b16 a[198:199], v197 offset:47616
  ds_read_b64_tr_b16 a[200:201], v196 offset:0
  ds_read_b64_tr_b16 a[202:203], v196 offset:512
  ds_read_b64_tr_b16 a[204:205], v196 offset:12288
  ds_read_b64_tr_b16 a[206:207], v196 offset:12800
  ds_read_b64_tr_b16 a[208:209], v196 offset:47104
  ds_read_b64_tr_b16 a[210:211], v196 offset:47616
  s_waitcnt lgkmcnt(15)
  v_mfma_f32_32x32x16_bf16 v[152:167], a[176:179], a[224:227], 0
  ds_read_b64_tr_b16 a[212:213], v198 offset:0
  ds_read_b64_tr_b16 a[214:215], v198 offset:512
  v_mfma_f32_32x32x16_bf16 v[152:167], a[96:99], a[228:231], v[152:167]
  ds_read_b64_tr_b16 a[216:217], v198 offset:12288
  ds_read_b64_tr_b16 a[218:219], v198 offset:12800
  ds_read_b64_tr_b16 a[220:221], v198 offset:47104
  ds_read_b64_tr_b16 a[222:223], v198 offset:47616
  ds_read_b64_tr_b16 a[176:177], v195 offset:1024
  s_waitcnt lgkmcnt(15)
  v_mfma_f32_32x32x16_bf16 v[152:167], a[180:183], a[232:235], v[152:167]
  ds_read_b64_tr_b16 a[178:179], v195 offset:1536
  ds_read_b64_tr_b16 a[180:181], v195 offset:13312
  v_mfma_f32_32x32x16_bf16 v[152:167], a[100:103], a[236:239], v[152:167]
  ds_read_b64_tr_b16 a[182:183], v195 offset:13824
  v_mfma_f32_32x32x16_bf16 v[152:167], a[184:187], a[240:243], v[152:167]
  ds_read_b64_tr_b16 a[184:185], v195 offset:48128
  ds_read_b64_tr_b16 a[186:187], v195 offset:48640
  v_mfma_f32_32x32x16_bf16 v[152:167], a[104:107], a[244:247], v[152:167]
  v_mfma_f32_32x32x16_bf16 v[152:167], a[188:191], a[248:251], v[152:167]
  ds_read_b64_tr_b16 a[188:189], v197 offset:1024
  ds_read_b64_tr_b16 a[190:191], v197 offset:1536
  v_mfma_f32_32x32x16_bf16 v[152:167], a[108:111], a[252:255], v[152:167]
  v_mfma_f32_32x32x16_bf16 v[152:167], a[192:195], a[144:147], v[152:167]
  ds_read_b64_tr_b16 a[192:193], v197 offset:13312
  ds_read_b64_tr_b16 a[194:195], v197 offset:13824
  v_mfma_f32_32x32x16_bf16 v[152:167], a[112:115], a[148:151], v[152:167]
  s_waitcnt vmcnt(17)
  v_xor_b32 v107, v72, v108
  s_waitcnt vmcnt(16)
  v_xor_b32 v106, v168, v108
  v_or_b32 v207, v107, v106
  s_waitcnt lgkmcnt(4)
  v_mfma_f32_32x32x16_bf16 v[152:167], a[196:199], a[152:155], v[152:167]
  s_waitcnt vmcnt(15)
  v_xor_b32 v107, v76, v109
  s_waitcnt vmcnt(14)
  v_xor_b32 v106, v172, v109
  v_or3_b32 v207, v207, v107, v106
  ds_read_b64_tr_b16 a[196:197], v197 offset:48128
  v_mfma_f32_32x32x16_bf16 v[152:167], a[116:119], a[156:159], v[152:167]
  s_waitcnt vmcnt(13)
  v_xor_b32 v107, v80, v110
  s_waitcnt vmcnt(12)
  v_xor_b32 v106, v176, v110
  v_or3_b32 v207, v207, v107, v106
  ds_read_b64_tr_b16 a[198:199], v197 offset:48640
  v_mfma_f32_32x32x16_bf16 v[136:151], a[200:203], a[224:227], 0
  s_waitcnt vmcnt(11)
  v_xor_b32 v107, v84, v111
  s_waitcnt vmcnt(10)
  v_xor_b32 v106, v180, v111
  v_or3_b32 v207, v207, v107, v106
  v_cvt_pk_bf16_f32 v24, v152, v153
  v_mfma_f32_32x32x16_bf16 v[136:151], a[120:123], a[228:231], v[136:151]
  s_waitcnt vmcnt(9)
  v_xor_b32 v107, v88, v104
  s_waitcnt vmcnt(8)
  v_xor_b32 v106, v184, v104
  v_or3_b32 v207, v207, v107, v106
  v_cvt_pk_bf16_f32 v48, v160, v161
  v_mfma_f32_32x32x16_bf16 v[136:151], a[204:207], a[232:235], v[136:151]
  s_waitcnt vmcnt(7)
  v_xor_b32 v107, v92, v105
  s_waitcnt vmcnt(6)
  v_xor_b32 v106, v188, v105
  v_or3_b32 v207, v207, v107, v106
  v_min3_u32 v107, v108, v109, v110
  v_mfma_f32_32x32x16_bf16 v[136:151], a[124:127], a[236:239], v[136:151]
  v_and_b32 v207, 0xff, v207
  v_min3_u32 v107, v107, v111, v104
  v_cmp_ne_u32 vcc, 0, v207
  s_add_u32 m0, s37, 18048
  v_min_u32 v107, v107, v105
  v_cmp_eq_u32_e64 s[6:7], 0, v107
  v_mfma_f32_32x32x16_bf16 v[136:151], a[208:211], a[240:243], v[136:151]
  buffer_load_dwordx4 v251, s[8:11], s64 offen offset:384 nt lds
  s_or_b64 vcc, vcc, s[6:7]
  s_cbranch_scc1 L_spin
L_pok:
  v_mfma_f32_32x32x16_bf16 v[136:151], a[128:131], a[244:247], v[136:151]
  v_cvt_pk_bf16_f32 v25, v154, v155
  v_cvt_pk_bf16_f32 v49, v162, v163
  v_cvt_pk_bf16_f32 v26, v156, v157
  v_cvt_pk_bf16_f32 v50, v164, v165
  v_cvt_pk_bf16_f32 v27, v158, v159
  v_cvt_pk_bf16_f32 v51, v166, v167
  v_mfma_f32_32x32x16_bf16 v[136:151], a[212:215], a[248:251], v[136:151]
  v_add_f32 v108, v72, v168
  v_add_f32 v109, v73, v169
  v_permlane16_swap_b32 v24, v48
  v_permlane16_swap_b32 v25, v49
  v_mfma_f32_32x32x16_bf16 v[136:151], a[132:135], a[252:255], v[136:151]
  v_permlane16_swap_b32 v26, v50
  v_add_f32 v110, v74, v170
  v_permlane16_swap_b32 v27, v51
  v_add_f32 v111, v75, v171
  v_mfma_f32_32x32x16_bf16 v[136:151], a[216:219], a[144:147], v[136:151]
  v_add_f32 v108, v108, v76
  v_add_f32 v109, v109, v77
  v_add_f32 v110, v110, v78
  v_add_f32 v111, v111, v79
  s_add_u32 m0, s37, 19072
  v_add_f32 v108, v108, v172
  v_mfma_f32_16x16x32_bf16 v[228:231], v[24:27], v[24:27], 0
  v_add_f32 v109, v109, v173
  v_add_f32 v110, v110, v174
  v_mfma_f32_16x16x32_bf16 v[232:235], a[168:171], v[24:27], 0
  v_add_f32 v111, v111, v175
  v_add_f32 v108, v108, v80
  v_mfma_f32_16x16x32_bf16 v[236:239], v[48:51], v[48:51], 0
  buffer_load_dwordx4 v252, s[8:11], s64 offen offset:384 nt lds
  v_mfma_f32_16x16x32_bf16 v[224:227], a[168:171], v[48:51], 0
  v_add_f32 v109, v109, v81
  v_add_f32 v110, v110, v82
  v_mfma_f32_32x32x16_bf16 v[136:151], a[136:139], a[148:151], v[136:151]
  v_add_f32 v111, v111, v83
  v_add_f32 v108, v108, v176
  v_add_f32 v109, v109, v177
  v_add_f32 v110, v110, v178
  v_add_f32 v111, v111, v179
  v_add_f32 v108, v108, v84
  v_mfma_f32_32x32x16_bf16 v[136:151], a[220:223], a[152:155], v[136:151]
  v_add_f32 v109, v109, v85
  v_add_f32 v110, v110, v86
  v_add_f32 v111, v111, v87
  v_add_f32 v108, v108, v180
  s_add_u32 m0, s37, 19968
  v_add_f32 v109, v109, v181
  v_mfma_f32_32x32x16_bf16 v[136:151], a[140:143], a[156:159], v[136:151]
  v_add_f32 v110, v110, v182
  buffer_load_dwordx4 v251, s[8:11], s64 offen offset:512 nt lds
  v_add_f32 v111, v111, v183
  v_add_f32 v108, v108, v88
  v_mfma_f32_32x32x16_bf16 v[152:167], a[176:179], a[224:227], 0
  v_add_f32 v109, v109, v89
  v_add_f32 v110, v110, v90
  v_add_f32 v111, v111, v91
  v_add_f32 v108, v108, v184
  v_add_f32 v109, v109, v185
  v_add_f32 v110, v110, v186
  v_mfma_f32_32x32x16_bf16 v[152:167], a[0:3], a[228:231], v[152:167]
  v_add_f32 v111, v111, v187
  v_add_f32 v108, v108, v92
  v_add_f32 v109, v109, v93
  v_add_f32 v110, v110, v94
  v_add_f32 v111, v111, v95
  v_add_f32 v108, v108, v188
  v_mfma_f32_32x32x16_bf16 v[152:167], a[180:183], a[232:235], v[152:167]
  v_add_f32 v109, v109, v189
  v_add_f32 v110, v110, v190
  v_add_f32 v111, v111, v191
  v_add_f32 v108, v108, v109
  v_add_f32 v110, v110, v111
  v_add_f32 v108, v108, v110
  v_mfma_f32_32x32x16_bf16 v[152:167], a[24:27], a[236:239], v[152:167]
  v_mov_b32 v109, v108
  v_cvt_pk_bf16_f32 v28, v136, v137
  s_add_u32 m0, s37, 20992
  v_permlane32_swap_b32 v108, v109
  v_add_f32 v108, v108, v109
  v_mfma_f32_32x32x16_bf16 v[152:167], a[184:187], a[240:243], v[152:167]
  v_cvt_pk_bf16_f32 v52, v144, v145
  v_cvt_pk_bf16_f32 v29, v138, v139
  v_cvt_pk_bf16_f32 v53, v146, v147
  v_cvt_pk_bf16_f32 v30, v140, v141
  v_cvt_pk_bf16_f32 v54, v148, v149
  v_cvt_pk_bf16_f32 v31, v142, v143
  buffer_load_dwordx4 v252, s[8:11], s64 offen offset:512 nt lds
  v_mfma_f32_32x32x16_bf16 v[152:167], a[48:51], a[244:247], v[152:167]
  v_cvt_pk_bf16_f32 v55, v150, v151
  v_mov_b32 v109, v108
  v_permlane16_swap_b32 v28, v52
  ds_read_b64_tr_b16 a[200:201], v196 offset:1024
  s_waitcnt lgkmcnt(1)
  v_mfma_f32_32x32x16_bf16 v[152:167], a[188:191], a[248:251], v[152:167]
  v_permlane16_swap_b32 v108, v109
  v_permlane16_swap_b32 v29, v53
  v_permlane16_swap_b32 v30, v54
  v_mfma_f32_32x32x16_bf16 v[152:167], a[72:75], a[252:255], v[152:167]
  v_permlane16_swap_b32 v31, v55
  v_add_f32 v108, v108, v109
  v_mul_f32 v108, 0xbbaaaaab, v108
  s_add_u32 m0, s37, 21888
  v_add_f32 v72, v72, v108
  v_mfma_f32_32x32x16_bf16 v[152:167], a[192:195], a[144:147], v[152:167]
  buffer_load_dwordx4 v251, s[8:11], s64 offen offset:640 nt lds
  v_add_f32 v73, v73, v108
  v_add_f32 v74, v74, v108
  v_add_f32 v75, v75, v108
  v_mfma_f32_16x16x32_bf16 v[228:231], v[28:31], v[28:31], v[228:231]
  v_add_f32 v168, v168, v108
  v_add_f32 v169, v169, v108
  v_mfma_f32_16x16x32_bf16 v[232:235], a[168:171], v[28:31], v[232:235]
  ds_read_b64_tr_b16 a[202:203], v196 offset:1536
  v_add_f32 v170, v170, v108
  v_mfma_f32_16x16x32_bf16 v[236:239], v[52:55], v[52:55], v[236:239]
  v_add_f32 v171, v171, v108
  v_add_f32 v76, v76, v108
  v_mfma_f32_16x16x32_bf16 v[224:227], a[168:171], v[52:55], v[224:227]
  ds_read_b64_tr_b16 a[204:205], v196 offset:13312
  ds_read_b64_tr_b16 a[206:207], v196 offset:13824
  v_mfma_f32_32x32x16_bf16 v[152:167], a[4:7], a[148:151], v[152:167]
  v_add_f32 v77, v77, v108
  v_add_f32 v78, v78, v108
  v_add_f32 v79, v79, v108
  v_add_f32 v172, v172, v108
  v_add_f32 v173, v173, v108
  v_add_f32 v174, v174, v108
  v_mfma_f32_32x32x16_bf16 v[152:167], a[196:199], a[152:155], v[152:167]
  v_add_f32 v175, v175, v108
  v_add_f32 v80, v80, v108
  ds_read_b64_tr_b16 a[208:209], v196 offset:48128
  ds_read_b64_tr_b16 a[210:211], v196 offset:48640
  s_add_u32 m0, s37, 22912
  v_add_f32 v81, v81, v108
  v_mfma_f32_32x32x16_bf16 v[152:167], a[28:31], a[156:159], v[152:167]
  v_add_f32 v82, v82, v108
  v_add_f32 v83, v83, v108
  v_add_f32 v176, v176, v108
  v_add_f32 v177, v177, v108
  v_add_f32 v178, v178, v108
  s_waitcnt lgkmcnt(4)
  v_mfma_f32_32x32x16_bf16 v[136:151], a[200:203], a[224:227], 0
  v_add_f32 v179, v179, v108
  v_add_f32 v84, v84, v108
  ds_read_b64_tr_b16 a[212:213], v198 offset:1024
  ds_read_b64_tr_b16 a[214:215], v198 offset:1536
  v_add_f32 v85, v85, v108
  v_add_f32 v86, v86, v108
  buffer_load_dwordx4 v252, s[8:11], s64 offen offset:640 nt lds
  v_mfma_f32_32x32x16_bf16 v[136:151], a[52:55], a[228:231], v[136:151]
  v_add_f32 v87, v87, v108
  v_add_f32 v180, v180, v108
  v_add_f32 v181, v181, v108
  v_add_f32 v182, v182, v108
  ds_read_b64_tr_b16 a[216:217], v198 offset:13312
  s_waitcnt lgkmcnt(5)
  v_mfma_f32_32x32x16_bf16 v[136:151], a[204:207], a[232:235], v[136:151]
  ds_read_b64_tr_b16 a[218:219], v198 offset:13824
  v_add_f32 v183, v183, v108
  v_add_f32 v88, v88, v108
  v_add_f32 v89, v89, v108
  v_add_f32 v90, v90, v108
  v_add_f32 v91, v91, v108
  v_mfma_f32_32x32x16_bf16 v[136:151], a[76:79], a[236:239], v[136:151]
  v_cvt_pk_bf16_f32 v32, v152, v153
  v_cvt_pk_bf16_f32 v56, v160, v161
  v_add_f32 v184, v184, v108
  v_cvt_pk_bf16_f32 v33, v154, v155
  v_cvt_pk_bf16_f32 v57, v162, v163
  s_waitcnt lgkmcnt(4)
  v_mfma_f32_32x32x16_bf16 v[136:151], a[208:211], a[240:243], v[136:151]
  v_cvt_pk_bf16_f32 v34, v156, v157
  v_cvt_pk_bf16_f32 v58, v164, v165
  v_cvt_pk_bf16_f32 v35, v158, v159
  v_cvt_pk_bf16_f32 v59, v166, v167
  v_add_f32 v185, v185, v108
  v_add_f32 v186, v186, v108
  v_mfma_f32_32x32x16_bf16 v[136:151], a[8:11], a[244:247], v[136:151]
  ds_read_b64_tr_b16 a[220:221], v198 offset:48128
  ds_read_b64_tr_b16 a[222:223], v198 offset:48640
  v_add_f32 v187, v187, v108
  v_add_f32 v92, v92, v108
  v_add_f32 v93, v93, v108
  s_waitcnt lgkmcnt(3)
  v_mfma_f32_32x32x16_bf16 v[136:151], a[212:215], a[248:251], v[136:151]
  v_permlane16_swap_b32 v32, v56
  v_permlane16_swap_b32 v33, v57
  v_permlane16_swap_b32 v34, v58
  v_mfma_f32_32x32x16_bf16 v[136:151], a[32:35], a[252:255], v[136:151]
  v_permlane16_swap_b32 v35, v59
  v_add_f32 v94, v94, v108
  v_add_f32 v95, v95, v108
  ds_read_b64_tr_b16 a[176:177], v195 offset:2048
  s_waitcnt lgkmcnt(3)
  v_mfma_f32_32x32x16_bf16 v[136:151], a[216:219], a[144:147], v[136:151]
  v_add_f32 v188, v188, v108
  v_add_f32 v189, v189, v108
  ds_read_b64_tr_b16 a[178:179], v195 offset:2560
  v_add_f32 v190, v190, v108
  v_add_f32 v191, v191, v108
  v_cvt_pk_bf16_f32 v72, v72, v73
  v_mfma_f32_16x16x32_bf16 v[228:231], v[32:35], v[32:35], v[228:231]
  v_cvt_pk_bf16_f32 v76, v76, v77
  v_cvt_pk_bf16_f32 v80, v80, v81
  v_mfma_f32_16x16x32_bf16 v[232:235], a[168:171], v[32:35], v[232:235]
  v_cvt_pk_bf16_f32 v84, v84, v85
  v_cvt_pk_bf16_f32 v88, v88, v89
  v_mfma_f32_16x16x32_bf16 v[236:239], v[56:59], v[56:59], v[236:239]
  s_waitcnt vmcnt(6)
  ds_read_b128 a[96:99], v245 offset:24576
  v_mfma_f32_16x16x32_bf16 v[224:227], a[168:171], v[56:59], v[224:227]
  ds_read_b64_tr_b16 a[180:181], v195 offset:14336
  ds_read_b64_tr_b16 a[182:183], v195 offset:14848
  v_mfma_f32_32x32x16_bf16 v[136:151], a[56:59], a[148:151], v[136:151]
  ds_read_b128 a[100:103], v246 offset:24576
  ds_read_b128 a[104:107], v245 offset:26624
  ds_read_b128 a[108:111], v246 offset:26624
  ds_read_b128 a[112:115], v245 offset:28672
  ds_read_b128 a[116:119], v246 offset:28672
  s_waitcnt lgkmcnt(9)
  v_mfma_f32_32x32x16_bf16 v[136:151], a[220:223], a[152:155], v[136:151]
  ds_read_b64_tr_b16 a[120:121], v247 offset:24576
  ds_read_b64_tr_b16 a[122:123], v249 offset:25088
  ds_read_b64_tr_b16 a[124:125], v248 offset:24576
  ds_read_b64_tr_b16 a[126:127], v250 offset:25088
  ds_read_b64_tr_b16 a[128:129], v247 offset:26624
  ds_read_b64_tr_b16 a[130:131], v249 offset:27136
  v_mfma_f32_32x32x16_bf16 v[136:151], a[80:83], a[156:159], v[136:151]
  ds_read_b64_tr_b16 a[132:133], v248 offset:26624
  ds_read_b64_tr_b16 a[134:135], v250 offset:27136
  ds_read_b64_tr_b16 a[136:137], v247 offset:28672
  ds_read_b64_tr_b16 a[138:139], v249 offset:29184
  ds_read_b64_tr_b16 a[184:185], v195 offset:49152
  s_waitcnt lgkmcnt(15)
  v_mfma_f32_32x32x16_bf16 v[152:167], a[176:179], a[224:227], 0
  ds_read_b64_tr_b16 a[186:187], v195 offset:49664
  ds_read_b64_tr_b16 a[188:189], v197 offset:2048
  ds_read_b64_tr_b16 a[190:191], v197 offset:2560
  ds_read_b64_tr_b16 a[140:141], v248 offset:28672
  ds_read_b64_tr_b16 a[192:193], v197 offset:14336
  ds_read_b64_tr_b16 a[194:195], v197 offset:14848
  v_mfma_f32_32x32x16_bf16 v[152:167], a[12:15], a[228:231], v[152:167]
  ds_read_b64_tr_b16 a[142:143], v250 offset:29184
  v_cvt_pk_bf16_f32 v92, v92, v93
  v_cvt_pk_bf16_f32 v73, v74, v75
  v_cvt_pk_bf16_f32 v77, v78, v79
  v_cvt_pk_bf16_f32 v81, v82, v83
  v_cvt_pk_bf16_f32 v85, v86, v87
  v_mfma_f32_32x32x16_bf16 v[152:167], a[180:183], a[232:235], v[152:167]
  v_cvt_pk_bf16_f32 v89, v90, v91
  v_cvt_pk_bf16_f32 v93, v94, v95
  v_cvt_pk_bf16_f32 v74, v168, v169
  v_cvt_pk_bf16_f32 v75, v170, v171
  v_cvt_pk_bf16_f32 v78, v172, v173
  v_cvt_pk_bf16_f32 v79, v174, v175
  v_mfma_f32_32x32x16_bf16 v[152:167], a[36:39], a[236:239], v[152:167]
  v_cvt_pk_bf16_f32 v82, v176, v177
  v_cvt_pk_bf16_f32 v83, v178, v179
  v_cvt_pk_bf16_f32 v86, v180, v181
  v_cvt_pk_bf16_f32 v87, v182, v183
  v_cvt_pk_bf16_f32 v90, v184, v185
  v_cvt_pk_bf16_f32 v91, v186, v187
  v_cvt_pk_bf16_f32 v94, v188, v189
  v_cvt_pk_bf16_f32 v95, v190, v191
  ds_write_b128 v103, v[72:75] offset:28672
  v_cvt_pk_bf16_f32 v36, v136, v137
  v_cvt_pk_bf16_f32 v60, v144, v145
  v_cvt_pk_bf16_f32 v37, v138, v139
  v_cvt_pk_bf16_f32 v61, v146, v147
  v_cvt_pk_bf16_f32 v38, v140, v141
  ds_write_b128 v103, v[76:79] offset:29696
  v_cvt_pk_bf16_f32 v62, v148, v149
  v_cvt_pk_bf16_f32 v39, v142, v143
  v_cvt_pk_bf16_f32 v63, v150, v151
  v_permlane16_swap_b32 v36, v60
  v_permlane16_swap_b32 v37, v61
  ds_write_b128 v103, v[80:83] offset:36864
  v_add_u32 v106, 28672, v255
  s_waitcnt lgkmcnt(9)
  v_mfma_f32_32x32x16_bf16 v[152:167], a[184:187], a[240:243], v[152:167]
  v_permlane16_swap_b32 v38, v62
  v_permlane16_swap_b32 v39, v63
  ds_write_b128 v103, v[84:87] offset:37888
  v_add_u32 v107, 81920, v106
  v_mfma_f32_32x32x16_bf16 v[152:167], a[60:63], a[244:247], v[152:167]
  s_waitcnt lgkmcnt(8)
  v_mfma_f32_32x32x16_bf16 v[152:167], a[188:191], a[248:251], v[152:167]
  ds_read_b64_tr_b16 a[196:197], v197 offset:49152
  ds_read_b64_tr_b16 a[198:199], v197 offset:49664
  ds_write_b128 v103, v[88:91] offset:38912
  v_mfma_f32_32x32x16_bf16 v[152:167], a[84:87], a[252:255], v[152:167]
  s_waitcnt lgkmcnt(7)
  v_mfma_f32_32x32x16_bf16 v[152:167], a[192:195], a[144:147], v[152:167]
  ds_write_b128 v103, v[92:95] offset:39936
  v_mfma_f32_16x16x32_bf16 v[228:231], v[36:39], v[36:39], v[228:231]
  ds_read_b64_tr_b16 a[200:201], v196 offset:2048
  ds_read_b64_tr_b16 a[202:203], v196 offset:2560
  v_mfma_f32_16x16x32_bf16 v[232:235], a[168:171], v[36:39], v[232:235]
  ds_read_b64_tr_b16 a[204:205], v196 offset:14336
  ds_read_b64_tr_b16 a[206:207], v196 offset:14848
  v_mfma_f32_16x16x32_bf16 v[236:239], v[60:63], v[60:63], v[236:239]
  ds_read_b64_tr_b16 a[208:209], v196 offset:49152
  ds_read_b64_tr_b16 a[210:211], v196 offset:49664
  v_mfma_f32_16x16x32_bf16 v[224:227], a[168:171], v[60:63], v[224:227]
  ds_read_b64_tr_b16 a[212:213], v198 offset:2048
  ds_read_b64_tr_b16 a[214:215], v198 offset:2560
  v_mfma_f32_32x32x16_bf16 v[152:167], a[16:19], a[148:151], v[152:167]
  ds_read_b64_tr_b16 a[216:217], v198 offset:14336
  ds_read_b64_tr_b16 a[218:219], v198 offset:14848
  ds_read_b64_tr_b16 a[220:221], v198 offset:49152
  s_waitcnt lgkmcnt(13)
  v_mfma_f32_32x32x16_bf16 v[152:167], a[196:199], a[152:155], v[152:167]
  ds_read_b64_tr_b16 a[222:223], v198 offset:49664
  v_mfma_f32_32x32x16_bf16 v[152:167], a[40:43], a[156:159], v[152:167]
  s_waitcnt lgkmcnt(10)
  v_mfma_f32_32x32x16_bf16 v[136:151], a[200:203], a[224:227], 0
  v_mfma_f32_32x32x16_bf16 v[136:151], a[64:67], a[228:231], v[136:151]
  s_waitcnt lgkmcnt(8)
  v_mfma_f32_32x32x16_bf16 v[136:151], a[204:207], a[232:235], v[136:151]
  v_mfma_f32_32x32x16_bf16 v[136:151], a[88:91], a[236:239], v[136:151]
  s_waitcnt lgkmcnt(0)
  s_barrier
  ds_read_b128 a[0:3], v106 offset:0
  ds_read_b128 a[24:27], v106 offset:40960
  ds_read_b128 a[48:51], v107 offset:0
  ds_read_b128 a[72:75], v107 offset:40960
  v_cvt_pk_bf16_f32 v40, v152, v153
  v_cvt_pk_bf16_f32 v64, v160, v161
  v_cvt_pk_bf16_f32 v41, v154, v155
  v_cvt_pk_bf16_f32 v65, v162, v163
  v_cvt_pk_bf16_f32 v42, v156, v157
  v_cvt_pk_bf16_f32 v66, v164, v165
  v_cvt_pk_bf16_f32 v43, v158, v159
  v_cvt_pk_bf16_f32 v67, v166, v167
  v_permlane16_swap_b32 v40, v64
  v_permlane16_swap_b32 v41, v65
  v_permlane16_swap_b32 v42, v66
  v_permlane16_swap_b32 v43, v67
  v_mfma_f32_32x32x16_bf16 v[136:151], a[208:211], a[240:243], v[136:151]
  ds_read_b128 a[4:7], v106 offset:1024
  ds_read_b128 a[28:31], v106 offset:41984
  ds_read_b128 a[52:55], v107 offset:1024
  ds_read_b128 a[76:79], v107 offset:41984
  s_add_u32 m0, s37, 30720
  ds_read_b128 a[8:11], v106 offset:8192
  v_mfma_f32_32x32x16_bf16 v[136:151], a[20:23], a[244:247], v[136:151]
  buffer_load_dwordx4 v251, s[8:11], s65 offen nt lds
  ds_read_b128 a[32:35], v106 offset:49152
  ds_read_b128 a[56:59], v107 offset:8192
  ds_read_b128 a[80:83], v107 offset:49152
  v_mfma_f32_32x32x16_bf16 v[136:151], a[212:215], a[248:251], v[136:151]
  ds_read_b128 a[12:15], v106 offset:9216
  ds_read_b128 a[36:39], v106 offset:50176
  ds_read_b128 a[60:63], v107 offset:9216
  ds_read_b128 a[84:87], v107 offset:50176
  ds_read_b128 a[16:19], v106 offset:10240
  ds_read_b128 a[40:43], v106 offset:51200
  v_mfma_f32_32x32x16_bf16 v[136:151], a[44:47], a[252:255], v[136:151]
  ds_read_b128 a[64:67], v107 offset:10240
  ds_read_b128 a[88:91], v107 offset:51200
  ds_read_b128 a[20:23], v106 offset:11264
  ds_read_b128 a[44:47], v106 offset:52224
  v_accvgpr_write_b32 a160, v64
  s_add_u32 m0, s37, 31744
  v_mfma_f32_32x32x16_bf16 v[136:151], a[216:219], a[144:147], v[136:151]
  buffer_load_dwordx4 v252, s[8:11], s65 offen nt lds
  v_accvgpr_write_b32 a161, v65
  v_accvgpr_write_b32 a162, v66
  v_accvgpr_write_b32 a163, v67
  v_mfma_f32_16x16x32_bf16 v[228:231], v[40:43], v[40:43], v[228:231]
  v_mfma_f32_16x16x32_bf16 v[232:235], a[168:171], v[40:43], v[232:235]
  v_mfma_f32_16x16x32_bf16 v[236:239], v[64:67], v[64:67], v[236:239]
  v_mfma_f32_16x16x32_bf16 v[224:227], a[168:171], v[64:67], v[224:227]
  v_mfma_f32_32x32x16_bf16 v[136:151], a[68:71], a[148:151], v[136:151]
  s_add_u32 m0, s37, 32640
  ds_read_b128 a[68:71], v107 offset:11264
  buffer_load_dwordx4 v251, s[8:11], s65 offen offset:128 nt lds
  v_mfma_f32_32x32x16_bf16 v[136:151], a[220:223], a[152:155], v[136:151]
  v_mfma_f32_32x32x16_bf16 v[136:151], a[92:95], a[156:159], v[136:151]
  ds_read_b128 a[92:95], v107 offset:52224
  v_mfma_f32_16x16x32_bf16 v[208:211], a[96:99], a[96:99], 0
  s_add_u32 m0, s37, 33664
  ds_write_b128 v245, v[0:3] offset:6144
  v_mfma_f32_16x16x32_bf16 v[212:215], a[96:99], v[112:115], 0
  v_mfma_f32_16x16x32_bf16 v[216:219], a[168:171], a[96:99], 0
  ds_write_b128 v246, v[4:7] offset:6144
  v_mfma_f32_16x16x32_bf16 v[208:211], a[100:103], a[100:103], v[208:211]
  buffer_load_dwordx4 v252, s[8:11], s65 offen offset:128 nt lds
  v_mfma_f32_16x16x32_bf16 v[212:215], a[100:103], v[116:119], v[212:215]
  ds_write_b128 v245, v[8:11] offset:8192
  v_mfma_f32_16x16x32_bf16 v[216:219], a[168:171], a[100:103], v[216:219]
  v_cvt_pk_bf16_f32 v44, v136, v137
  v_cvt_pk_bf16_f32 v68, v144, v145
  v_mfma_f32_16x16x32_bf16 v[208:211], a[104:107], a[104:107], v[208:211]
  s_add_u32 m0, s37, 34560
  v_cvt_pk_bf16_f32 v45, v138, v139
  v_mfma_f32_16x16x32_bf16 v[212:215], a[104:107], v[120:123], v[212:215]
  v_cvt_pk_bf16_f32 v69, v146, v147
  v_cvt_pk_bf16_f32 v46, v140, v141
  v_mfma_f32_16x16x32_bf16 v[216:219], a[168:171], a[104:107], v[216:219]
  v_cvt_pk_bf16_f32 v70, v148, v149
  v_cvt_pk_bf16_f32 v47, v142, v143
  v_mfma_f32_16x16x32_bf16 v[208:211], a[108:111], a[108:111], v[208:211]
  buffer_load_dwordx4 v251, s[8:11], s65 offen offset:256 nt lds
  v_mfma_f32_16x16x32_bf16 v[212:215], a[108:111], v[124:127], v[212:215]
  v_cvt_pk_bf16_f32 v71, v150, v151
  ds_write_b128 v246, v[12:15] offset:8192
  v_mfma_f32_16x16x32_bf16 v[216:219], a[168:171], a[108:111], v[216:219]
  v_permlane16_swap_b32 v44, v68
  v_mfma_f32_16x16x32_bf16 v[208:211], a[112:115], a[112:115], v[208:211]
  s_add_u32 m0, s37, 35584
  ds_write_b128 v245, v[16:19] offset:10240
  v_mfma_f32_16x16x32_bf16 v[212:215], a[112:115], v[128:131], v[212:215]
  v_permlane16_swap_b32 v45, v69
  v_mfma_f32_16x16x32_bf16 v[216:219], a[168:171], a[112:115], v[216:219]
  v_permlane16_swap_b32 v46, v70
  v_mfma_f32_16x16x32_bf16 v[208:211], a[116:119], a[116:119], v[208:211]
  buffer_load_dwordx4 v252, s[8:11], s65 offen offset:256 nt lds
  v_mfma_f32_16x16x32_bf16 v[212:215], a[116:119], v[132:135], v[212:215]
  s_add_u32 m0, s37, 24192
  ds_write_b128 v246, v[20:23] offset:10240
  v_mfma_f32_16x16x32_bf16 v[216:219], a[168:171], a[116:119], v[216:219]
  v_accvgpr_write_b32 a144, v48
  s_waitcnt lgkmcnt(3)
  v_mfma_f32_16x16x32_bf16 v[152:155], v[112:115], a[0:3], 0
  v_cndmask_b32 v242, v208, v209, s[48:49]
  v_cndmask_b32 v243, v210, v211, s[48:49]
  v_mfma_f32_16x16x32_bf16 v[156:159], v[112:115], a[24:27], 0
  v_cndmask_b32 v242, v242, v243, s[50:51]
  v_cndmask_b32 v243, v212, v213, s[48:49]
  v_mfma_f32_16x16x32_bf16 v[160:163], v[112:115], a[48:51], 0
  v_cndmask_b32 v244, v214, v215, s[48:49]
  v_cndmask_b32 v243, v243, v244, s[50:51]
  v_mfma_f32_16x16x32_bf16 v[164:167], v[112:115], a[72:75], 0
  buffer_load_dwordx4 v251, s[8:11], s65 offen offset:384 nt lds
  v_mfma_f32_16x16x32_bf16 v[152:155], v[116:119], a[4:7], v[152:155]
  s_add_u32 m0, s37, 25216
  v_fma_f32 v243, v243, 2.0, v240
  v_mfma_f32_16x16x32_bf16 v[156:159], v[116:119], a[28:31], v[156:159]
  v_add_f32 v244, v216, v241
  v_add_f32 v242, v242, v243
  v_mfma_f32_16x16x32_bf16 v[160:163], v[116:119], a[52:55], v[160:163]
  v_mul_f32 v244, v244, v244
  v_fma_f32 v242, v244, s89, v242
  v_mfma_f32_16x16x32_bf16 v[164:167], v[116:119], a[76:79], v[164:167]
  v_rsq_f32 v242, v242
  v_mfma_f32_16x16x32_bf16 v[152:155], v[120:123], a[8:11], v[152:155]
  v_cndmask_b32 v242, 0, v242, s[52:53]
  ds_write_b128 v245, v[24:27] offset:12288
  v_mfma_f32_16x16x32_bf16 v[156:159], v[120:123], a[32:35], v[156:159]
  buffer_load_dwordx4 v252, s[8:11], s65 offen offset:384 nt lds
  v_mfma_f32_16x16x32_bf16 v[160:163], v[120:123], a[56:59], v[160:163]
  s_add_u32 m0, s37, 26112
  ds_write_b128 v246, v[28:31] offset:12288
  v_mfma_f32_16x16x32_bf16 v[164:167], v[120:123], a[80:83], v[164:167]
  v_permlane16_swap_b32 v47, v71
  v_mfma_f32_16x16x32_bf16 v[152:155], v[124:127], a[12:15], v[152:155]
  ds_write_b128 v245, v[32:35] offset:14336
  v_accvgpr_write_b32 a145, v49
  v_mfma_f32_16x16x32_bf16 v[156:159], v[124:127], a[36:39], v[156:159]
  v_accvgpr_write_b32 a146, v50
  v_accvgpr_write_b32 a147, v51
  v_mfma_f32_16x16x32_bf16 v[160:163], v[124:127], a[60:63], v[160:163]
  ds_write_b128 v246, v[36:39] offset:14336
  v_accvgpr_write_b32 a148, v52
  v_mfma_f32_16x16x32_bf16 v[164:167], v[124:127], a[84:87], v[164:167]
  buffer_load_dwordx4 v251, s[8:11], s65 offen offset:512 nt lds
  v_mfma_f32_16x16x32_bf16 v[152:155], v[128:131], a[16:19], v[152:155]
  s_add_u32 m0, s37, 27136
  ds_write_b128 v245, v[40:43] offset:16384
  v_mfma_f32_16x16x32_bf16 v[156:159], v[128:131], a[40:43], v[156:159]
  v_accvgpr_write_b32 a149, v53
  v_accvgpr_write_b32 a150, v54
  v_mfma_f32_16x16x32_bf16 v[160:163], v[128:131], a[64:67], v[160:163]
  ds_write_b128 v246, v[44:47] offset:16384
  v_accvgpr_write_b32 a151, v55
  v_mfma_f32_16x16x32_bf16 v[164:167], v[128:131], a[88:91], v[164:167]
  v_accvgpr_write_b32 a152, v56
  v_accvgpr_write_b32 a153, v57
  v_mfma_f32_16x16x32_bf16 v[152:155], v[132:135], a[20:23], v[152:155]
  v_accvgpr_write_b32 a154, v58
  v_accvgpr_write_b32 a155, v59
  v_mfma_f32_16x16x32_bf16 v[156:159], v[132:135], a[44:47], v[156:159]
  buffer_load_dwordx4 v252, s[8:11], s65 offen offset:512 nt lds
  v_mfma_f32_16x16x32_bf16 v[160:163], v[132:135], a[68:71], v[160:163]
  s_add_u32 m0, s37, 28032
  v_accvgpr_write_b32 a156, v60
  v_mfma_f32_16x16x32_bf16 v[164:167], v[132:135], a[92:95], v[164:167]
  v_accvgpr_write_b32 a157, v61
  v_accvgpr_write_b32 a158, v62
  v_mfma_f32_16x16x4_f32 v[220:223], v242, a172, 0
  v_accvgpr_write_b32 a159, v63
  v_accvgpr_write_b32 a164, v68
  v_accvgpr_write_b32 a165, v69
  v_accvgpr_write_b32 a166, v70
  v_accvgpr_write_b32 a167, v71
  s_barrier
  v_mfma_f32_16x16x32_bf16 v[228:231], v[44:47], v[44:47], v[228:231]
  ds_write_b64 v245, v[96:97] offset:36864
  ds_write_b128 v245, v[112:115] offset:0
  v_mfma_f32_16x16x32_bf16 v[232:235], a[168:171], v[44:47], v[232:235]
  v_mfma_f32_16x16x32_bf16 v[236:239], v[68:71], v[68:71], v[236:239]
  buffer_load_dwordx4 v251, s[8:11], s65 offen offset:640 nt lds
  v_mfma_f32_16x16x32_bf16 v[224:227], a[168:171], v[68:71], v[224:227]
  s_add_u32 m0, s37, 29056
  ds_write_b128 v246, v[116:119] offset:0
  v_mfma_f32_16x16x32_bf16 v[136:139], a[96:99], a[0:3], v[152:155]
  v_cndmask_b32 v98, v228, v229, s[48:49]
  v_cndmask_b32 v243, v230, v231, s[48:49]
  v_mfma_f32_16x16x32_bf16 v[140:143], a[96:99], a[24:27], v[156:159]
  v_cndmask_b32 v100, v236, v237, s[48:49]
  v_mov_b32 v99, v232
  v_mfma_f32_16x16x32_bf16 v[136:139], a[100:103], a[4:7], v[136:139]
  v_cndmask_b32 v98, v98, v243, s[50:51]
  v_cndmask_b32 v243, v238, v239, s[48:49]
  v_mfma_f32_16x16x32_bf16 v[140:143], a[100:103], a[28:31], v[140:143]
  v_cndmask_b32 v100, v100, v243, s[50:51]
  v_mov_b32 v101, v224
  v_mfma_f32_16x16x32_bf16 v[136:139], a[104:107], a[8:11], v[136:139]
  buffer_load_dwordx4 v252, s[8:11], s65 offen offset:640 nt lds
  v_mfma_f32_16x16x32_bf16 v[140:143], a[104:107], a[32:35], v[140:143]
  s_add_u32 m0, s37, 18432
  v_add_f32 v98, s90, v98
  v_mfma_f32_16x16x32_bf16 v[136:139], a[108:111], a[12:15], v[136:139]
  v_add_f32 v100, s90, v100
  ds_write_b64 v245, v[98:99] offset:36872
  ds_write_b64 v246, v[100:101] offset:36864
  v_mfma_f32_16x16x32_bf16 v[140:143], a[108:111], a[36:39], v[140:143]
  ds_write_b128 v245, v[120:123] offset:2048
  v_mfma_f32_16x16x32_bf16 v[136:139], a[112:115], a[16:19], v[136:139]
  v_mfma_f32_16x16x32_bf16 v[140:143], a[112:115], a[40:43], v[140:143]
  ds_write_b128 v246, v[124:127] offset:2048
  v_mfma_f32_16x16x32_bf16 v[136:139], a[116:119], a[20:23], v[136:139]
  v_mfma_f32_16x16x32_bf16 v[140:143], a[116:119], a[44:47], v[140:143]
  ds_write_b128 v245, v[128:131] offset:4096
  v_mfma_f32_16x16x32_bf16 v[144:147], a[96:99], a[48:51], v[160:163]
  v_mfma_f32_16x16x32_bf16 v[148:151], a[96:99], a[72:75], v[164:167]
  s_waitcnt vmcnt(12)
  ds_read_b128 a[96:99], v245 offset:18432
  v_mfma_f32_16x16x32_bf16 v[144:147], a[100:103], a[52:55], v[144:147]
  ds_write_b128 v246, v[132:135] offset:4096
  v_mul_f32 v168, v136, v220
  v_mul_f32 v169, v137, v221
  v_mul_f32 v170, v138, v222
  v_mul_f32 v171, v139, v223
  v_max3_f32 v236, v168, v169, v170
  v_max_f32 v236, v236, v171
  v_mov_b32 v232, v236
  v_mul_f32 v172, v140, v220
  v_mul_f32 v173, v141, v221
  v_mul_f32 v174, v142, v222
  v_mul_f32 v175, v143, v223
  v_max3_f32 v237, v172, v173, v174
  v_max_f32 v237, v237, v175
  v_permlane32_swap_b32 v236, v232
  v_mov_b32 v233, v237
  v_max_f32 v236, v236, v232
  v_mov_b32 v232, v236
  v_mfma_f32_16x16x32_bf16 v[148:151], a[100:103], a[76:79], v[148:151]
  v_permlane32_swap_b32 v237, v233
  v_permlane16_swap_b32 v236, v232
  v_max_f32 v237, v237, v233
  v_mov_b32 v233, v237
  ds_read_b128 a[100:103], v246 offset:18432
  v_mfma_f32_16x16x32_bf16 v[144:147], a[104:107], a[56:59], v[144:147]
  v_max_f32 v236, v236, v232
  v_sub_f32 v168, v168, v236
  v_sub_f32 v169, v169, v236
  v_sub_f32 v170, v170, v236
  v_sub_f32 v171, v171, v236
  v_permlane16_swap_b32 v237, v233
  v_exp_f32 v168, v168
  v_exp_f32 v169, v169
  v_exp_f32 v170, v170
  v_exp_f32 v171, v171
  v_mfma_f32_16x16x32_bf16 v[148:151], a[104:107], a[80:83], v[148:151]
  v_max_f32 v237, v237, v233
  v_sub_f32 v172, v172, v237
  v_sub_f32 v173, v173, v237
  v_sub_f32 v174, v174, v237
  v_sub_f32 v175, v175, v237
  v_exp_f32 v172, v172
  v_exp_f32 v173, v173
  v_exp_f32 v174, v174
  v_exp_f32 v175, v175
  ds_read_b128 a[104:107], v245 offset:20480
  v_mfma_f32_16x16x32_bf16 v[144:147], a[108:111], a[60:63], v[144:147]
  v_mul_f32 v192, v168, v220
  v_mul_f32 v193, v169, v221
  v_mfma_f32_16x16x32_bf16 v[148:151], a[108:111], a[84:87], v[148:151]
  v_mul_f32 v196, v172, v220
  v_mul_f32 v197, v173, v221
  v_mfma_f32_16x16x32_bf16 v[144:147], a[112:115], a[64:67], v[144:147]
  v_mul_f32 v194, v170, v222
  v_mul_f32 v195, v171, v223
  v_mfma_f32_16x16x32_bf16 v[148:151], a[112:115], a[88:91], v[148:151]
  v_mul_f32 v198, v174, v222
  v_mul_f32 v199, v175, v223
  v_mfma_f32_16x16x32_bf16 v[144:147], a[116:119], a[68:71], v[144:147]
  ds_read_b128 a[108:111], v246 offset:20480
  v_cvt_pk_bf16_f32 v184, v192, v193
  v_mfma_f32_16x16x32_bf16 v[148:151], a[116:119], a[92:95], v[148:151]
  v_cvt_pk_bf16_f32 v186, v196, v197
  s_waitcnt lgkmcnt(2)
  v_mfma_f32_16x16x32_bf16 v[208:211], a[96:99], a[96:99], 0
  v_cvt_pk_bf16_f32 v185, v194, v195
  v_cvt_pk_bf16_f32 v187, v198, v199
  v_mul_f32 v176, v144, v220
  v_mul_f32 v177, v145, v221
  v_mul_f32 v178, v146, v222
  v_mul_f32 v179, v147, v223
  v_max3_f32 v238, v176, v177, v178
  v_mfma_f32_16x16x32_bf16 v[212:215], a[96:99], v[112:115], 0
  v_max_f32 v238, v238, v179
  v_mov_b32 v234, v238
  v_mul_f32 v180, v148, v220
  v_mul_f32 v181, v149, v221
  v_mul_f32 v182, v150, v222
  v_mul_f32 v183, v151, v223
  ds_read_b128 a[112:115], v245 offset:22528
  v_max3_f32 v239, v180, v181, v182
  ds_read_b128 a[116:119], v246 offset:22528
  v_mfma_f32_16x16x32_bf16 v[216:219], a[168:171], a[96:99], 0
  v_max_f32 v239, v239, v183
  v_permlane32_swap_b32 v238, v234
  v_mov_b32 v235, v239
  v_permlane16_swap_b32 v184, v186
  v_max_f32 v238, v238, v234
  v_mov_b32 v234, v238
  v_mfma_f32_16x16x32_bf16 v[208:211], a[100:103], a[100:103], v[208:211]
  v_permlane32_swap_b32 v239, v235
  v_permlane16_swap_b32 v185, v187
  v_max_f32 v239, v239, v235
  v_mfma_f32_16x16x32_bf16 v[212:215], a[100:103], v[116:119], v[212:215]
  v_mov_b32 v235, v239
  v_sub_f32 v228, 0, v236
  v_mfma_f32_16x16x32_bf16 v[216:219], a[168:171], a[100:103], v[216:219]
  v_sub_f32 v229, 0, v237
  s_waitcnt lgkmcnt(2)
  v_mfma_f32_16x16x32_bf16 v[208:211], a[104:107], a[104:107], v[208:211]
  v_permlane16_swap_b32 v238, v234
  v_mfma_f32_16x16x32_bf16 v[212:215], a[104:107], v[120:123], v[212:215]
  v_permlane16_swap_b32 v239, v235
  v_mfma_f32_16x16x32_bf16 v[216:219], a[168:171], a[104:107], v[216:219]
  v_max_f32 v238, v238, v234
  v_max_f32 v239, v239, v235
  v_mfma_f32_16x16x32_bf16 v[208:211], a[108:111], a[108:111], v[208:211]
  v_sub_f32 v176, v176, v238
  v_sub_f32 v177, v177, v238
  v_mfma_f32_16x16x32_bf16 v[212:215], a[108:111], v[124:127], v[212:215]
  v_sub_f32 v180, v180, v239
  v_sub_f32 v181, v181, v239
  v_mfma_f32_16x16x32_bf16 v[216:219], a[168:171], a[108:111], v[216:219]
  v_sub_f32 v178, v178, v238
  s_waitcnt lgkmcnt(0)
  v_mfma_f32_16x16x32_bf16 v[208:211], a[112:115], a[112:115], v[208:211]
  v_sub_f32 v179, v179, v238
  v_sub_f32 v182, v182, v239
  v_mfma_f32_16x16x32_bf16 v[212:215], a[112:115], v[128:131], v[212:215]
  v_sub_f32 v183, v183, v239
  v_add_f32 v236, v168, v169
  v_mfma_f32_16x16x32_bf16 v[216:219], a[168:171], a[112:115], v[216:219]
  v_exp_f32 v176, v176
  v_mfma_f32_16x16x32_bf16 v[208:211], a[116:119], a[116:119], v[208:211]
  v_exp_f32 v177, v177
  v_mfma_f32_16x16x32_bf16 v[212:215], a[116:119], v[132:135], v[212:215]
  v_exp_f32 v180, v180
  v_mfma_f32_16x16x32_bf16 v[216:219], a[168:171], a[116:119], v[216:219]
  v_exp_f32 v181, v181
  v_mfma_f32_32x32x16_bf16 v[0:15], a[120:123], v[184:187], 0
  v_exp_f32 v178, v178
  v_exp_f32 v179, v179
  v_cndmask_b32 v242, v208, v209, s[48:49]
  v_cndmask_b32 v243, v210, v211, s[48:49]
  v_cndmask_b32 v242, v242, v243, s[50:51]
  v_cndmask_b32 v243, v212, v213, s[48:49]
  v_cndmask_b32 v244, v214, v215, s[48:49]
  v_cndmask_b32 v243, v243, v244, s[50:51]
  v_fma_f32 v243, v243, 2.0, v240
  v_add_f32 v242, v242, v243
  v_add_f32 v244, v216, v241
  v_mul_f32 v244, v244, v244
  v_mfma_f32_32x32x16_bf16 v[16:31], a[124:127], v[184:187], 0
  v_fma_f32 v242, v244, s89, v242
  v_rsq_f32 v242, v242
  v_exp_f32 v182, v182
  v_cndmask_b32 v242, 0, v242, s[52:53]
  v_mfma_f32_32x32x16_bf16 v[32:47], a[128:131], v[184:187], 0
  v_exp_f32 v183, v183
  v_mul_f32 v200, v176, v220
  v_mul_f32 v201, v177, v221
  v_mul_f32 v204, v180, v220
  v_mul_f32 v205, v181, v221
  v_mfma_f32_32x32x16_bf16 v[48:63], a[132:135], v[184:187], 0
  v_mul_f32 v202, v178, v222
  v_mul_f32 v203, v179, v223
  v_mul_f32 v206, v182, v222
  v_mul_f32 v207, v183, v223
  v_cvt_pk_bf16_f32 v188, v200, v201
  v_cvt_pk_bf16_f32 v190, v204, v205
  v_mfma_f32_32x32x16_bf16 v[64:79], a[136:139], v[184:187], 0
  v_cvt_pk_bf16_f32 v189, v202, v203
  v_cvt_pk_bf16_f32 v191, v206, v207
  v_permlane16_swap_b32 v188, v190
  v_add_f32 v237, v172, v173
  v_add_f32 v236, v236, v170
  v_mfma_f32_32x32x16_bf16 v[80:95], a[140:143], v[184:187], 0
  v_permlane16_swap_b32 v189, v191
  v_add_f32 v237, v237, v174
  v_add_f32 v232, v236, v171
  v_add_f32 v233, v237, v175
  v_sub_f32 v230, 0, v238
  v_mfma_f32_16x16x4_f32 v[224:227], v242, a172, 0
  v_sub_f32 v231, 0, v239
  v_add_f32 v238, v176, v177
  v_add_f32 v239, v180, v181
  v_add_f32 v238, v238, v178
  v_add_f32 v239, v239, v182
  v_add_f32 v234, v238, v179
  v_mfma_f32_16x16x32_bf16 v[136:139], a[96:99], a[0:3], v[152:155]
  v_add_f32 v235, v239, v183
  v_mfma_f32_16x16x32_bf16 v[140:143], a[96:99], a[24:27], v[156:159]
  v_mfma_f32_16x16x32_bf16 v[136:139], a[100:103], a[4:7], v[136:139]
  v_mfma_f32_16x16x32_bf16 v[140:143], a[100:103], a[28:31], v[140:143]
  v_mfma_f32_16x16x32_bf16 v[136:139], a[104:107], a[8:11], v[136:139]
  v_mfma_f32_16x16x32_bf16 v[140:143], a[104:107], a[32:35], v[140:143]
  v_mfma_f32_16x16x32_bf16 v[136:139], a[108:111], a[12:15], v[136:139]
  v_mfma_f32_16x16x32_bf16 v[140:143], a[108:111], a[36:39], v[140:143]
  v_mfma_f32_16x16x32_bf16 v[136:139], a[112:115], a[16:19], v[136:139]
  v_mfma_f32_16x16x32_bf16 v[140:143], a[112:115], a[40:43], v[140:143]
  v_mfma_f32_16x16x32_bf16 v[136:139], a[116:119], a[20:23], v[136:139]
  v_mfma_f32_16x16x32_bf16 v[140:143], a[116:119], a[44:47], v[140:143]
  v_mfma_f32_32x32x16_bf16 v[96:111], a[120:123], v[188:191], 0
  ds_read_b64_tr_b16 a[120:121], v247 offset:18432
  ds_read_b64_tr_b16 a[122:123], v249 offset:18944
  v_mfma_f32_32x32x16_bf16 a[176:191], a[124:127], v[188:191], 0
  ds_read_b64_tr_b16 a[124:125], v248 offset:18432
  ds_read_b64_tr_b16 a[126:127], v250 offset:18944
  v_mfma_f32_32x32x16_bf16 a[192:207], a[128:131], v[188:191], 0
  v_fma_f32 v168, v136, v224, v228
  v_fma_f32 v169, v137, v225, v228
  ds_read_b64_tr_b16 a[128:129], v247 offset:20480
  ds_read_b64_tr_b16 a[130:131], v249 offset:20992
  v_fma_f32 v172, v140, v224, v229
  v_fma_f32 v173, v141, v225, v229
  v_mfma_f32_32x32x16_bf16 a[208:223], a[132:135], v[188:191], 0
  ds_read_b64_tr_b16 a[132:133], v248 offset:20480
  ds_read_b64_tr_b16 a[134:135], v250 offset:20992
  v_fma_f32 v170, v138, v226, v228
  v_exp_f32 v168, v168
  v_fma_f32 v174, v142, v226, v229
  v_mfma_f32_32x32x16_bf16 a[224:239], a[136:139], v[188:191], 0
  ds_read_b64_tr_b16 a[136:137], v247 offset:22528
  ds_read_b64_tr_b16 a[138:139], v249 offset:23040
  v_exp_f32 v169, v169
  v_exp_f32 v172, v172
  v_mfma_f32_32x32x16_bf16 a[240:255], a[140:143], v[188:191], 0
  ds_read_b64_tr_b16 a[140:141], v248 offset:22528
  ds_read_b64_tr_b16 a[142:143], v250 offset:23040
  v_exp_f32 v173, v173
  v_exp_f32 v170, v170
  v_mfma_f32_16x16x32_bf16 v[144:147], a[96:99], a[48:51], v[160:163]
  v_fma_f32 v171, v139, v227, v228
  v_add_f32 v236, v168, v169
  v_mfma_f32_16x16x32_bf16 v[148:151], a[96:99], a[72:75], v[164:167]
  s_waitcnt vmcnt(6)
  ds_read_b128 a[96:99], v245 offset:30720
  v_mfma_f32_16x16x32_bf16 v[144:147], a[100:103], a[52:55], v[144:147]
  v_fma_f32 v175, v143, v227, v229
  v_add_f32 v237, v172, v173
  v_mfma_f32_16x16x32_bf16 v[148:151], a[100:103], a[76:79], v[148:151]
  ds_read_b128 a[100:103], v246 offset:30720
  v_add_f32 v236, v236, v170
  v_mfma_f32_16x16x32_bf16 v[144:147], a[104:107], a[56:59], v[144:147]
  v_exp_f32 v174, v174
  v_mfma_f32_16x16x32_bf16 v[148:151], a[104:107], a[80:83], v[148:151]
  ds_read_b128 a[104:107], v245 offset:32768
  v_add_f32 v237, v237, v174
  v_mfma_f32_16x16x32_bf16 v[144:147], a[108:111], a[60:63], v[144:147]
  v_exp_f32 v171, v171
  v_mfma_f32_16x16x32_bf16 v[148:151], a[108:111], a[84:87], v[148:151]
  s_waitcnt lgkmcnt(3)
  buffer_load_dwordx4 v251, s[8:11], s66 offen nt lds
  v_mfma_f32_16x16x32_bf16 v[144:147], a[112:115], a[64:67], v[144:147]
  ds_read_b128 a[108:111], v246 offset:32768
  s_add_u32 m0, s37, 19456
  v_mfma_f32_16x16x32_bf16 v[148:151], a[112:115], a[88:91], v[148:151]
  v_exp_f32 v175, v175
  v_mfma_f32_16x16x32_bf16 v[144:147], a[116:119], a[68:71], v[144:147]
  v_add_f32 v236, v236, v171
  v_add_f32 v237, v237, v175
  v_mfma_f32_16x16x32_bf16 v[148:151], a[116:119], a[92:95], v[148:151]
  v_max_f32 v253, v236, v237
  s_waitcnt lgkmcnt(2)
  v_mfma_f32_16x16x32_bf16 v[208:211], a[96:99], a[96:99], 0
  v_cmp_lt_f32 vcc, s88, v253
  ds_read_b128 a[112:115], v245 offset:34816
  v_mfma_f32_16x16x32_bf16 v[212:215], a[96:99], v[112:115], 0
  buffer_load_dwordx4 v252, s[8:11], s66 offen nt lds
  v_mfma_f32_16x16x32_bf16 v[216:219], a[168:171], a[96:99], 0
  s_add_u32 m0, s37, 20352
  ds_read_b128 a[116:119], v246 offset:34816
  v_mfma_f32_16x16x32_bf16 v[208:211], a[100:103], a[100:103], v[208:211]
  s_cbranch_vccnz L_tr_1_0
L_ret_1_0:
  v_mfma_f32_16x16x32_bf16 v[212:215], a[100:103], v[116:119], v[212:215]
  v_mul_f32 v168, v168, v224
  v_mul_f32 v169, v169, v225
  v_mfma_f32_16x16x32_bf16 v[216:219], a[168:171], a[100:103], v[216:219]
  v_mul_f32 v172, v172, v224
  s_waitcnt lgkmcnt(2)
  v_mfma_f32_16x16x32_bf16 v[208:211], a[104:107], a[104:107], v[208:211]
  v_mul_f32 v173, v173, v225
  v_mul_f32 v170, v170, v226
  v_mfma_f32_16x16x32_bf16 v[212:215], a[104:107], v[120:123], v[212:215]
  buffer_load_dwordx4 v251, s[8:11], s66 offen offset:128 nt lds
  v_mfma_f32_16x16x32_bf16 v[216:219], a[168:171], a[104:107], v[216:219]
  v_mul_f32 v171, v171, v227
  s_add_u32 m0, s37, 21376
  v_mfma_f32_16x16x32_bf16 v[208:211], a[108:111], a[108:111], v[208:211]
  v_mul_f32 v174, v174, v226
  v_mul_f32 v175, v175, v227
  v_mfma_f32_16x16x32_bf16 v[212:215], a[108:111], v[124:127], v[212:215]
  v_cvt_pk_bf16_f32 v184, v168, v169
  v_cvt_pk_bf16_f32 v186, v172, v173
  v_mfma_f32_16x16x32_bf16 v[216:219], a[168:171], a[108:111], v[216:219]
  v_cvt_pk_bf16_f32 v185, v170, v171
  s_waitcnt lgkmcnt(0)
  v_mfma_f32_16x16x32_bf16 v[208:211], a[112:115], a[112:115], v[208:211]
  v_cvt_pk_bf16_f32 v187, v174, v175
  v_fma_f32 v176, v144, v224, v230
  v_mfma_f32_16x16x32_bf16 v[212:215], a[112:115], v[128:131], v[212:215]
  v_permlane16_swap_b32 v184, v186
  buffer_load_dwordx4 v252, s[8:11], s66 offen offset:128 nt lds
  v_mfma_f32_16x16x32_bf16 v[216:219], a[168:171], a[112:115], v[216:219]
  v_permlane16_swap_b32 v185, v187
  v_mfma_f32_16x16x32_bf16 v[208:211], a[116:119], a[116:119], v[208:211]
  s_add_u32 m0, s37, 22272
  v_fma_f32 v177, v145, v225, v230
  v_mfma_f32_16x16x32_bf16 v[212:215], a[116:119], v[132:135], v[212:215]
  v_fma_f32 v180, v148, v224, v231
  v_fma_f32 v181, v149, v225, v231
  v_mfma_f32_16x16x32_bf16 v[216:219], a[168:171], a[116:119], v[216:219]
  v_fma_f32 v178, v146, v226, v230
  v_fma_f32 v182, v150, v226, v231
  v_cndmask_b32 v242, v208, v209, s[48:49]
  v_cndmask_b32 v243, v210, v211, s[48:49]
  v_cndmask_b32 v242, v242, v243, s[50:51]
  v_mfma_f32_32x32x16_bf16 v[0:15], a[120:123], v[184:187], v[0:15]
  v_cndmask_b32 v243, v212, v213, s[48:49]
  v_cndmask_b32 v244, v214, v215, s[48:49]
  v_cndmask_b32 v243, v243, v244, s[50:51]
  v_fma_f32 v243, v243, 2.0, v240
  v_add_f32 v242, v242, v243
  v_add_f32 v244, v216, v241
  v_mul_f32 v244, v244, v244
  buffer_load_dwordx4 v251, s[8:11], s66 offen offset:256 nt lds
  v_mfma_f32_32x32x16_bf16 v[16:31], a[124:127], v[184:187], v[16:31]
  v_fma_f32 v242, v244, s89, v242
  s_add_u32 m0, s37, 23296
  v_rsq_f32 v242, v242
  v_exp_f32 v176, v176
  v_mfma_f32_32x32x16_bf16 v[32:47], a[128:131], v[184:187], v[32:47]
  v_exp_f32 v177, v177
  v_fma_f32 v179, v147, v227, v230
  v_exp_f32 v180, v180
  v_fma_f32 v183, v151, v227, v231
  v_mfma_f32_32x32x16_bf16 v[48:63], a[132:135], v[184:187], v[48:63]
  v_exp_f32 v181, v181
  v_exp_f32 v178, v178
  v_exp_f32 v182, v182
  buffer_load_dwordx4 v252, s[8:11], s66 offen offset:256 nt lds
  v_mfma_f32_32x32x16_bf16 v[64:79], a[136:139], v[184:187], v[64:79]
  v_exp_f32 v179, v179
  v_cndmask_b32 v242, 0, v242, s[52:53]
  v_add_f32 v238, v176, v177
  v_add_f32 v239, v180, v181
  s_add_u32 m0, s37, 30336
  v_mfma_f32_32x32x16_bf16 v[80:95], a[140:143], v[184:187], v[80:95]
  v_exp_f32 v183, v183
  v_add_f32 v238, v238, v178
  v_add_f32 v239, v239, v182
  v_add_f32 v238, v238, v179
  v_add_f32 v239, v239, v183
  v_mfma_f32_16x16x4_f32 v[220:223], v242, a172, 0
  v_max_f32 v254, v238, v239
  v_cmp_lt_f32 vcc, s88, v254
  v_add_f32 v192, v192, v168
  v_add_f32 v193, v193, v169
  v_add_f32 v196, v196, v172
  v_add_f32 v197, v197, v173
  v_mfma_f32_16x16x32_bf16 v[136:139], a[96:99], a[0:3], v[152:155]
  s_cbranch_vccnz L_tr_1_1
L_ret_1_1:
  v_mfma_f32_16x16x32_bf16 v[140:143], a[96:99], a[24:27], v[156:159]
  v_mul_f32 v176, v176, v224
  v_mul_f32 v177, v177, v225
  v_mfma_f32_16x16x32_bf16 v[136:139], a[100:103], a[4:7], v[136:139]
  v_mul_f32 v180, v180, v224
  v_mul_f32 v181, v181, v225
  v_mfma_f32_16x16x32_bf16 v[140:143], a[100:103], a[28:31], v[140:143]
  v_mul_f32 v178, v178, v226
  v_mul_f32 v179, v179, v227
  v_mfma_f32_16x16x32_bf16 v[136:139], a[104:107], a[8:11], v[136:139]
  v_mul_f32 v182, v182, v226
  v_mul_f32 v183, v183, v227
  v_mfma_f32_16x16x32_bf16 v[140:143], a[104:107], a[32:35], v[140:143]
  v_cvt_pk_bf16_f32 v188, v176, v177
  v_cvt_pk_bf16_f32 v190, v180, v181
  v_mfma_f32_16x16x32_bf16 v[136:139], a[108:111], a[12:15], v[136:139]
  v_cvt_pk_bf16_f32 v189, v178, v179
  v_cvt_pk_bf16_f32 v191, v182, v183
  v_mfma_f32_16x16x32_bf16 v[140:143], a[108:111], a[36:39], v[140:143]
  v_permlane16_swap_b32 v188, v190
  v_mfma_f32_16x16x32_bf16 v[136:139], a[112:115], a[16:19], v[136:139]
  v_permlane16_swap_b32 v189, v191
  v_mfma_f32_16x16x32_bf16 v[140:143], a[112:115], a[40:43], v[140:143]
  v_add_f32 v194, v194, v170
  v_add_f32 v198, v198, v174
  v_mfma_f32_16x16x32_bf16 v[136:139], a[116:119], a[20:23], v[136:139]
  v_add_f32 v195, v195, v171
  v_add_f32 v232, v232, v236
  v_mfma_f32_16x16x32_bf16 v[140:143], a[116:119], a[44:47], v[140:143]
  v_add_f32 v199, v199, v175
  v_add_f32 v233, v233, v237
  v_mfma_f32_32x32x16_bf16 v[96:111], a[120:123], v[188:191], v[96:111]
  ds_read_b64_tr_b16 a[120:121], v247 offset:30720
  ds_read_b64_tr_b16 a[122:123], v249 offset:31232
  v_fma_f32 v168, v136, v220, v228
  v_fma_f32 v169, v137, v221, v228
  v_fma_f32 v170, v138, v222, v228
  v_fma_f32 v172, v140, v220, v229
  v_mfma_f32_32x32x16_bf16 a[176:191], a[124:127], v[188:191], a[176:191]
  v_fma_f32 v173, v141, v221, v229
  v_exp_f32 v168, v168
  v_exp_f32 v169, v169
  v_fma_f32 v174, v142, v222, v229
  v_mfma_f32_32x32x16_bf16 a[192:207], a[128:131], v[188:191], a[192:207]
  v_exp_f32 v172, v172
  v_exp_f32 v173, v173
  v_exp_f32 v170, v170
  v_mfma_f32_32x32x16_bf16 a[208:223], a[132:135], v[188:191], a[208:223]
  v_fma_f32 v171, v139, v223, v228
  v_add_f32 v236, v168, v169
  v_exp_f32 v174, v174
  v_fma_f32 v175, v143, v223, v229
  v_add_f32 v237, v172, v173
  v_mfma_f32_32x32x16_bf16 a[224:239], a[136:139], v[188:191], a[224:239]
  v_exp_f32 v171, v171
  v_add_f32 v236, v236, v170
  v_exp_f32 v175, v175
  v_add_f32 v237, v237, v174
  v_mfma_f32_32x32x16_bf16 a[240:255], a[140:143], v[188:191], a[240:255]
  v_add_f32 v236, v236, v171
  v_add_f32 v237, v237, v175
  ds_read_b64_tr_b16 a[124:125], v248 offset:30720
  ds_read_b64_tr_b16 a[126:127], v250 offset:31232
  ds_read_b64_tr_b16 a[128:129], v247 offset:32768
  ds_read_b64_tr_b16 a[130:131], v249 offset:33280
  v_mfma_f32_16x16x32_bf16 v[144:147], a[96:99], a[48:51], v[160:163]
  ds_read_b64_tr_b16 a[132:133], v248 offset:32768
  ds_read_b64_tr_b16 a[134:135], v250 offset:33280
  v_mfma_f32_16x16x32_bf16 v[148:151], a[96:99], a[72:75], v[164:167]
  s_waitcnt vmcnt(6)
  ds_read_b128 a[96:99], v245 offset:24576
  v_mfma_f32_16x16x32_bf16 v[144:147], a[100:103], a[52:55], v[144:147]
  ds_read_b64_tr_b16 a[136:137], v247 offset:34816
  ds_read_b64_tr_b16 a[138:139], v249 offset:35328
  v_mfma_f32_16x16x32_bf16 v[148:151], a[100:103], a[76:79], v[148:151]
  ds_read_b128 a[100:103], v246 offset:24576
  ds_read_b64_tr_b16 a[140:141], v248 offset:34816
  v_mfma_f32_16x16x32_bf16 v[144:147], a[104:107], a[56:59], v[144:147]
  ds_read_b64_tr_b16 a[142:143], v250 offset:35328
  v_max_f32 v253, v236, v237
  v_mfma_f32_16x16x32_bf16 v[148:151], a[104:107], a[80:83], v[148:151]
  ds_read_b128 a[104:107], v245 offset:26624
  v_cmp_lt_f32 vcc, s88, v253
  v_mfma_f32_16x16x32_bf16 v[144:147], a[108:111], a[60:63], v[144:147]
  v_add_f32 v200, v200, v176
  v_add_f32 v201, v201, v177
  v_mfma_f32_16x16x32_bf16 v[148:151], a[108:111], a[84:87], v[148:151]
  ds_read_b128 a[108:111], v246 offset:26624
  v_add_f32 v204, v204, v180
  v_mfma_f32_16x16x32_bf16 v[144:147], a[112:115], a[64:67], v[144:147]
  s_cbranch_vccnz L_tr_2_0
L_ret_2_0:
  v_mfma_f32_16x16x32_bf16 v[148:151], a[112:115], a[88:91], v[148:151]
  ds_read_b128 a[112:115], v245 offset:28672
  v_mul_f32 v168, v168, v220
  v_mfma_f32_16x16x32_bf16 v[144:147], a[116:119], a[68:71], v[144:147]
  v_mul_f32 v169, v169, v221
  v_mul_f32 v172, v172, v220
  v_mfma_f32_16x16x32_bf16 v[148:151], a[116:119], a[92:95], v[148:151]
  ds_read_b128 a[116:119], v246 offset:28672
  s_waitcnt lgkmcnt(7)
  v_mfma_f32_16x16x32_bf16 v[208:211], a[96:99], a[96:99], 0
  v_mul_f32 v173, v173, v221
  v_mul_f32 v170, v170, v222
  v_mfma_f32_16x16x32_bf16 v[212:215], a[96:99], v[112:115], 0
  v_mul_f32 v171, v171, v223
  v_mul_f32 v174, v174, v222
  v_mfma_f32_16x16x32_bf16 v[216:219], a[168:171], a[96:99], 0
  v_mul_f32 v175, v175, v223
  s_waitcnt lgkmcnt(4)
  buffer_load_dwordx4 v251, s[8:11], s66 offen offset:384 nt lds
  v_mfma_f32_16x16x32_bf16 v[208:211], a[100:103], a[100:103], v[208:211]
  s_add_u32 m0, s37, 31360
  v_cvt_pk_bf16_f32 v184, v168, v169
  v_mfma_f32_16x16x32_bf16 v[212:215], a[100:103], v[116:119], v[212:215]
  v_cvt_pk_bf16_f32 v186, v172, v173
  v_cvt_pk_bf16_f32 v185, v170, v171
  v_mfma_f32_16x16x32_bf16 v[216:219], a[168:171], a[100:103], v[216:219]
  v_cvt_pk_bf16_f32 v187, v174, v175
  s_waitcnt lgkmcnt(1)
  v_mfma_f32_16x16x32_bf16 v[208:211], a[104:107], a[104:107], v[208:211]
  v_permlane16_swap_b32 v184, v186
  v_mfma_f32_16x16x32_bf16 v[212:215], a[104:107], v[120:123], v[212:215]
  v_permlane16_swap_b32 v185, v187
  v_mfma_f32_16x16x32_bf16 v[216:219], a[168:171], a[104:107], v[216:219]
  buffer_load_dwordx4 v252, s[8:11], s66 offen offset:384 nt lds
  v_mfma_f32_16x16x32_bf16 v[208:211], a[108:111], a[108:111], v[208:211]
  s_add_u32 m0, s37, 32256
  v_add_f32 v205, v205, v181
  v_mfma_f32_16x16x32_bf16 v[212:215], a[108:111], v[124:127], v[212:215]
  v_add_f32 v202, v202, v178
  v_add_f32 v206, v206, v182
  v_mfma_f32_16x16x32_bf16 v[216:219], a[168:171], a[108:111], v[216:219]
  v_fma_f32 v176, v144, v220, v230
  v_fma_f32 v177, v145, v221, v230
  v_mfma_f32_16x16x32_bf16 v[208:211], a[112:115], a[112:115], v[208:211]
  v_fma_f32 v180, v148, v220, v231
  v_add_f32 v203, v203, v179
  v_mfma_f32_16x16x32_bf16 v[212:215], a[112:115], v[128:131], v[212:215]
  v_fma_f32 v181, v149, v221, v231
  v_add_f32 v207, v207, v183
  v_mfma_f32_16x16x32_bf16 v[216:219], a[168:171], a[112:115], v[216:219]
  buffer_load_dwordx4 v251, s[8:11], s66 offen offset:512 nt lds
  s_waitcnt lgkmcnt(0)
  v_mfma_f32_16x16x32_bf16 v[208:211], a[116:119], a[116:119], v[208:211]
  s_add_u32 m0, s37, 33280
  v_fma_f32 v178, v146, v222, v230
  v_mfma_f32_16x16x32_bf16 v[212:215], a[116:119], v[132:135], v[212:215]
  v_fma_f32 v182, v150, v222, v231
  v_fma_f32 v179, v147, v223, v230
  v_mfma_f32_16x16x32_bf16 v[216:219], a[168:171], a[116:119], v[216:219]
  v_exp_f32 v176, v176
  v_mfma_f32_32x32x16_bf16 v[0:15], a[120:123], v[184:187], v[0:15]
  v_cndmask_b32 v242, v208, v209, s[48:49]
  v_cndmask_b32 v243, v210, v211, s[48:49]
  v_cndmask_b32 v242, v242, v243, s[50:51]
  v_cndmask_b32 v243, v212, v213, s[48:49]
  v_cndmask_b32 v244, v214, v215, s[48:49]
  v_cndmask_b32 v243, v243, v244, s[50:51]
  v_fma_f32 v243, v243, 2.0, v240
  v_add_f32 v242, v242, v243
  v_add_f32 v244, v216, v241
  v_mul_f32 v244, v244, v244
  buffer_load_dwordx4 v252, s[8:11], s66 offen offset:512 nt lds
  v_mfma_f32_32x32x16_bf16 v[16:31], a[124:127], v[184:187], v[16:31]
  v_fma_f32 v242, v244, s89, v242
  v_rsq_f32 v242, v242
  s_add_u32 m0, s37, 34176
  v_exp_f32 v177, v177
  v_mfma_f32_32x32x16_bf16 v[32:47], a[128:131], v[184:187], v[32:47]
  v_exp_f32 v180, v180
  buffer_load_dwordx4 v251, s[8:11], s66 offen offset:640 nt lds
  v_add_f32 v234, v234, v238
  v_mfma_f32_32x32x16_bf16 v[48:63], a[132:135], v[184:187], v[48:63]
  v_exp_f32 v181, v181
  v_add_f32 v235, v235, v239
  v_fma_f32 v183, v151, v223, v231
  v_exp_f32 v178, v178
  v_mfma_f32_32x32x16_bf16 v[64:79], a[136:139], v[184:187], v[64:79]
  v_exp_f32 v182, v182
  v_exp_f32 v179, v179
  v_cndmask_b32 v242, 0, v242, s[52:53]
  v_add_f32 v238, v176, v177
  v_mfma_f32_32x32x16_bf16 v[80:95], a[140:143], v[184:187], v[80:95]
  v_add_f32 v239, v180, v181
  v_exp_f32 v183, v183
  v_add_f32 v238, v238, v178
  v_add_f32 v239, v239, v182
  v_add_f32 v238, v238, v179
  v_mfma_f32_16x16x4_f32 v[224:227], v242, a172, 0
  s_add_u32 m0, s37, 35200
  v_add_f32 v239, v239, v183
  buffer_load_dwordx4 v252, s[8:11], s66 offen offset:640 nt lds
  v_max_f32 v254, v238, v239
  v_mfma_f32_16x16x32_bf16 v[136:139], a[96:99], a[0:3], v[152:155]
  v_cmp_lt_f32 vcc, s88, v254
  s_add_u32 m0, s37, 24576
  v_mfma_f32_16x16x32_bf16 v[140:143], a[96:99], a[24:27], v[156:159]
  s_cbranch_vccnz L_tr_2_1
L_ret_2_1:
  v_mfma_f32_16x16x32_bf16 v[136:139], a[100:103], a[4:7], v[136:139]
  v_mul_f32 v176, v176, v220
  v_mul_f32 v177, v177, v221
  v_mfma_f32_16x16x32_bf16 v[140:143], a[100:103], a[28:31], v[140:143]
  v_mul_f32 v180, v180, v220
  v_mul_f32 v181, v181, v221
  v_mfma_f32_16x16x32_bf16 v[136:139], a[104:107], a[8:11], v[136:139]
  v_mul_f32 v178, v178, v222
  v_mul_f32 v179, v179, v223
  v_mfma_f32_16x16x32_bf16 v[140:143], a[104:107], a[32:35], v[140:143]
  v_mul_f32 v182, v182, v222
  v_mul_f32 v183, v183, v223
  v_mfma_f32_16x16x32_bf16 v[136:139], a[108:111], a[12:15], v[136:139]
  v_cvt_pk_bf16_f32 v188, v176, v177
  v_cvt_pk_bf16_f32 v190, v180, v181
  v_mfma_f32_16x16x32_bf16 v[140:143], a[108:111], a[36:39], v[140:143]
  v_cvt_pk_bf16_f32 v189, v178, v179
  v_cvt_pk_bf16_f32 v191, v182, v183
  v_mfma_f32_16x16x32_bf16 v[136:139], a[112:115], a[16:19], v[136:139]
  v_permlane16_swap_b32 v188, v190
  v_mfma_f32_16x16x32_bf16 v[140:143], a[112:115], a[40:43], v[140:143]
  v_permlane16_swap_b32 v189, v191
  v_mfma_f32_16x16x32_bf16 v[136:139], a[116:119], a[20:23], v[136:139]
  ds_read_b128 v[112:115], v245 offset:6144
  ds_read_b128 v[116:119], v246 offset:6144
  v_mfma_f32_16x16x32_bf16 v[140:143], a[116:119], a[44:47], v[140:143]
  v_add_f32 v192, v192, v168
  v_add_f32 v193, v193, v169
  v_mfma_f32_32x32x16_bf16 v[96:111], a[120:123], v[188:191], v[96:111]
  ds_read_b128 v[120:123], v245 offset:8192
  v_add_f32 v196, v196, v172
  v_add_f32 v197, v197, v173
  v_fma_f32 v168, v136, v224, v228
  v_fma_f32 v169, v137, v225, v228
  ds_read_b128 v[124:127], v246 offset:8192
  v_mfma_f32_32x32x16_bf16 a[176:191], a[124:127], v[188:191], a[176:191]
  v_add_f32 v194, v194, v170
  v_add_f32 v198, v198, v174
  v_add_f32 v195, v195, v171
  v_fma_f32 v172, v140, v224, v229
  ds_read_b128 v[128:131], v245 offset:10240
  v_fma_f32 v173, v141, v225, v229
  v_mfma_f32_32x32x16_bf16 a[192:207], a[128:131], v[188:191], a[192:207]
  v_exp_f32 v168, v168
  v_exp_f32 v169, v169
  v_fma_f32 v170, v138, v226, v228
  v_add_f32 v232, v232, v236
  v_mfma_f32_32x32x16_bf16 a[208:223], a[132:135], v[188:191], a[208:223]
  v_add_f32 v199, v199, v175
  ds_read_b128 v[132:135], v246 offset:10240
  v_fma_f32 v174, v142, v226, v229
  v_fma_f32 v171, v139, v227, v228
  v_exp_f32 v172, v172
  v_mfma_f32_32x32x16_bf16 a[224:239], a[136:139], v[188:191], a[224:239]
  v_exp_f32 v173, v173
  v_exp_f32 v170, v170
  v_add_f32 v233, v233, v237
  v_add_f32 v236, v168, v169
  v_mfma_f32_32x32x16_bf16 a[240:255], a[140:143], v[188:191], a[240:255]
  v_fma_f32 v175, v143, v227, v229
  v_exp_f32 v174, v174
  v_exp_f32 v171, v171
  v_add_f32 v237, v172, v173
  v_mfma_f32_16x16x32_bf16 v[144:147], a[96:99], a[48:51], v[160:163]
  v_add_f32 v236, v236, v170
  v_add_f32 v237, v237, v174
  v_mfma_f32_16x16x32_bf16 v[148:151], a[96:99], a[72:75], v[164:167]
  s_waitcnt vmcnt(6)
  ds_read_b128 a[96:99], v245 offset:18432
  v_mfma_f32_16x16x32_bf16 v[144:147], a[100:103], a[52:55], v[144:147]
  v_exp_f32 v175, v175
  v_mfma_f32_16x16x32_bf16 v[148:151], a[100:103], a[76:79], v[148:151]
  v_add_f32 v236, v236, v171
  v_add_f32 v237, v237, v175
  v_mfma_f32_16x16x32_bf16 v[144:147], a[104:107], a[56:59], v[144:147]
  ds_read_b128 a[100:103], v246 offset:18432
  v_max_f32 v253, v236, v237
  v_mfma_f32_16x16x32_bf16 v[148:151], a[104:107], a[80:83], v[148:151]
  ds_read_b128 a[104:107], v245 offset:20480
  v_cmp_lt_f32 vcc, s88, v253
  v_mfma_f32_16x16x32_bf16 v[144:147], a[108:111], a[60:63], v[144:147]
  ds_read_b64_tr_b16 a[120:121], v247 offset:24576
  ds_read_b64_tr_b16 a[122:123], v249 offset:25088
  v_mfma_f32_16x16x32_bf16 v[148:151], a[108:111], a[84:87], v[148:151]
  ds_read_b128 a[108:111], v246 offset:20480
  ds_read_b64_tr_b16 a[124:125], v248 offset:24576
  v_mfma_f32_16x16x32_bf16 v[144:147], a[112:115], a[64:67], v[144:147]
  ds_read_b64_tr_b16 a[126:127], v250 offset:25088
  ds_read_b64_tr_b16 a[128:129], v247 offset:26624
  v_mfma_f32_16x16x32_bf16 v[148:151], a[112:115], a[88:91], v[148:151]
  ds_read_b64_tr_b16 a[130:131], v249 offset:27136
  ds_read_b64_tr_b16 a[132:133], v248 offset:26624
  v_mfma_f32_16x16x32_bf16 v[144:147], a[116:119], a[68:71], v[144:147]
  ds_read_b64_tr_b16 a[134:135], v250 offset:27136
  ds_read_b64_tr_b16 a[136:137], v247 offset:28672
  v_mfma_f32_16x16x32_bf16 v[148:151], a[116:119], a[92:95], v[148:151]
  ds_read_b64_tr_b16 a[138:139], v249 offset:29184
  s_waitcnt lgkmcnt(13)
  v_mfma_f32_16x16x32_bf16 v[152:155], v[112:115], a[0:3], 0
  ds_read_b64_tr_b16 a[140:141], v248 offset:28672
  ds_read_b64_tr_b16 a[142:143], v250 offset:29184
  v_mfma_f32_16x16x32_bf16 v[156:159], v[112:115], a[24:27], 0
  s_cbranch_vccnz L_tr_3_0
L_ret_3_0:
  v_mfma_f32_16x16x32_bf16 v[160:163], v[112:115], a[48:51], 0
  ds_read_b128 a[112:115], v245 offset:22528
  ds_read_b128 a[116:119], v246 offset:22528
  v_mfma_f32_16x16x32_bf16 v[164:167], v[112:115], a[72:75], 0
  v_mul_f32 v168, v168, v224
  v_mul_f32 v169, v169, v225
  v_mfma_f32_16x16x32_bf16 v[152:155], v[116:119], a[4:7], v[152:155]
  v_mul_f32 v172, v172, v224
  v_mul_f32 v173, v173, v225
  v_mfma_f32_16x16x32_bf16 v[156:159], v[116:119], a[28:31], v[156:159]
  v_mul_f32 v170, v170, v226
  v_mul_f32 v171, v171, v227
  v_mfma_f32_16x16x32_bf16 v[160:163], v[116:119], a[52:55], v[160:163]
  v_mul_f32 v174, v174, v226
  v_mul_f32 v175, v175, v227
  v_mfma_f32_16x16x32_bf16 v[164:167], v[116:119], a[76:79], v[164:167]
  ds_read_b64 v[240:241], v245 offset:36864
  v_cvt_pk_bf16_f32 v184, v168, v169
  v_mfma_f32_16x16x32_bf16 v[152:155], v[120:123], a[8:11], v[152:155]
  v_cvt_pk_bf16_f32 v186, v172, v173
  v_cvt_pk_bf16_f32 v185, v170, v171
  v_mfma_f32_16x16x32_bf16 v[156:159], v[120:123], a[32:35], v[156:159]
  v_cvt_pk_bf16_f32 v187, v174, v175
  v_add_f32 v200, v200, v176
  v_mfma_f32_16x16x32_bf16 v[160:163], v[120:123], a[56:59], v[160:163]
  s_waitcnt lgkmcnt(3)
  buffer_load_dwordx4 v251, s[8:11], s67 offen nt lds
  v_mfma_f32_16x16x32_bf16 v[164:167], v[120:123], a[80:83], v[164:167]
  s_add_u32 m0, s37, 25600
  v_add_f32 v201, v201, v177
  v_mfma_f32_16x16x32_bf16 v[152:155], v[124:127], a[12:15], v[152:155]
  v_permlane16_swap_b32 v184, v186
  v_mfma_f32_16x16x32_bf16 v[156:159], v[124:127], a[36:39], v[156:159]
  v_permlane16_swap_b32 v185, v187
  v_mfma_f32_16x16x32_bf16 v[160:163], v[124:127], a[60:63], v[160:163]
  v_add_f32 v204, v204, v180
  v_add_f32 v205, v205, v181
  v_mfma_f32_16x16x32_bf16 v[164:167], v[124:127], a[84:87], v[164:167]
  v_add_f32 v202, v202, v178
  v_add_f32 v206, v206, v182
  v_mfma_f32_16x16x32_bf16 v[152:155], v[128:131], a[16:19], v[152:155]
  buffer_load_dwordx4 v252, s[8:11], s67 offen nt lds
  v_mfma_f32_16x16x32_bf16 v[156:159], v[128:131], a[40:43], v[156:159]
  s_add_u32 m0, s37, 26496
  v_fma_f32 v176, v144, v224, v230
  v_mfma_f32_16x16x32_bf16 v[160:163], v[128:131], a[64:67], v[160:163]
  v_fma_f32 v177, v145, v225, v230
  v_fma_f32 v180, v148, v224, v231
  v_mfma_f32_16x16x32_bf16 v[164:167], v[128:131], a[88:91], v[164:167]
  v_add_f32 v203, v203, v179
  v_fma_f32 v181, v149, v225, v231
  v_mfma_f32_16x16x32_bf16 v[152:155], v[132:135], a[20:23], v[152:155]
  v_add_f32 v207, v207, v183
  v_fma_f32 v178, v146, v226, v230
  v_mfma_f32_16x16x32_bf16 v[156:159], v[132:135], a[44:47], v[156:159]
  v_fma_f32 v182, v150, v226, v231
  v_fma_f32 v179, v147, v227, v230
  v_mfma_f32_16x16x32_bf16 v[160:163], v[132:135], a[68:71], v[160:163]
  buffer_load_dwordx4 v251, s[8:11], s67 offen offset:128 nt lds
  v_mfma_f32_16x16x32_bf16 v[164:167], v[132:135], a[92:95], v[164:167]
  s_add_u32 m0, s37, 27520
  v_add_f32 v234, v234, v238
  v_mfma_f32_16x16x32_bf16 v[208:211], a[96:99], a[96:99], 0
  v_exp_f32 v176, v176
  v_mfma_f32_16x16x32_bf16 v[212:215], a[96:99], v[112:115], 0
  v_exp_f32 v177, v177
  v_mfma_f32_16x16x32_bf16 v[216:219], a[168:171], a[96:99], 0
  v_exp_f32 v180, v180
  v_mfma_f32_16x16x32_bf16 v[208:211], a[100:103], a[100:103], v[208:211]
  v_exp_f32 v181, v181
  v_mfma_f32_16x16x32_bf16 v[212:215], a[100:103], v[116:119], v[212:215]
  buffer_load_dwordx4 v252, s[8:11], s67 offen offset:128 nt lds
  v_mfma_f32_16x16x32_bf16 v[216:219], a[168:171], a[100:103], v[216:219]
  s_add_u32 m0, s37, 28416
  v_add_f32 v235, v235, v239
  v_mfma_f32_16x16x32_bf16 v[208:211], a[104:107], a[104:107], v[208:211]
  v_fma_f32 v183, v151, v227, v231
  v_add_f32 v238, v176, v177
  v_mfma_f32_16x16x32_bf16 v[212:215], a[104:107], v[120:123], v[212:215]
  v_exp_f32 v178, v178
  v_mfma_f32_16x16x32_bf16 v[216:219], a[168:171], a[104:107], v[216:219]
  v_exp_f32 v182, v182
  v_mfma_f32_16x16x32_bf16 v[208:211], a[108:111], a[108:111], v[208:211]
  v_exp_f32 v179, v179
  v_mfma_f32_16x16x32_bf16 v[212:215], a[108:111], v[124:127], v[212:215]
  buffer_load_dwordx4 v251, s[8:11], s67 offen offset:256 nt lds
  v_mfma_f32_16x16x32_bf16 v[216:219], a[168:171], a[108:111], v[216:219]
  s_add_u32 m0, s37, 29440
  s_waitcnt lgkmcnt(0)
  v_mfma_f32_16x16x32_bf16 v[208:211], a[112:115], a[112:115], v[208:211]
  v_add_f32 v239, v180, v181
  v_add_f32 v238, v238, v178
  v_mfma_f32_16x16x32_bf16 v[212:215], a[112:115], v[128:131], v[212:215]
  v_exp_f32 v183, v183
  v_mfma_f32_16x16x32_bf16 v[216:219], a[168:171], a[112:115], v[216:219]
  v_add_f32 v239, v239, v182
  v_add_f32 v238, v238, v179
  v_mfma_f32_16x16x32_bf16 v[208:211], a[116:119], a[116:119], v[208:211]
  v_add_f32 v239, v239, v183
  v_max_f32 v254, v238, v239
  v_mfma_f32_16x16x32_bf16 v[212:215], a[116:119], v[132:135], v[212:215]
  buffer_load_dwordx4 v252, s[8:11], s67 offen offset:256 nt lds
  v_mfma_f32_16x16x32_bf16 v[216:219], a[168:171], a[116:119], v[216:219]
  s_add_u32 m0, s37, 18048
  v_cmp_lt_f32 vcc, s88, v254
  v_mfma_f32_32x32x16_bf16 v[0:15], a[120:123], v[184:187], v[0:15]
  v_cndmask_b32 v242, v208, v209, s[48:49]
  v_cndmask_b32 v243, v210, v211, s[48:49]
  v_cndmask_b32 v242, v242, v243, s[50:51]
  v_cndmask_b32 v243, v212, v213, s[48:49]
  v_cndmask_b32 v244, v214, v215, s[48:49]
  v_cndmask_b32 v243, v243, v244, s[50:51]
  v_fma_f32 v243, v243, 2.0, v240
  v_add_f32 v242, v242, v243
  v_add_f32 v244, v216, v241
  v_mul_f32 v244, v244, v244
  v_mfma_f32_32x32x16_bf16 v[16:31], a[124:127], v[184:187], v[16:31]
  v_fma_f32 v242, v244, s89, v242
  v_rsq_f32 v242, v242
  s_cbranch_vccnz L_tr_3_1
L_ret_3_1:
  v_cndmask_b32 v242, 0, v242, s[52:53]
  v_mfma_f32_32x32x16_bf16 v[32:47], a[128:131], v[184:187], v[32:47]
  v_mul_f32 v176, v176, v224
  v_mul_f32 v177, v177, v225
  v_mul_f32 v180, v180, v224
  v_mul_f32 v181, v181, v225
  v_mul_f32 v178, v178, v226
  v_mul_f32 v179, v179, v227
  v_mfma_f32_32x32x16_bf16 v[48:63], a[132:135], v[184:187], v[48:63]
  v_mul_f32 v182, v182, v226
  v_mul_f32 v183, v183, v227
  v_cvt_pk_bf16_f32 v188, v176, v177
  v_cvt_pk_bf16_f32 v190, v180, v181
  v_cvt_pk_bf16_f32 v189, v178, v179
  v_cvt_pk_bf16_f32 v191, v182, v183
  v_mfma_f32_32x32x16_bf16 v[64:79], a[136:139], v[184:187], v[64:79]
  v_permlane16_swap_b32 v188, v190
  v_permlane16_swap_b32 v189, v191
  v_add_f32 v192, v192, v168
  v_add_f32 v193, v193, v169
  v_mfma_f32_32x32x16_bf16 v[80:95], a[140:143], v[184:187], v[80:95]
  v_add_f32 v196, v196, v172
  v_add_f32 v197, v197, v173
  v_add_f32 v194, v194, v170
  v_add_f32 v195, v195, v171
  v_add_f32 v198, v198, v174
  v_add_f32 v199, v199, v175
  v_mfma_f32_16x16x4_f32 v[220:223], v242, a172, 0
  v_cvt_pk_bf16_f32 v208, v192, v193
  v_cvt_pk_bf16_f32 v210, v196, v197
  v_cvt_pk_bf16_f32 v209, v194, v195
  v_cvt_pk_bf16_f32 v211, v198, v199
  v_permlane16_swap_b32 v208, v210
  v_mfma_f32_16x16x32_bf16 v[136:139], a[96:99], a[0:3], v[152:155]
  v_permlane16_swap_b32 v209, v211
  v_mfma_f32_16x16x32_bf16 v[140:143], a[96:99], a[24:27], v[156:159]
  v_add_f32 v200, v200, v176
  v_add_f32 v201, v201, v177
  v_mfma_f32_16x16x32_bf16 v[136:139], a[100:103], a[4:7], v[136:139]
  v_add_f32 v202, v202, v178
  v_add_f32 v203, v203, v179
  v_mfma_f32_16x16x32_bf16 v[140:143], a[100:103], a[28:31], v[140:143]
  v_add_f32 v204, v204, v180
  v_add_f32 v205, v205, v181
  v_mfma_f32_16x16x32_bf16 v[136:139], a[104:107], a[8:11], v[136:139]
  v_add_f32 v206, v206, v182
  v_add_f32 v207, v207, v183
  v_mfma_f32_16x16x32_bf16 v[140:143], a[104:107], a[32:35], v[140:143]
  v_cvt_pk_bf16_f32 v212, v200, v201
  v_cvt_pk_bf16_f32 v213, v202, v203
  v_mfma_f32_16x16x32_bf16 v[136:139], a[108:111], a[12:15], v[136:139]
  v_cvt_pk_bf16_f32 v214, v204, v205
  v_cvt_pk_bf16_f32 v215, v206, v207
  v_mfma_f32_16x16x32_bf16 v[140:143], a[108:111], a[36:39], v[140:143]
  v_permlane16_swap_b32 v212, v214
  v_mfma_f32_16x16x32_bf16 v[136:139], a[112:115], a[16:19], v[136:139]
  v_permlane16_swap_b32 v213, v215
  v_mfma_f32_16x16x32_bf16 v[140:143], a[112:115], a[40:43], v[140:143]
  v_add_f32 v232, v232, v236
  v_add_f32 v233, v233, v237
  v_mfma_f32_16x16x32_bf16 v[136:139], a[116:119], a[20:23], v[136:139]
  v_add_f32 v234, v234, v238
  v_add_f32 v235, v235, v239
  v_mfma_f32_16x16x32_bf16 v[140:143], a[116:119], a[44:47], v[140:143]
  v_mfma_f32_32x32x16_bf16 v[96:111], a[120:123], v[188:191], v[96:111]
  ds_read_b64_tr_b16 a[120:121], v247 offset:0
  ds_read_b64_tr_b16 a[122:123], v249 offset:512
  v_mfma_f32_32x32x16_bf16 a[176:191], a[124:127], v[188:191], a[176:191]
  ds_read_b64_tr_b16 a[124:125], v248 offset:0
  ds_read_b64_tr_b16 a[126:127], v250 offset:512
  v_fma_f32 v168, v136, v220, v228
  v_fma_f32 v169, v137, v221, v228
  v_fma_f32 v172, v140, v220, v229
  v_fma_f32 v173, v141, v221, v229
  v_mfma_f32_32x32x16_bf16 a[192:207], a[128:131], v[188:191], a[192:207]
  ds_read_b64_tr_b16 a[128:129], v247 offset:2048
  ds_read_b64_tr_b16 a[130:131], v249 offset:2560
  v_fma_f32 v170, v138, v222, v228
  v_exp_f32 v168, v168
  v_fma_f32 v174, v142, v222, v229
  v_mfma_f32_32x32x16_bf16 a[208:223], a[132:135], v[188:191], a[208:223]
  ds_read_b64_tr_b16 a[132:133], v248 offset:2048
  ds_read_b64_tr_b16 a[134:135], v250 offset:2560
  v_exp_f32 v169, v169
  v_fma_f32 v171, v139, v223, v228
  v_add_f32 v236, v168, v169
  v_mfma_f32_32x32x16_bf16 a[224:239], a[136:139], v[188:191], a[224:239]
  ds_read_b64_tr_b16 a[136:137], v247 offset:4096
  ds_read_b64_tr_b16 a[138:139], v249 offset:4608
  v_exp_f32 v172, v172
  v_exp_f32 v173, v173
  v_mfma_f32_32x32x16_bf16 a[240:255], a[140:143], v[188:191], a[240:255]
  ds_read_b64_tr_b16 a[140:141], v248 offset:4096
  ds_read_b64_tr_b16 a[142:143], v250 offset:4608
  v_exp_f32 v170, v170
  v_fma_f32 v175, v143, v223, v229
  v_add_f32 v237, v172, v173
  v_mfma_f32_16x16x32_bf16 v[144:147], a[96:99], a[48:51], v[160:163]
  v_exp_f32 v174, v174
  v_mfma_f32_16x16x32_bf16 v[148:151], a[96:99], a[72:75], v[164:167]
  s_waitcnt vmcnt(6)
  ds_read_b128 a[96:99], v245 offset:30720
  v_mfma_f32_16x16x32_bf16 v[144:147], a[100:103], a[52:55], v[144:147]
  v_exp_f32 v171, v171
  v_mfma_f32_16x16x32_bf16 v[148:151], a[100:103], a[76:79], v[148:151]
  ds_read_b128 a[100:103], v246 offset:30720
  v_add_f32 v236, v236, v170
  v_mfma_f32_16x16x32_bf16 v[144:147], a[104:107], a[56:59], v[144:147]
  v_exp_f32 v175, v175
  v_mfma_f32_16x16x32_bf16 v[148:151], a[104:107], a[80:83], v[148:151]
  ds_read_b128 a[104:107], v245 offset:32768
  v_add_f32 v237, v237, v174
  v_mfma_f32_16x16x32_bf16 v[144:147], a[108:111], a[60:63], v[144:147]
  v_add_f32 v236, v236, v171
  v_add_f32 v237, v237, v175
  v_mfma_f32_16x16x32_bf16 v[148:151], a[108:111], a[84:87], v[148:151]
  ds_read_b128 a[108:111], v246 offset:32768
  v_max_f32 v253, v236, v237
  v_mfma_f32_16x16x32_bf16 v[144:147], a[112:115], a[64:67], v[144:147]
  v_cmp_lt_f32 vcc, s88, v253
  ds_write_b128 v245, a[144:147] offset:0
  v_mfma_f32_16x16x32_bf16 v[148:151], a[112:115], a[88:91], v[148:151]
  ds_read_b128 a[112:115], v245 offset:34816
  ds_read_b64_tr_b16 a[144:145], v247 offset:6144
  v_mfma_f32_16x16x32_bf16 v[144:147], a[116:119], a[68:71], v[144:147]
  ds_write_b128 v246, a[148:151] offset:0
  v_mfma_f32_16x16x32_bf16 v[148:151], a[116:119], a[92:95], v[148:151]
  ds_read_b128 a[116:119], v246 offset:34816
  s_waitcnt lgkmcnt(7)
  v_mfma_f32_32x32x16_bf16 v[0:15], a[120:123], v[208:211], v[0:15]
  v_mfma_f32_32x32x16_bf16 v[16:31], a[124:127], v[208:211], v[16:31]
  ds_write_b128 v245, a[152:155] offset:2048
  v_mfma_f32_32x32x16_bf16 v[32:47], a[128:131], v[208:211], v[32:47]
  v_fma_f32 v176, v144, v220, v230
  v_fma_f32 v177, v145, v221, v230
  v_fma_f32 v180, v148, v220, v231
  v_fma_f32 v181, v149, v221, v231
  v_fma_f32 v178, v146, v222, v230
  v_fma_f32 v182, v150, v222, v231
  v_mfma_f32_32x32x16_bf16 v[48:63], a[132:135], v[208:211], v[48:63]
  v_exp_f32 v176, v176
  v_exp_f32 v177, v177
  v_exp_f32 v180, v180
  v_mfma_f32_32x32x16_bf16 v[64:79], a[136:139], v[208:211], v[64:79]
  v_fma_f32 v179, v147, v223, v230
  v_exp_f32 v181, v181
  v_fma_f32 v183, v151, v223, v231
  v_exp_f32 v178, v178
  v_mfma_f32_32x32x16_bf16 v[80:95], a[140:143], v[208:211], v[80:95]
  s_cbranch_vccnz L_tr_4_0
L_ret_4_0:
  v_mul_f32 v192, v168, v220
  v_mul_f32 v193, v169, v221
  v_mul_f32 v196, v172, v220
  v_mul_f32 v197, v173, v221
  v_mfma_f32_32x32x16_bf16 v[96:111], a[120:123], v[212:215], v[96:111]
  ds_read_b64_tr_b16 a[120:121], v247 offset:18432
  ds_read_b64_tr_b16 a[122:123], v249 offset:18944
  v_mul_f32 v194, v170, v222
  v_mul_f32 v195, v171, v223
  v_mul_f32 v198, v174, v222
  v_mul_f32 v199, v175, v223
  v_mfma_f32_32x32x16_bf16 a[176:191], a[124:127], v[212:215], a[176:191]
  ds_read_b64_tr_b16 a[124:125], v248 offset:18432
  ds_read_b64_tr_b16 a[126:127], v250 offset:18944
  v_cvt_pk_bf16_f32 v184, v192, v193
  v_cvt_pk_bf16_f32 v186, v196, v197
  v_cvt_pk_bf16_f32 v185, v194, v195
  v_cvt_pk_bf16_f32 v187, v198, v199
  v_mfma_f32_32x32x16_bf16 a[192:207], a[128:131], v[212:215], a[192:207]
  ds_read_b64_tr_b16 a[128:129], v247 offset:20480
  ds_read_b64_tr_b16 a[130:131], v249 offset:20992
  v_permlane16_swap_b32 v184, v186
  v_permlane16_swap_b32 v185, v187
  v_mfma_f32_32x32x16_bf16 a[208:223], a[132:135], v[212:215], a[208:223]
  ds_read_b64_tr_b16 a[132:133], v248 offset:20480
  ds_read_b64_tr_b16 a[134:135], v250 offset:20992
  v_exp_f32 v182, v182
  v_exp_f32 v179, v179
  v_mfma_f32_32x32x16_bf16 a[224:239], a[136:139], v[212:215], a[224:239]
  ds_read_b64_tr_b16 a[136:137], v247 offset:22528
  ds_read_b64_tr_b16 a[138:139], v249 offset:23040
  v_add_f32 v238, v176, v177
  v_add_f32 v239, v180, v181
  v_exp_f32 v183, v183
  v_mfma_f32_32x32x16_bf16 a[240:255], a[140:143], v[212:215], a[240:255]
  ds_read_b64_tr_b16 a[140:141], v248 offset:22528
  ds_read_b64_tr_b16 a[142:143], v250 offset:23040
  v_add_f32 v238, v238, v178
  v_add_f32 v239, v239, v182
  v_add_f32 v238, v238, v179
  v_add_f32 v239, v239, v183
  v_mfma_f32_16x16x32_bf16 v[208:211], a[96:99], a[96:99], 0
  v_max_f32 v254, v238, v239
  v_cmp_lt_f32 vcc, s88, v254
  v_mfma_f32_16x16x32_bf16 v[212:215], a[96:99], v[112:115], 0
  v_add_f32 v232, v232, v236
  v_add_f32 v233, v233, v237
  v_mfma_f32_16x16x32_bf16 v[216:219], a[168:171], a[96:99], 0
  s_cbranch_vccnz L_tr_4_1
L_ret_4_1:
  v_mfma_f32_16x16x32_bf16 v[208:211], a[100:103], a[100:103], v[208:211]
  v_mul_f32 v200, v176, v220
  v_mul_f32 v201, v177, v221
  v_mfma_f32_16x16x32_bf16 v[212:215], a[100:103], v[116:119], v[212:215]
  v_mul_f32 v204, v180, v220
  v_mul_f32 v205, v181, v221
  v_mfma_f32_16x16x32_bf16 v[216:219], a[168:171], a[100:103], v[216:219]
  v_mul_f32 v202, v178, v222
  s_waitcnt lgkmcnt(2)
  v_mfma_f32_16x16x32_bf16 v[208:211], a[104:107], a[104:107], v[208:211]
  v_mul_f32 v203, v179, v223
  v_mul_f32 v206, v182, v222
  v_mfma_f32_16x16x32_bf16 v[212:215], a[104:107], v[120:123], v[212:215]
  s_waitcnt lgkmcnt(0)
  buffer_load_dwordx4 v251, s[8:11], s67 offen offset:384 nt lds
  v_mfma_f32_16x16x32_bf16 v[216:219], a[168:171], a[104:107], v[216:219]
  s_add_u32 m0, s37, 19072
  v_mul_f32 v207, v183, v223
  v_mfma_f32_16x16x32_bf16 v[208:211], a[108:111], a[108:111], v[208:211]
  v_cvt_pk_bf16_f32 v188, v200, v201
  v_cvt_pk_bf16_f32 v190, v204, v205
  v_mfma_f32_16x16x32_bf16 v[212:215], a[108:111], v[124:127], v[212:215]
  v_cvt_pk_bf16_f32 v189, v202, v203
  v_cvt_pk_bf16_f32 v191, v206, v207
  v_mfma_f32_16x16x32_bf16 v[216:219], a[168:171], a[108:111], v[216:219]
  v_permlane16_swap_b32 v188, v190
  v_mfma_f32_16x16x32_bf16 v[208:211], a[112:115], a[112:115], v[208:211]
  v_permlane16_swap_b32 v189, v191
  v_mfma_f32_16x16x32_bf16 v[212:215], a[112:115], v[128:131], v[212:215]
  buffer_load_dwordx4 v252, s[8:11], s67 offen offset:384 nt lds
  v_mfma_f32_16x16x32_bf16 v[216:219], a[168:171], a[112:115], v[216:219]
  s_add_u32 m0, s37, 19968
  v_add_f32 v234, v234, v238
  v_mfma_f32_16x16x32_bf16 v[208:211], a[116:119], a[116:119], v[208:211]
  v_add_f32 v235, v235, v239
  ds_write_b128 v246, a[156:159] offset:2048
  v_mfma_f32_16x16x32_bf16 v[212:215], a[116:119], v[132:135], v[212:215]
  ds_read_b64_tr_b16 a[146:147], v249 offset:6656
  ds_read_b64_tr_b16 a[148:149], v248 offset:6144
  v_mfma_f32_16x16x32_bf16 v[216:219], a[168:171], a[116:119], v[216:219]
  ds_write_b128 v245, a[160:163] offset:4096
  v_mfma_f32_32x32x16_bf16 v[0:15], a[120:123], v[184:187], v[0:15]
  v_cndmask_b32 v242, v208, v209, s[48:49]
  v_cndmask_b32 v243, v210, v211, s[48:49]
  v_cndmask_b32 v242, v242, v243, s[50:51]
  v_cndmask_b32 v243, v212, v213, s[48:49]
  v_cndmask_b32 v244, v214, v215, s[48:49]
  v_cndmask_b32 v243, v243, v244, s[50:51]
  v_fma_f32 v243, v243, 2.0, v240
  v_add_f32 v242, v242, v243
  v_add_f32 v244, v216, v241
  v_mul_f32 v244, v244, v244
  buffer_load_dwordx4 v251, s[8:11], s67 offen offset:512 nt lds
  v_mfma_f32_32x32x16_bf16 v[16:31], a[124:127], v[184:187], v[16:31]
  v_fma_f32 v242, v244, s89, v242
  v_rsq_f32 v242, v242
  s_add_u32 m0, s37, 20992
  v_cndmask_b32 v242, 0, v242, s[52:53]
  ds_write_b128 v246, a[164:167] offset:4096
  v_mfma_f32_32x32x16_bf16 v[32:47], a[128:131], v[184:187], v[32:47]
  ds_read_b64_tr_b16 a[150:151], v250 offset:6656
  buffer_load_dwordx4 v252, s[8:11], s67 offen offset:512 nt lds
  s_add_u32 m0, s37, 21888
  ds_read_b64_tr_b16 a[152:153], v247 offset:8192
  v_mfma_f32_32x32x16_bf16 v[48:63], a[132:135], v[184:187], v[48:63]
  ds_read_b64_tr_b16 a[154:155], v249 offset:8704
  ds_read_b64_tr_b16 a[156:157], v248 offset:8192
  ds_read_b64_tr_b16 a[158:159], v250 offset:8704
  ds_read_b64_tr_b16 a[160:161], v247 offset:10240
  ds_read_b64_tr_b16 a[162:163], v249 offset:10752
  ds_read_b64_tr_b16 a[164:165], v248 offset:10240
  v_mfma_f32_32x32x16_bf16 v[64:79], a[136:139], v[184:187], v[64:79]
  buffer_load_dwordx4 v251, s[8:11], s67 offen offset:640 nt lds
  s_add_u32 m0, s37, 22912
  ds_read_b64_tr_b16 a[166:167], v250 offset:10752
  v_mfma_f32_32x32x16_bf16 v[80:95], a[140:143], v[184:187], v[80:95]
  v_mfma_f32_16x16x4_f32 v[224:227], v242, a172, 0
  buffer_load_dwordx4 v252, s[8:11], s67 offen offset:640 nt lds
  s_add_u32 m0, s37, 30720
  v_mfma_f32_16x16x32_bf16 v[136:139], a[96:99], a[0:3], v[152:155]
  v_mfma_f32_16x16x32_bf16 v[140:143], a[96:99], a[24:27], v[156:159]
  v_mfma_f32_16x16x32_bf16 v[136:139], a[100:103], a[4:7], v[136:139]
  v_mfma_f32_16x16x32_bf16 v[140:143], a[100:103], a[28:31], v[140:143]
  v_mfma_f32_16x16x32_bf16 v[136:139], a[104:107], a[8:11], v[136:139]
  v_mfma_f32_16x16x32_bf16 v[140:143], a[104:107], a[32:35], v[140:143]
  v_mfma_f32_16x16x32_bf16 v[136:139], a[108:111], a[12:15], v[136:139]
  v_mfma_f32_16x16x32_bf16 v[140:143], a[108:111], a[36:39], v[140:143]
  v_mfma_f32_16x16x32_bf16 v[136:139], a[112:115], a[16:19], v[136:139]
  v_mfma_f32_16x16x32_bf16 v[140:143], a[112:115], a[40:43], v[140:143]
  v_mfma_f32_16x16x32_bf16 v[136:139], a[116:119], a[20:23], v[136:139]
  v_mfma_f32_16x16x32_bf16 v[140:143], a[116:119], a[44:47], v[140:143]
  v_mfma_f32_32x32x16_bf16 v[96:111], a[120:123], v[188:191], v[96:111]
  ds_read_b64_tr_b16 a[120:121], v247 offset:30720
  ds_read_b64_tr_b16 a[122:123], v249 offset:31232
  v_mfma_f32_32x32x16_bf16 a[176:191], a[124:127], v[188:191], a[176:191]
  ds_read_b64_tr_b16 a[124:125], v248 offset:30720
  ds_read_b64_tr_b16 a[126:127], v250 offset:31232
  v_mfma_f32_32x32x16_bf16 a[192:207], a[128:131], v[188:191], a[192:207]
  ds_read_b64_tr_b16 a[128:129], v247 offset:32768
  ds_read_b64_tr_b16 a[130:131], v249 offset:33280
  v_fma_f32 v168, v136, v224, v228
  v_fma_f32 v169, v137, v225, v228
  v_fma_f32 v172, v140, v224, v229
  v_fma_f32 v173, v141, v225, v229
  v_mfma_f32_32x32x16_bf16 a[208:223], a[132:135], v[188:191], a[208:223]
  ds_read_b64_tr_b16 a[132:133], v248 offset:32768
  ds_read_b64_tr_b16 a[134:135], v250 offset:33280
  v_exp_f32 v168, v168
  v_exp_f32 v169, v169
  v_mfma_f32_32x32x16_bf16 a[224:239], a[136:139], v[188:191], a[224:239]
  ds_read_b64_tr_b16 a[136:137], v247 offset:34816
  ds_read_b64_tr_b16 a[138:139], v249 offset:35328
  v_fma_f32 v170, v138, v226, v228
  v_fma_f32 v174, v142, v226, v229
  v_fma_f32 v171, v139, v227, v228
  v_add_f32 v236, v168, v169
  v_mfma_f32_32x32x16_bf16 a[240:255], a[140:143], v[188:191], a[240:255]
  ds_read_b64_tr_b16 a[140:141], v248 offset:34816
  ds_read_b64_tr_b16 a[142:143], v250 offset:35328
  v_exp_f32 v172, v172
  v_exp_f32 v173, v173
  v_mfma_f32_16x16x32_bf16 v[144:147], a[96:99], a[48:51], v[160:163]
  v_exp_f32 v170, v170
  v_mfma_f32_16x16x32_bf16 v[148:151], a[96:99], a[72:75], v[164:167]
  s_waitcnt vmcnt(6)
  ds_read_b128 a[96:99], v245 offset:24576
  v_mfma_f32_16x16x32_bf16 v[144:147], a[100:103], a[52:55], v[144:147]
  v_exp_f32 v174, v174
  v_mfma_f32_16x16x32_bf16 v[148:151], a[100:103], a[76:79], v[148:151]
  ds_read_b128 a[100:103], v246 offset:24576
  v_fma_f32 v175, v143, v227, v229
  v_mfma_f32_16x16x32_bf16 v[144:147], a[104:107], a[56:59], v[144:147]
  v_exp_f32 v171, v171
  v_mfma_f32_16x16x32_bf16 v[148:151], a[104:107], a[80:83], v[148:151]
  ds_read_b128 a[104:107], v245 offset:26624
  v_add_f32 v237, v172, v173
  v_mfma_f32_16x16x32_bf16 v[144:147], a[108:111], a[60:63], v[144:147]
  v_add_f32 v236, v236, v170
  v_add_f32 v237, v237, v174
  v_mfma_f32_16x16x32_bf16 v[148:151], a[108:111], a[84:87], v[148:151]
  s_waitcnt lgkmcnt(3)
  buffer_load_dwordx4 v251, s[8:11], s68 offen nt lds
  v_mfma_f32_16x16x32_bf16 v[144:147], a[112:115], a[64:67], v[144:147]
  s_add_u32 m0, s37, 31744
  ds_read_b128 a[108:111], v246 offset:26624
  v_mfma_f32_16x16x32_bf16 v[148:151], a[112:115], a[88:91], v[148:151]
  ds_read_b128 a[112:115], v245 offset:28672
  v_add_f32 v236, v236, v171
  v_mfma_f32_16x16x32_bf16 v[144:147], a[116:119], a[68:71], v[144:147]
  v_exp_f32 v175, v175
  v_mfma_f32_16x16x32_bf16 v[148:151], a[116:119], a[92:95], v[148:151]
  v_add_f32 v237, v237, v175
  s_waitcnt lgkmcnt(3)
  v_mfma_f32_16x16x32_bf16 v[208:211], a[96:99], a[96:99], 0
  v_max_f32 v253, v236, v237
  v_cmp_lt_f32 vcc, s88, v253
  v_mfma_f32_16x16x32_bf16 v[212:215], a[96:99], v[112:115], 0
  buffer_load_dwordx4 v252, s[8:11], s68 offen nt lds
  v_mfma_f32_16x16x32_bf16 v[216:219], a[168:171], a[96:99], 0
  s_add_u32 m0, s37, 32640
  ds_read_b128 a[116:119], v246 offset:28672
  v_mfma_f32_16x16x32_bf16 v[208:211], a[100:103], a[100:103], v[208:211]
  s_cbranch_vccnz L_tr_5_0
L_ret_5_0:
  v_mfma_f32_16x16x32_bf16 v[212:215], a[100:103], v[116:119], v[212:215]
  v_mul_f32 v168, v168, v224
  v_mul_f32 v169, v169, v225
  v_mfma_f32_16x16x32_bf16 v[216:219], a[168:171], a[100:103], v[216:219]
  v_mul_f32 v172, v172, v224
  s_waitcnt lgkmcnt(2)
  v_mfma_f32_16x16x32_bf16 v[208:211], a[104:107], a[104:107], v[208:211]
  v_mul_f32 v173, v173, v225
  v_mul_f32 v170, v170, v226
  v_mfma_f32_16x16x32_bf16 v[212:215], a[104:107], v[120:123], v[212:215]
  buffer_load_dwordx4 v251, s[8:11], s68 offen offset:128 nt lds
  v_mfma_f32_16x16x32_bf16 v[216:219], a[168:171], a[104:107], v[216:219]
  s_add_u32 m0, s37, 33664
  v_mul_f32 v171, v171, v227
  v_mfma_f32_16x16x32_bf16 v[208:211], a[108:111], a[108:111], v[208:211]
  v_mul_f32 v174, v174, v226
  v_mul_f32 v175, v175, v227
  v_mfma_f32_16x16x32_bf16 v[212:215], a[108:111], v[124:127], v[212:215]
  v_cvt_pk_bf16_f32 v184, v168, v169
  v_cvt_pk_bf16_f32 v186, v172, v173
  v_mfma_f32_16x16x32_bf16 v[216:219], a[168:171], a[108:111], v[216:219]
  v_cvt_pk_bf16_f32 v185, v170, v171
  s_waitcnt lgkmcnt(0)
  v_mfma_f32_16x16x32_bf16 v[208:211], a[112:115], a[112:115], v[208:211]
  v_cvt_pk_bf16_f32 v187, v174, v175
  v_fma_f32 v176, v144, v224, v230
  v_mfma_f32_16x16x32_bf16 v[212:215], a[112:115], v[128:131], v[212:215]
  buffer_load_dwordx4 v252, s[8:11], s68 offen offset:128 nt lds
  v_mfma_f32_16x16x32_bf16 v[216:219], a[168:171], a[112:115], v[216:219]
  v_permlane16_swap_b32 v184, v186
  v_mfma_f32_16x16x32_bf16 v[208:211], a[116:119], a[116:119], v[208:211]
  v_permlane16_swap_b32 v185, v187
  v_mfma_f32_16x16x32_bf16 v[212:215], a[116:119], v[132:135], v[212:215]
  s_add_u32 m0, s37, 34560
  v_fma_f32 v177, v145, v225, v230
  v_mfma_f32_16x16x32_bf16 v[216:219], a[168:171], a[116:119], v[216:219]
  v_fma_f32 v180, v148, v224, v231
  v_fma_f32 v181, v149, v225, v231
  v_mfma_f32_32x32x16_bf16 v[0:15], a[120:123], v[184:187], v[0:15]
  v_cndmask_b32 v242, v208, v209, s[48:49]
  v_cndmask_b32 v243, v210, v211, s[48:49]
  v_cndmask_b32 v242, v242, v243, s[50:51]
  v_cndmask_b32 v243, v212, v213, s[48:49]
  v_cndmask_b32 v244, v214, v215, s[48:49]
  v_cndmask_b32 v243, v243, v244, s[50:51]
  v_fma_f32 v243, v243, 2.0, v240
  v_add_f32 v242, v242, v243
  v_add_f32 v244, v216, v241
  v_fma_f32 v178, v146, v226, v230
  v_mul_f32 v244, v244, v244
  buffer_load_dwordx4 v251, s[8:11], s68 offen offset:256 nt lds
  v_mfma_f32_32x32x16_bf16 v[16:31], a[124:127], v[184:187], v[16:31]
  v_fma_f32 v242, v244, s89, v242
  v_fma_f32 v182, v150, v226, v231
  v_rsq_f32 v242, v242
  v_exp_f32 v176, v176
  v_mfma_f32_32x32x16_bf16 v[32:47], a[128:131], v[184:187], v[32:47]
  v_exp_f32 v177, v177
  v_exp_f32 v180, v180
  v_fma_f32 v179, v147, v227, v230
  s_add_u32 m0, s37, 35584
  v_mfma_f32_32x32x16_bf16 v[48:63], a[132:135], v[184:187], v[48:63]
  v_exp_f32 v181, v181
  v_fma_f32 v183, v151, v227, v231
  v_exp_f32 v178, v178
  v_cndmask_b32 v242, 0, v242, s[52:53]
  v_mfma_f32_32x32x16_bf16 v[64:79], a[136:139], v[184:187], v[64:79]
  v_exp_f32 v182, v182
  v_exp_f32 v179, v179
  v_add_f32 v238, v176, v177
  v_add_f32 v239, v180, v181
  buffer_load_dwordx4 v252, s[8:11], s68 offen offset:256 nt lds
  v_mfma_f32_32x32x16_bf16 v[80:95], a[140:143], v[184:187], v[80:95]
  v_exp_f32 v183, v183
  v_add_f32 v238, v238, v178
  v_add_f32 v239, v239, v182
  v_add_f32 v238, v238, v179
  s_add_u32 m0, s37, 24192
  v_mfma_f32_16x16x4_f32 v[220:223], v242, a172, 0
  v_add_f32 v239, v239, v183
  v_max_f32 v254, v238, v239
  v_cmp_lt_f32 vcc, s88, v254
  v_add_f32 v192, v192, v168
  v_add_f32 v193, v193, v169
  v_add_f32 v196, v196, v172
  v_mfma_f32_16x16x32_bf16 v[136:139], a[96:99], a[0:3], v[152:155]
  s_cbranch_vccnz L_tr_5_1
L_ret_5_1:
  v_mfma_f32_16x16x32_bf16 v[140:143], a[96:99], a[24:27], v[156:159]
  v_mul_f32 v176, v176, v224
  v_mul_f32 v177, v177, v225
  v_mfma_f32_16x16x32_bf16 v[136:139], a[100:103], a[4:7], v[136:139]
  v_mul_f32 v180, v180, v224
  v_mul_f32 v181, v181, v225
  v_mfma_f32_16x16x32_bf16 v[140:143], a[100:103], a[28:31], v[140:143]
  v_mul_f32 v178, v178, v226
  v_mul_f32 v179, v179, v227
  v_mfma_f32_16x16x32_bf16 v[136:139], a[104:107], a[8:11], v[136:139]
  v_mul_f32 v182, v182, v226
  v_mul_f32 v183, v183, v227
  v_mfma_f32_16x16x32_bf16 v[140:143], a[104:107], a[32:35], v[140:143]
  v_cvt_pk_bf16_f32 v188, v176, v177
  v_cvt_pk_bf16_f32 v190, v180, v181
  v_mfma_f32_16x16x32_bf16 v[136:139], a[108:111], a[12:15], v[136:139]
  v_cvt_pk_bf16_f32 v189, v178, v179
  v_cvt_pk_bf16_f32 v191, v182, v183
  v_mfma_f32_16x16x32_bf16 v[140:143], a[108:111], a[36:39], v[140:143]
  v_permlane16_swap_b32 v188, v190
  v_mfma_f32_16x16x32_bf16 v[136:139], a[112:115], a[16:19], v[136:139]
  v_permlane16_swap_b32 v189, v191
  v_mfma_f32_16x16x32_bf16 v[140:143], a[112:115], a[40:43], v[140:143]
  v_add_f32 v197, v197, v173
  v_add_f32 v194, v194, v170
  v_mfma_f32_16x16x32_bf16 v[136:139], a[116:119], a[20:23], v[136:139]
  v_add_f32 v198, v198, v174
  v_add_f32 v195, v195, v171
  v_mfma_f32_16x16x32_bf16 v[140:143], a[116:119], a[44:47], v[140:143]
  v_add_f32 v232, v232, v236
  v_add_f32 v199, v199, v175
  v_mfma_f32_32x32x16_bf16 v[96:111], a[120:123], v[188:191], v[96:111]
  ds_read_b64_tr_b16 a[120:121], v247 offset:24576
  ds_read_b64_tr_b16 a[122:123], v249 offset:25088
  v_fma_f32 v168, v136, v220, v228
  v_fma_f32 v169, v137, v221, v228
  v_fma_f32 v170, v138, v222, v228
  v_fma_f32 v172, v140, v220, v229
  v_mfma_f32_32x32x16_bf16 a[176:191], a[124:127], v[188:191], a[176:191]
  ds_read_b64_tr_b16 a[124:125], v248 offset:24576
  ds_read_b64_tr_b16 a[126:127], v250 offset:25088
  v_fma_f32 v173, v141, v221, v229
  v_exp_f32 v168, v168
  v_fma_f32 v174, v142, v222, v229
  v_mfma_f32_32x32x16_bf16 a[192:207], a[128:131], v[188:191], a[192:207]
  ds_read_b64_tr_b16 a[128:129], v247 offset:26624
  ds_read_b64_tr_b16 a[130:131], v249 offset:27136
  v_exp_f32 v169, v169
  v_exp_f32 v172, v172
  v_mfma_f32_32x32x16_bf16 a[208:223], a[132:135], v[188:191], a[208:223]
  ds_read_b64_tr_b16 a[132:133], v248 offset:26624
  ds_read_b64_tr_b16 a[134:135], v250 offset:27136
  v_exp_f32 v173, v173
  v_fma_f32 v171, v139, v223, v228
  v_add_f32 v233, v233, v237
  v_mfma_f32_32x32x16_bf16 a[224:239], a[136:139], v[188:191], a[224:239]
  ds_read_b64_tr_b16 a[136:137], v247 offset:28672
  ds_read_b64_tr_b16 a[138:139], v249 offset:29184
  v_exp_f32 v170, v170
  v_add_f32 v236, v168, v169
  v_fma_f32 v175, v143, v223, v229
  v_mfma_f32_32x32x16_bf16 a[240:255], a[140:143], v[188:191], a[240:255]
  ds_read_b64_tr_b16 a[140:141], v248 offset:28672
  ds_read_b64_tr_b16 a[142:143], v250 offset:29184
  v_exp_f32 v174, v174
  v_exp_f32 v171, v171
  v_mfma_f32_16x16x32_bf16 v[144:147], a[96:99], a[48:51], v[160:163]
  v_add_f32 v237, v172, v173
  v_add_f32 v236, v236, v170
  v_mfma_f32_16x16x32_bf16 v[148:151], a[96:99], a[72:75], v[164:167]
  s_waitcnt vmcnt(6)
  ds_read_b128 a[96:99], v245 offset:18432
  v_mfma_f32_16x16x32_bf16 v[144:147], a[100:103], a[52:55], v[144:147]
  v_exp_f32 v175, v175
  v_mfma_f32_16x16x32_bf16 v[148:151], a[100:103], a[76:79], v[148:151]
  ds_read_b128 a[100:103], v246 offset:18432
  v_add_f32 v237, v237, v174
  v_mfma_f32_16x16x32_bf16 v[144:147], a[104:107], a[56:59], v[144:147]
  v_add_f32 v236, v236, v171
  v_add_f32 v237, v237, v175
  v_mfma_f32_16x16x32_bf16 v[148:151], a[104:107], a[80:83], v[148:151]
  ds_read_b128 a[104:107], v245 offset:20480
  v_max_f32 v253, v236, v237
  v_mfma_f32_16x16x32_bf16 v[144:147], a[108:111], a[60:63], v[144:147]
  v_cmp_lt_f32 vcc, s88, v253
  v_add_f32 v200, v200, v176
  v_mfma_f32_16x16x32_bf16 v[148:151], a[108:111], a[84:87], v[148:151]
  s_waitcnt lgkmcnt(3)
  buffer_load_dwordx4 v251, s[8:11], s68 offen offset:384 nt lds
  v_mfma_f32_16x16x32_bf16 v[144:147], a[112:115], a[64:67], v[144:147]
  s_add_u32 m0, s37, 25216
  ds_read_b128 a[108:111], v246 offset:20480
  v_mfma_f32_16x16x32_bf16 v[148:151], a[112:115], a[88:91], v[148:151]
  ds_read_b128 a[112:115], v245 offset:22528
  v_add_f32 v201, v201, v177
  v_mfma_f32_16x16x32_bf16 v[144:147], a[116:119], a[68:71], v[144:147]
  s_cbranch_vccnz L_tr_6_0
L_ret_6_0:
  v_mfma_f32_16x16x32_bf16 v[148:151], a[116:119], a[92:95], v[148:151]
  ds_read_b128 a[116:119], v246 offset:22528
  s_waitcnt lgkmcnt(4)
  v_mfma_f32_16x16x32_bf16 v[208:211], a[96:99], a[96:99], 0
  v_mul_f32 v168, v168, v220
  v_mul_f32 v169, v169, v221
  v_mfma_f32_16x16x32_bf16 v[212:215], a[96:99], v[112:115], 0
  buffer_load_dwordx4 v252, s[8:11], s68 offen offset:384 nt lds
  v_mfma_f32_16x16x32_bf16 v[216:219], a[168:171], a[96:99], 0
  s_add_u32 m0, s37, 26112
  v_mul_f32 v172, v172, v220
  v_mfma_f32_16x16x32_bf16 v[208:211], a[100:103], a[100:103], v[208:211]
  v_mul_f32 v173, v173, v221
  v_mul_f32 v170, v170, v222
  v_mfma_f32_16x16x32_bf16 v[212:215], a[100:103], v[116:119], v[212:215]
  v_mul_f32 v171, v171, v223
  v_mul_f32 v174, v174, v222
  v_mfma_f32_16x16x32_bf16 v[216:219], a[168:171], a[100:103], v[216:219]
  v_mul_f32 v175, v175, v223
  s_waitcnt lgkmcnt(2)
  v_mfma_f32_16x16x32_bf16 v[208:211], a[104:107], a[104:107], v[208:211]
  v_cvt_pk_bf16_f32 v184, v168, v169
  v_cvt_pk_bf16_f32 v186, v172, v173
  v_mfma_f32_16x16x32_bf16 v[212:215], a[104:107], v[120:123], v[212:215]
  buffer_load_dwordx4 v251, s[8:11], s68 offen offset:512 nt lds
  v_mfma_f32_16x16x32_bf16 v[216:219], a[168:171], a[104:107], v[216:219]
  s_add_u32 m0, s37, 27136
  v_cvt_pk_bf16_f32 v185, v170, v171
  v_mfma_f32_16x16x32_bf16 v[208:211], a[108:111], a[108:111], v[208:211]
  v_cvt_pk_bf16_f32 v187, v174, v175
  v_add_f32 v204, v204, v180
  v_mfma_f32_16x16x32_bf16 v[212:215], a[108:111], v[124:127], v[212:215]
  v_permlane16_swap_b32 v184, v186
  v_mfma_f32_16x16x32_bf16 v[216:219], a[168:171], a[108:111], v[216:219]
  v_add_f32 v205, v205, v181
  s_waitcnt lgkmcnt(0)
  v_mfma_f32_16x16x32_bf16 v[208:211], a[112:115], a[112:115], v[208:211]
  v_permlane16_swap_b32 v185, v187
  v_mfma_f32_16x16x32_bf16 v[212:215], a[112:115], v[128:131], v[212:215]
  buffer_load_dwordx4 v252, s[8:11], s68 offen offset:512 nt lds
  v_mfma_f32_16x16x32_bf16 v[216:219], a[168:171], a[112:115], v[216:219]
  s_add_u32 m0, s37, 28032
  v_add_f32 v202, v202, v178
  v_mfma_f32_16x16x32_bf16 v[208:211], a[116:119], a[116:119], v[208:211]
  v_add_f32 v206, v206, v182
  v_fma_f32 v176, v144, v220, v230
  v_mfma_f32_16x16x32_bf16 v[212:215], a[116:119], v[132:135], v[212:215]
  v_fma_f32 v177, v145, v221, v230
  v_fma_f32 v180, v148, v220, v231
  v_mfma_f32_16x16x32_bf16 v[216:219], a[168:171], a[116:119], v[216:219]
  v_add_f32 v203, v203, v179
  v_fma_f32 v181, v149, v221, v231
  v_cndmask_b32 v242, v208, v209, s[48:49]
  v_cndmask_b32 v243, v210, v211, s[48:49]
  v_cndmask_b32 v242, v242, v243, s[50:51]
  v_mfma_f32_32x32x16_bf16 v[0:15], a[120:123], v[184:187], v[0:15]
  v_cndmask_b32 v243, v212, v213, s[48:49]
  v_cndmask_b32 v244, v214, v215, s[48:49]
  v_cndmask_b32 v243, v243, v244, s[50:51]
  v_fma_f32 v243, v243, 2.0, v240
  v_add_f32 v242, v242, v243
  v_add_f32 v207, v207, v183
  v_add_f32 v244, v216, v241
  v_fma_f32 v178, v146, v222, v230
  v_mul_f32 v244, v244, v244
  buffer_load_dwordx4 v251, s[8:11], s68 offen offset:640 nt lds
  v_mfma_f32_32x32x16_bf16 v[16:31], a[124:127], v[184:187], v[16:31]
  v_fma_f32 v242, v244, s89, v242
  v_fma_f32 v182, v150, v222, v231
  v_rsq_f32 v242, v242
  v_exp_f32 v176, v176
  v_mfma_f32_32x32x16_bf16 v[32:47], a[128:131], v[184:187], v[32:47]
  v_exp_f32 v177, v177
  v_exp_f32 v180, v180
  v_fma_f32 v179, v147, v223, v230
  v_add_f32 v234, v234, v238
  v_mfma_f32_32x32x16_bf16 v[48:63], a[132:135], v[184:187], v[48:63]
  v_exp_f32 v181, v181
  v_add_f32 v235, v235, v239
  v_fma_f32 v183, v151, v223, v231
  v_exp_f32 v178, v178
  v_mfma_f32_32x32x16_bf16 v[64:79], a[136:139], v[184:187], v[64:79]
  v_exp_f32 v182, v182
  v_exp_f32 v179, v179
  v_cndmask_b32 v242, 0, v242, s[52:53]
  v_add_f32 v238, v176, v177
  v_mfma_f32_32x32x16_bf16 v[80:95], a[140:143], v[184:187], v[80:95]
  v_add_f32 v239, v180, v181
  v_exp_f32 v183, v183
  v_add_f32 v238, v238, v178
  v_add_f32 v239, v239, v182
  v_add_f32 v238, v238, v179
  v_mfma_f32_16x16x4_f32 v[224:227], v242, a172, 0
  s_add_u32 m0, s37, 29056
  v_add_f32 v239, v239, v183
  buffer_load_dwordx4 v252, s[8:11], s68 offen offset:640 nt lds
  v_max_f32 v254, v238, v239
  v_mfma_f32_16x16x32_bf16 v[136:139], a[96:99], a[0:3], v[152:155]
  v_cmp_lt_f32 vcc, s88, v254
  s_add_u32 m0, s37, 18432
  v_mfma_f32_16x16x32_bf16 v[140:143], a[96:99], a[24:27], v[156:159]
  s_cbranch_vccnz L_tr_6_1
L_ret_6_1:
  v_mfma_f32_16x16x32_bf16 v[136:139], a[100:103], a[4:7], v[136:139]
  v_mul_f32 v176, v176, v220
  v_mul_f32 v177, v177, v221
  v_mfma_f32_16x16x32_bf16 v[140:143], a[100:103], a[28:31], v[140:143]
  v_mul_f32 v180, v180, v220
  v_mul_f32 v181, v181, v221
  v_mfma_f32_16x16x32_bf16 v[136:139], a[104:107], a[8:11], v[136:139]
  v_mul_f32 v178, v178, v222
  v_mul_f32 v179, v179, v223
  v_mfma_f32_16x16x32_bf16 v[140:143], a[104:107], a[32:35], v[140:143]
  v_mul_f32 v182, v182, v222
  v_mul_f32 v183, v183, v223
  v_mfma_f32_16x16x32_bf16 v[136:139], a[108:111], a[12:15], v[136:139]
  v_cvt_pk_bf16_f32 v188, v176, v177
  v_cvt_pk_bf16_f32 v190, v180, v181
  v_mfma_f32_16x16x32_bf16 v[140:143], a[108:111], a[36:39], v[140:143]
  v_cvt_pk_bf16_f32 v189, v178, v179
  v_cvt_pk_bf16_f32 v191, v182, v183
  v_mfma_f32_16x16x32_bf16 v[136:139], a[112:115], a[16:19], v[136:139]
  v_permlane16_swap_b32 v188, v190
  v_mfma_f32_16x16x32_bf16 v[140:143], a[112:115], a[40:43], v[140:143]
  v_permlane16_swap_b32 v189, v191
  v_mfma_f32_16x16x32_bf16 v[136:139], a[116:119], a[20:23], v[136:139]
  ds_read_b128 v[112:115], v245 offset:12288
  v_add_f32 v192, v192, v168
  v_mfma_f32_16x16x32_bf16 v[140:143], a[116:119], a[44:47], v[140:143]
  v_add_f32 v193, v193, v169
  v_add_f32 v196, v196, v172
  v_mfma_f32_32x32x16_bf16 v[96:111], a[120:123], v[188:191], v[96:111]
  ds_read_b64_tr_b16 a[120:121], v247 offset:18432
  ds_read_b64_tr_b16 a[122:123], v249 offset:18944
  ds_read_b128 v[116:119], v246 offset:12288
  v_add_f32 v197, v197, v173
  v_fma_f32 v168, v136, v224, v228
  v_fma_f32 v169, v137, v225, v228
  v_mfma_f32_32x32x16_bf16 a[176:191], a[124:127], v[188:191], a[176:191]
  ds_read_b64_tr_b16 a[124:125], v248 offset:18432
  ds_read_b64_tr_b16 a[126:127], v250 offset:18944
  v_add_f32 v194, v194, v170
  ds_read_b128 v[120:123], v245 offset:14336
  v_add_f32 v198, v198, v174
  v_add_f32 v195, v195, v171
  v_mfma_f32_32x32x16_bf16 a[192:207], a[128:131], v[188:191], a[192:207]
  ds_read_b64_tr_b16 a[128:129], v247 offset:20480
  ds_read_b64_tr_b16 a[130:131], v249 offset:20992
  v_fma_f32 v172, v140, v224, v229
  v_fma_f32 v173, v141, v225, v229
  ds_read_b128 v[124:127], v246 offset:14336
  v_fma_f32 v170, v138, v226, v228
  v_mfma_f32_32x32x16_bf16 a[208:223], a[132:135], v[188:191], a[208:223]
  ds_read_b64_tr_b16 a[132:133], v248 offset:20480
  ds_read_b64_tr_b16 a[134:135], v250 offset:20992
  v_exp_f32 v168, v168
  v_exp_f32 v169, v169
  v_mfma_f32_32x32x16_bf16 a[224:239], a[136:139], v[188:191], a[224:239]
  ds_read_b64_tr_b16 a[136:137], v247 offset:22528
  ds_read_b64_tr_b16 a[138:139], v249 offset:23040
  v_add_f32 v232, v232, v236
  v_fma_f32 v174, v142, v226, v229
  v_fma_f32 v171, v139, v227, v228
  ds_read_b128 v[128:131], v245 offset:16384
  v_mfma_f32_32x32x16_bf16 a[240:255], a[140:143], v[188:191], a[240:255]
  ds_read_b64_tr_b16 a[140:141], v248 offset:22528
  ds_read_b64_tr_b16 a[142:143], v250 offset:23040
  v_exp_f32 v172, v172
  v_exp_f32 v173, v173
  v_mfma_f32_16x16x32_bf16 v[144:147], a[96:99], a[48:51], v[160:163]
  v_add_f32 v199, v199, v175
  v_add_f32 v233, v233, v237
  v_mfma_f32_16x16x32_bf16 v[148:151], a[96:99], a[72:75], v[164:167]
  v_exp_f32 v170, v170
  v_mfma_f32_16x16x32_bf16 v[144:147], a[100:103], a[52:55], v[144:147]
  v_add_f32 v236, v168, v169
  v_fma_f32 v175, v143, v227, v229
  v_mfma_f32_16x16x32_bf16 v[148:151], a[100:103], a[76:79], v[148:151]
  v_exp_f32 v174, v174
  v_mfma_f32_16x16x32_bf16 v[144:147], a[104:107], a[56:59], v[144:147]
  v_exp_f32 v171, v171
  v_mfma_f32_16x16x32_bf16 v[148:151], a[104:107], a[80:83], v[148:151]
  v_add_f32 v237, v172, v173
  v_add_f32 v236, v236, v170
  v_mfma_f32_16x16x32_bf16 v[144:147], a[108:111], a[60:63], v[144:147]
  ds_read_b128 v[132:135], v246 offset:16384
  v_add_f32 v237, v237, v174
  v_mfma_f32_16x16x32_bf16 v[148:151], a[108:111], a[84:87], v[148:151]
  v_exp_f32 v175, v175
  s_waitcnt lgkmcnt(1)
  buffer_load_dwordx4 v251, s[8:11], s69 offen nt lds
  v_mfma_f32_16x16x32_bf16 v[144:147], a[112:115], a[64:67], v[144:147]
  s_add_u32 m0, s37, 19456
  v_add_f32 v236, v236, v171
  v_mfma_f32_16x16x32_bf16 v[148:151], a[112:115], a[88:91], v[148:151]
  v_add_f32 v237, v237, v175
  v_max_f32 v253, v236, v237
  v_mfma_f32_16x16x32_bf16 v[144:147], a[116:119], a[68:71], v[144:147]
  v_cmp_lt_f32 vcc, s88, v253
  v_add_f32 v200, v200, v176
  v_mfma_f32_16x16x32_bf16 v[148:151], a[116:119], a[92:95], v[148:151]
  s_cbranch_vccnz L_tr_7_0
L_ret_7_0:
  v_mfma_f32_16x16x32_bf16 v[152:155], v[112:115], a[0:3], 0
  s_waitcnt vmcnt(7)
  ds_read_b128 a[96:99], v245 offset:30720
  v_mfma_f32_16x16x32_bf16 v[156:159], v[112:115], a[24:27], 0
  buffer_load_dwordx4 v252, s[8:11], s69 offen nt lds
  v_mfma_f32_16x16x32_bf16 v[160:163], v[112:115], a[48:51], 0
  s_add_u32 m0, s37, 20352
  ds_read_b128 a[100:103], v246 offset:30720
  v_mfma_f32_16x16x32_bf16 v[164:167], v[112:115], a[72:75], 0
  ds_read_b128 a[104:107], v245 offset:32768
  v_mul_f32 v168, v168, v224
  v_mfma_f32_16x16x32_bf16 v[152:155], v[116:119], a[4:7], v[152:155]
  v_mul_f32 v169, v169, v225
  v_mul_f32 v172, v172, v224
  v_mfma_f32_16x16x32_bf16 v[156:159], v[116:119], a[28:31], v[156:159]
  v_mul_f32 v173, v173, v225
  v_mul_f32 v170, v170, v226
  v_mfma_f32_16x16x32_bf16 v[160:163], v[116:119], a[52:55], v[160:163]
  v_mul_f32 v171, v171, v227
  v_mul_f32 v174, v174, v226
  v_mfma_f32_16x16x32_bf16 v[164:167], v[116:119], a[76:79], v[164:167]
  buffer_load_dwordx4 v251, s[8:11], s69 offen offset:128 nt lds
  v_mfma_f32_16x16x32_bf16 v[152:155], v[120:123], a[8:11], v[152:155]
  s_add_u32 m0, s37, 21376
  v_mul_f32 v175, v175, v227
  v_mfma_f32_16x16x32_bf16 v[156:159], v[120:123], a[32:35], v[156:159]
  ds_read_b128 a[108:111], v246 offset:32768
  ds_read_b128 a[112:115], v245 offset:34816
  v_mfma_f32_16x16x32_bf16 v[160:163], v[120:123], a[56:59], v[160:163]
  v_cvt_pk_bf16_f32 v184, v168, v169
  v_cvt_pk_bf16_f32 v186, v172, v173
  v_mfma_f32_16x16x32_bf16 v[164:167], v[120:123], a[80:83], v[164:167]
  v_cvt_pk_bf16_f32 v185, v170, v171
  v_cvt_pk_bf16_f32 v187, v174, v175
  v_mfma_f32_16x16x32_bf16 v[152:155], v[124:127], a[12:15], v[152:155]
  ds_read_b128 a[116:119], v246 offset:34816
  v_add_f32 v201, v201, v177
  v_mfma_f32_16x16x32_bf16 v[156:159], v[124:127], a[36:39], v[156:159]
  buffer_load_dwordx4 v252, s[8:11], s69 offen offset:128 nt lds
  v_mfma_f32_16x16x32_bf16 v[160:163], v[124:127], a[60:63], v[160:163]
  s_add_u32 m0, s37, 22272
  ds_read_b64 v[240:241], v245 offset:36872
  v_mfma_f32_16x16x32_bf16 v[164:167], v[124:127], a[84:87], v[164:167]
  v_add_f32 v204, v204, v180
  v_add_f32 v205, v205, v181
  v_mfma_f32_16x16x32_bf16 v[152:155], v[128:131], a[16:19], v[152:155]
  v_permlane16_swap_b32 v184, v186
  v_mfma_f32_16x16x32_bf16 v[156:159], v[128:131], a[40:43], v[156:159]
  v_permlane16_swap_b32 v185, v187
  v_mfma_f32_16x16x32_bf16 v[160:163], v[128:131], a[64:67], v[160:163]
  v_fma_f32 v176, v144, v224, v230
  v_fma_f32 v177, v145, v225, v230
  v_mfma_f32_16x16x32_bf16 v[164:167], v[128:131], a[88:91], v[164:167]
  buffer_load_dwordx4 v251, s[8:11], s69 offen offset:256 nt lds
  s_waitcnt lgkmcnt(2)
  v_mfma_f32_16x16x32_bf16 v[152:155], v[132:135], a[20:23], v[152:155]
  s_add_u32 m0, s37, 23296
  v_add_f32 v202, v202, v178
  v_mfma_f32_16x16x32_bf16 v[156:159], v[132:135], a[44:47], v[156:159]
  v_add_f32 v206, v206, v182
  v_add_f32 v203, v203, v179
  v_mfma_f32_16x16x32_bf16 v[160:163], v[132:135], a[68:71], v[160:163]
  v_fma_f32 v180, v148, v224, v231
  v_fma_f32 v181, v149, v225, v231
  v_mfma_f32_16x16x32_bf16 v[164:167], v[132:135], a[92:95], v[164:167]
  v_exp_f32 v176, v176
  v_mfma_f32_16x16x32_bf16 v[208:211], a[96:99], a[96:99], 0
  v_exp_f32 v177, v177
  buffer_load_dwordx4 v252, s[8:11], s69 offen offset:256 nt lds
  v_mfma_f32_16x16x32_bf16 v[212:215], a[96:99], v[112:115], 0
  s_add_u32 m0, s37, 6144
  v_fma_f32 v178, v146, v226, v230
  v_mfma_f32_16x16x32_bf16 v[216:219], a[168:171], a[96:99], 0
  v_add_f32 v234, v234, v238
  v_add_f32 v207, v207, v183
  v_mfma_f32_16x16x32_bf16 v[208:211], a[100:103], a[100:103], v[208:211]
  v_fma_f32 v182, v150, v226, v231
  v_fma_f32 v179, v147, v227, v230
  v_mfma_f32_16x16x32_bf16 v[212:215], a[100:103], v[116:119], v[212:215]
  v_exp_f32 v180, v180
  v_mfma_f32_16x16x32_bf16 v[216:219], a[168:171], a[100:103], v[216:219]
  v_exp_f32 v181, v181
  v_mfma_f32_16x16x32_bf16 v[208:211], a[104:107], a[104:107], v[208:211]
  buffer_load_dwordx4 v255, s[32:35], s40 offen lds
  v_mfma_f32_16x16x32_bf16 v[212:215], a[104:107], v[120:123], v[212:215]
  v_exp_f32 v178, v178
  v_mfma_f32_16x16x32_bf16 v[216:219], a[168:171], a[104:107], v[216:219]
  v_add_f32 v235, v235, v239
  v_add_f32 v238, v176, v177
  v_mfma_f32_16x16x32_bf16 v[208:211], a[108:111], a[108:111], v[208:211]
  v_fma_f32 v183, v151, v227, v231
  v_add_f32 v239, v180, v181
  v_mfma_f32_16x16x32_bf16 v[212:215], a[108:111], v[124:127], v[212:215]
  v_exp_f32 v182, v182
  v_mfma_f32_16x16x32_bf16 v[216:219], a[168:171], a[108:111], v[216:219]
  v_exp_f32 v179, v179
  v_mfma_f32_16x16x32_bf16 v[208:211], a[112:115], a[112:115], v[208:211]
  buffer_load_dwordx4 v255, s[32:35], s40 offen offset:1024 lds
  v_mfma_f32_16x16x32_bf16 v[212:215], a[112:115], v[128:131], v[212:215]
  v_add_f32 v238, v238, v178
  v_add_f32 v239, v239, v182
  v_mfma_f32_16x16x32_bf16 v[216:219], a[168:171], a[112:115], v[216:219]
  v_add_f32 v238, v238, v179
  s_waitcnt lgkmcnt(0)
  v_mfma_f32_16x16x32_bf16 v[208:211], a[116:119], a[116:119], v[208:211]
  v_exp_f32 v183, v183
  v_mfma_f32_16x16x32_bf16 v[212:215], a[116:119], v[132:135], v[212:215]
  v_add_f32 v239, v239, v183
  v_max_f32 v254, v238, v239
  v_mfma_f32_16x16x32_bf16 v[216:219], a[168:171], a[116:119], v[216:219]
  v_cmp_lt_f32 vcc, s88, v254
  v_add_f32 v192, v192, v168
  v_mfma_f32_32x32x16_bf16 v[0:15], a[120:123], v[184:187], v[0:15]
  v_cndmask_b32 v242, v208, v209, s[48:49]
  v_cndmask_b32 v243, v210, v211, s[48:49]
  v_cndmask_b32 v242, v242, v243, s[50:51]
  v_cndmask_b32 v243, v212, v213, s[48:49]
  v_cndmask_b32 v244, v214, v215, s[48:49]
  v_cndmask_b32 v243, v243, v244, s[50:51]
  v_fma_f32 v243, v243, 2.0, v240
  v_add_f32 v242, v242, v243
  v_add_f32 v244, v216, v241
  v_mul_f32 v244, v244, v244
  buffer_load_dwordx4 v255, s[32:35], s40 offen offset:2048 lds
  v_mfma_f32_32x32x16_bf16 v[16:31], a[124:127], v[184:187], v[16:31]
  v_fma_f32 v242, v244, s89, v242
  v_rsq_f32 v242, v242
  s_cbranch_vccnz L_tr_7_1
L_ret_7_1:
  v_cndmask_b32 v242, 0, v242, s[52:53]
  v_mfma_f32_32x32x16_bf16 v[32:47], a[128:131], v[184:187], v[32:47]
  v_mul_f32 v176, v176, v224
  buffer_load_dwordx4 v255, s[32:35], s40 offen offset:3072 lds
  s_add_u32 s40, s40, 4096
  s_add_u32 m0, s37, 10240
  v_mfma_f32_32x32x16_bf16 v[48:63], a[132:135], v[184:187], v[48:63]
  v_mul_f32 v177, v177, v225
  v_mul_f32 v180, v180, v224
  v_mul_f32 v181, v181, v225
  v_mul_f32 v178, v178, v226
  v_mul_f32 v179, v179, v227
  v_mul_f32 v182, v182, v226
  v_mfma_f32_32x32x16_bf16 v[64:79], a[136:139], v[184:187], v[64:79]
  buffer_load_dwordx4 v255, s[32:35], s40 offen lds
  v_mul_f32 v183, v183, v227
  v_cvt_pk_bf16_f32 v188, v176, v177
  v_cvt_pk_bf16_f32 v190, v180, v181
  v_mfma_f32_32x32x16_bf16 v[80:95], a[140:143], v[184:187], v[80:95]
  v_cvt_pk_bf16_f32 v189, v178, v179
  v_cvt_pk_bf16_f32 v191, v182, v183
  v_permlane16_swap_b32 v188, v190
  v_add_f32 v193, v193, v169
  v_add_f32 v196, v196, v172
  v_mfma_f32_16x16x4_f32 v[220:223], v242, a172, 0
  buffer_load_dwordx4 v255, s[32:35], s40 offen offset:1024 lds
  s_add_u32 m0, s37, 30336
  v_permlane16_swap_b32 v189, v191
  v_mfma_f32_16x16x32_bf16 v[136:139], a[96:99], a[0:3], v[152:155]
  v_add_f32 v197, v197, v173
  v_add_f32 v194, v194, v170
  v_mfma_f32_16x16x32_bf16 v[140:143], a[96:99], a[24:27], v[156:159]
  v_add_f32 v195, v195, v171
  v_add_f32 v198, v198, v174
  v_mfma_f32_16x16x32_bf16 v[136:139], a[100:103], a[4:7], v[136:139]
  v_add_f32 v199, v199, v175
  v_cvt_pk_bf16_f32 v208, v192, v193
  v_mfma_f32_16x16x32_bf16 v[140:143], a[100:103], a[28:31], v[140:143]
  v_cvt_pk_bf16_f32 v210, v196, v197
  v_cvt_pk_bf16_f32 v209, v194, v195
  v_mfma_f32_16x16x32_bf16 v[136:139], a[104:107], a[8:11], v[136:139]
  v_cvt_pk_bf16_f32 v211, v198, v199
  v_add_f32 v200, v200, v176
  v_mfma_f32_16x16x32_bf16 v[140:143], a[104:107], a[32:35], v[140:143]
  v_permlane16_swap_b32 v208, v210
  v_mfma_f32_16x16x32_bf16 v[136:139], a[108:111], a[12:15], v[136:139]
  v_permlane16_swap_b32 v209, v211
  v_mfma_f32_16x16x32_bf16 v[140:143], a[108:111], a[36:39], v[140:143]
  v_add_f32 v201, v201, v177
  v_add_f32 v204, v204, v180
  v_mfma_f32_16x16x32_bf16 v[136:139], a[112:115], a[16:19], v[136:139]
  v_add_f32 v205, v205, v181
  v_add_f32 v202, v202, v178
  v_mfma_f32_16x16x32_bf16 v[140:143], a[112:115], a[40:43], v[140:143]
  v_add_f32 v203, v203, v179
  v_cvt_pk_bf16_f32 v212, v200, v201
  v_mfma_f32_16x16x32_bf16 v[136:139], a[116:119], a[20:23], v[136:139]
  v_cvt_pk_bf16_f32 v214, v204, v205
  v_add_f32 v206, v206, v182
  v_mfma_f32_16x16x32_bf16 v[140:143], a[116:119], a[44:47], v[140:143]
  v_add_f32 v207, v207, v183
  v_cvt_pk_bf16_f32 v213, v202, v203
  v_mfma_f32_32x32x16_bf16 v[96:111], a[120:123], v[188:191], v[96:111]
  ds_read_b64_tr_b16 a[120:121], v247 offset:30720
  ds_read_b64_tr_b16 a[122:123], v249 offset:31232
  v_cvt_pk_bf16_f32 v215, v206, v207
  v_permlane16_swap_b32 v212, v214
  v_fma_f32 v168, v136, v220, v228
  v_mfma_f32_32x32x16_bf16 a[176:191], a[124:127], v[188:191], a[176:191]
  ds_read_b64_tr_b16 a[124:125], v248 offset:30720
  ds_read_b64_tr_b16 a[126:127], v250 offset:31232
  v_permlane16_swap_b32 v213, v215
  v_fma_f32 v169, v137, v221, v228
  v_fma_f32 v172, v140, v220, v229
  v_mfma_f32_32x32x16_bf16 a[192:207], a[128:131], v[188:191], a[192:207]
  ds_read_b64_tr_b16 a[128:129], v247 offset:32768
  ds_read_b64_tr_b16 a[130:131], v249 offset:33280
  v_fma_f32 v173, v141, v221, v229
  v_exp_f32 v168, v168
  v_fma_f32 v170, v138, v222, v228
  v_mfma_f32_32x32x16_bf16 a[208:223], a[132:135], v[188:191], a[208:223]
  ds_read_b64_tr_b16 a[132:133], v248 offset:32768
  ds_read_b64_tr_b16 a[134:135], v250 offset:33280
  v_exp_f32 v169, v169
  v_add_f32 v232, v232, v236
  v_fma_f32 v174, v142, v222, v229
  v_mfma_f32_32x32x16_bf16 a[224:239], a[136:139], v[188:191], a[224:239]
  ds_read_b64_tr_b16 a[136:137], v247 offset:34816
  ds_read_b64_tr_b16 a[138:139], v249 offset:35328
  v_exp_f32 v172, v172
  v_exp_f32 v173, v173
  v_mfma_f32_32x32x16_bf16 a[240:255], a[140:143], v[188:191], a[240:255]
  ds_read_b64_tr_b16 a[140:141], v248 offset:34816
  ds_read_b64_tr_b16 a[142:143], v250 offset:35328
  v_exp_f32 v170, v170
  v_fma_f32 v171, v139, v223, v228
  v_add_f32 v233, v233, v237
  v_mfma_f32_16x16x32_bf16 v[144:147], a[96:99], a[48:51], v[160:163]
  v_add_f32 v236, v168, v169
  v_fma_f32 v175, v143, v223, v229
  v_mfma_f32_16x16x32_bf16 v[148:151], a[96:99], a[72:75], v[164:167]
  s_waitcnt vmcnt(12)
  ds_read_b128 a[96:99], v245 offset:24576
  v_mfma_f32_16x16x32_bf16 v[144:147], a[100:103], a[52:55], v[144:147]
  v_exp_f32 v174, v174
  v_mfma_f32_16x16x32_bf16 v[148:151], a[100:103], a[76:79], v[148:151]
  ds_read_b128 a[100:103], v246 offset:24576
  v_add_f32 v237, v172, v173
  v_mfma_f32_16x16x32_bf16 v[144:147], a[104:107], a[56:59], v[144:147]
  v_exp_f32 v171, v171
  v_mfma_f32_16x16x32_bf16 v[148:151], a[104:107], a[80:83], v[148:151]
  ds_read_b128 a[104:107], v245 offset:26624
  v_add_f32 v236, v236, v170
  v_mfma_f32_16x16x32_bf16 v[144:147], a[108:111], a[60:63], v[144:147]
  v_exp_f32 v175, v175
  v_mfma_f32_16x16x32_bf16 v[148:151], a[108:111], a[84:87], v[148:151]
  s_waitcnt lgkmcnt(3)
  buffer_load_dwordx4 v251, s[8:11], s69 offen offset:384 nt lds
  v_mfma_f32_16x16x32_bf16 v[144:147], a[112:115], a[64:67], v[144:147]
  s_add_u32 m0, s37, 31360
  ds_read_b128 a[108:111], v246 offset:26624
  v_mfma_f32_16x16x32_bf16 v[148:151], a[112:115], a[88:91], v[148:151]
  ds_read_b128 a[112:115], v245 offset:28672
  v_add_f32 v237, v237, v174
  v_mfma_f32_16x16x32_bf16 v[144:147], a[116:119], a[68:71], v[144:147]
  v_add_f32 v236, v236, v171
  v_add_f32 v237, v237, v175
  v_mfma_f32_16x16x32_bf16 v[148:151], a[116:119], a[92:95], v[148:151]
  v_max_f32 v253, v236, v237
  v_cmp_lt_f32 vcc, s88, v253
  v_mfma_f32_32x32x16_bf16 v[0:15], a[144:147], v[208:211], v[0:15]
  buffer_load_dwordx4 v252, s[8:11], s69 offen offset:384 nt lds
  s_add_u32 m0, s37, 32256
  ds_read_b128 a[116:119], v246 offset:28672
  v_fma_f32 v176, v144, v220, v230
  v_mfma_f32_32x32x16_bf16 v[16:31], a[148:151], v[208:211], v[16:31]
  v_fma_f32 v177, v145, v221, v230
  v_fma_f32 v180, v148, v220, v231
  v_fma_f32 v181, v149, v221, v231
  v_fma_f32 v178, v146, v222, v230
  v_fma_f32 v182, v150, v222, v231
  v_fma_f32 v179, v147, v223, v230
  v_mfma_f32_32x32x16_bf16 v[32:47], a[152:155], v[208:211], v[32:47]
  buffer_load_dwordx4 v251, s[8:11], s69 offen offset:512 nt lds
  s_add_u32 m0, s37, 33280
  v_exp_f32 v176, v176
  v_mfma_f32_32x32x16_bf16 v[48:63], a[156:159], v[208:211], v[48:63]
  v_exp_f32 v177, v177
  v_exp_f32 v180, v180
  v_exp_f32 v181, v181
  v_mfma_f32_32x32x16_bf16 v[64:79], a[160:163], v[208:211], v[64:79]
  buffer_load_dwordx4 v252, s[8:11], s69 offen offset:512 nt lds
  s_add_u32 m0, s37, 34176
  v_add_f32 v234, v234, v238
  v_add_f32 v235, v235, v239
  v_mfma_f32_32x32x16_bf16 v[80:95], a[164:167], v[208:211], v[80:95]
  s_cbranch_vccnz L_tr_8_0
L_ret_8_0:
  v_mul_f32 v192, v168, v220
  v_mul_f32 v193, v169, v221
  v_mul_f32 v196, v172, v220
  v_mul_f32 v197, v173, v221
  v_mfma_f32_32x32x16_bf16 v[96:111], a[144:147], v[212:215], v[96:111]
  buffer_load_dwordx4 v251, s[8:11], s69 offen offset:640 nt lds
  s_add_u32 m0, s37, 35200
  v_mul_f32 v194, v170, v222
  v_mul_f32 v195, v171, v223
  v_mfma_f32_32x32x16_bf16 a[176:191], a[148:151], v[212:215], a[176:191]
  v_mul_f32 v198, v174, v222
  v_mul_f32 v199, v175, v223
  v_cvt_pk_bf16_f32 v184, v192, v193
  v_cvt_pk_bf16_f32 v186, v196, v197
  v_cvt_pk_bf16_f32 v185, v194, v195
  v_cvt_pk_bf16_f32 v187, v198, v199
  v_mfma_f32_32x32x16_bf16 a[192:207], a[152:155], v[212:215], a[192:207]
  buffer_load_dwordx4 v252, s[8:11], s69 offen offset:640 nt lds
  s_add_u32 m0, s37, 24576
  v_permlane16_swap_b32 v184, v186
  v_mfma_f32_32x32x16_bf16 a[208:223], a[156:159], v[212:215], a[208:223]
  v_permlane16_swap_b32 v185, v187
  v_fma_f32 v183, v151, v223, v231
  v_exp_f32 v178, v178
  v_add_f32 v238, v176, v177
  v_mfma_f32_32x32x16_bf16 a[224:239], a[160:163], v[212:215], a[224:239]
  v_exp_f32 v182, v182
  v_exp_f32 v179, v179
  v_add_f32 v239, v180, v181
  v_add_f32 v238, v238, v178
  v_mfma_f32_32x32x16_bf16 a[240:255], a[164:167], v[212:215], a[240:255]
  v_exp_f32 v183, v183
  v_add_f32 v239, v239, v182
  v_add_f32 v238, v238, v179
  v_add_f32 v239, v239, v183
  s_waitcnt lgkmcnt(0)
  v_mfma_f32_16x16x32_bf16 v[208:211], a[96:99], a[96:99], 0
  v_max_f32 v254, v238, v239
  v_cmp_lt_f32 vcc, s88, v254
  v_mfma_f32_16x16x32_bf16 v[212:215], a[96:99], v[112:115], 0
  v_add_f32 v232, v232, v236
  v_add_f32 v233, v233, v237
  v_mfma_f32_16x16x32_bf16 v[216:219], a[168:171], a[96:99], 0
  s_cbranch_vccnz L_tr_8_1
L_ret_8_1:
  v_mfma_f32_16x16x32_bf16 v[208:211], a[100:103], a[100:103], v[208:211]
  v_mul_f32 v200, v176, v220
  v_mul_f32 v201, v177, v221
  v_mfma_f32_16x16x32_bf16 v[212:215], a[100:103], v[116:119], v[212:215]
  v_mul_f32 v204, v180, v220
  v_mul_f32 v205, v181, v221
  v_mfma_f32_16x16x32_bf16 v[216:219], a[168:171], a[100:103], v[216:219]
  v_mul_f32 v202, v178, v222
  v_mul_f32 v203, v179, v223
  v_mfma_f32_16x16x32_bf16 v[208:211], a[104:107], a[104:107], v[208:211]
  v_mul_f32 v206, v182, v222
  v_mul_f32 v207, v183, v223
  v_mfma_f32_16x16x32_bf16 v[212:215], a[104:107], v[120:123], v[212:215]
  v_cvt_pk_bf16_f32 v188, v200, v201
  v_cvt_pk_bf16_f32 v190, v204, v205
  v_mfma_f32_16x16x32_bf16 v[216:219], a[168:171], a[104:107], v[216:219]
  v_cvt_pk_bf16_f32 v189, v202, v203
  v_cvt_pk_bf16_f32 v191, v206, v207
  v_mfma_f32_16x16x32_bf16 v[208:211], a[108:111], a[108:111], v[208:211]
  v_permlane16_swap_b32 v188, v190
  v_mfma_f32_16x16x32_bf16 v[212:215], a[108:111], v[124:127], v[212:215]
  v_permlane16_swap_b32 v189, v191
  v_mfma_f32_16x16x32_bf16 v[216:219], a[168:171], a[108:111], v[216:219]
  v_add_f32 v234, v234, v238
  v_add_f32 v235, v235, v239
  v_mfma_f32_16x16x32_bf16 v[208:211], a[112:115], a[112:115], v[208:211]
  ds_read_b64_tr_b16 a[144:145], v247 offset:12288
  ds_read_b64_tr_b16 a[146:147], v249 offset:12800
  v_mfma_f32_16x16x32_bf16 v[212:215], a[112:115], v[128:131], v[212:215]
  ds_read_b64_tr_b16 a[148:149], v248 offset:12288
  ds_read_b64_tr_b16 a[150:151], v250 offset:12800
  v_mfma_f32_16x16x32_bf16 v[216:219], a[168:171], a[112:115], v[216:219]
  ds_read_b64_tr_b16 a[152:153], v247 offset:14336
  ds_read_b64_tr_b16 a[154:155], v249 offset:14848
  v_mfma_f32_16x16x32_bf16 v[208:211], a[116:119], a[116:119], v[208:211]
  ds_read_b64_tr_b16 a[156:157], v248 offset:14336
  ds_read_b64_tr_b16 a[158:159], v250 offset:14848
  v_mfma_f32_16x16x32_bf16 v[212:215], a[116:119], v[132:135], v[212:215]
  ds_read_b64_tr_b16 a[160:161], v247 offset:16384
  ds_read_b64_tr_b16 a[162:163], v249 offset:16896
  v_mfma_f32_16x16x32_bf16 v[216:219], a[168:171], a[116:119], v[216:219]
  ds_read_b64_tr_b16 a[164:165], v248 offset:16384
  ds_read_b64_tr_b16 a[166:167], v250 offset:16896
  v_cndmask_b32 v242, v208, v209, s[48:49]
  v_cndmask_b32 v243, v210, v211, s[48:49]
  v_cndmask_b32 v242, v242, v243, s[50:51]
  v_mfma_f32_32x32x16_bf16 v[0:15], a[120:123], v[184:187], v[0:15]
  v_cndmask_b32 v243, v212, v213, s[48:49]
  v_cndmask_b32 v244, v214, v215, s[48:49]
  v_cndmask_b32 v243, v243, v244, s[50:51]
  v_fma_f32 v243, v243, 2.0, v240
  v_add_f32 v242, v242, v243
  v_add_f32 v244, v216, v241
  v_mul_f32 v244, v244, v244
  v_mfma_f32_32x32x16_bf16 v[16:31], a[124:127], v[184:187], v[16:31]
  v_fma_f32 v242, v244, s89, v242
  v_rsq_f32 v242, v242
  v_mfma_f32_32x32x16_bf16 v[32:47], a[128:131], v[184:187], v[32:47]
  v_cndmask_b32 v242, 0, v242, s[52:53]
  v_mfma_f32_32x32x16_bf16 v[48:63], a[132:135], v[184:187], v[48:63]
  v_mfma_f32_32x32x16_bf16 v[64:79], a[136:139], v[184:187], v[64:79]
  v_mfma_f32_32x32x16_bf16 v[80:95], a[140:143], v[184:187], v[80:95]
  v_mfma_f32_16x16x4_f32 v[224:227], v242, a172, 0
  v_mfma_f32_16x16x32_bf16 v[136:139], a[96:99], a[0:3], v[152:155]
  v_mfma_f32_16x16x32_bf16 v[140:143], a[96:99], a[24:27], v[156:159]
  v_mfma_f32_16x16x32_bf16 v[136:139], a[100:103], a[4:7], v[136:139]
  v_mfma_f32_16x16x32_bf16 v[140:143], a[100:103], a[28:31], v[140:143]
  v_mfma_f32_16x16x32_bf16 v[136:139], a[104:107], a[8:11], v[136:139]
  v_mfma_f32_16x16x32_bf16 v[140:143], a[104:107], a[32:35], v[140:143]
  v_mfma_f32_16x16x32_bf16 v[136:139], a[108:111], a[12:15], v[136:139]
  v_mfma_f32_16x16x32_bf16 v[140:143], a[108:111], a[36:39], v[140:143]
  v_mfma_f32_16x16x32_bf16 v[136:139], a[112:115], a[16:19], v[136:139]
  v_mfma_f32_16x16x32_bf16 v[140:143], a[112:115], a[40:43], v[140:143]
  v_mfma_f32_16x16x32_bf16 v[136:139], a[116:119], a[20:23], v[136:139]
  v_mfma_f32_16x16x32_bf16 v[140:143], a[116:119], a[44:47], v[140:143]
  v_mfma_f32_32x32x16_bf16 v[96:111], a[120:123], v[188:191], v[96:111]
  ds_read_b64_tr_b16 a[120:121], v247 offset:24576
  ds_read_b64_tr_b16 a[122:123], v249 offset:25088
  v_mfma_f32_32x32x16_bf16 a[176:191], a[124:127], v[188:191], a[176:191]
  ds_read_b64_tr_b16 a[124:125], v248 offset:24576
  ds_read_b64_tr_b16 a[126:127], v250 offset:25088
  v_mfma_f32_32x32x16_bf16 a[192:207], a[128:131], v[188:191], a[192:207]
  ds_read_b64_tr_b16 a[128:129], v247 offset:26624
  ds_read_b64_tr_b16 a[130:131], v249 offset:27136
  v_fma_f32 v168, v136, v224, v228
  v_fma_f32 v169, v137, v225, v228
  v_fma_f32 v172, v140, v224, v229
  v_fma_f32 v173, v141, v225, v229
  v_mfma_f32_32x32x16_bf16 a[208:223], a[132:135], v[188:191], a[208:223]
  ds_read_b64_tr_b16 a[132:133], v248 offset:26624
  ds_read_b64_tr_b16 a[134:135], v250 offset:27136
  v_exp_f32 v168, v168
  v_exp_f32 v169, v169
  v_mfma_f32_32x32x16_bf16 a[224:239], a[136:139], v[188:191], a[224:239]
  ds_read_b64_tr_b16 a[136:137], v247 offset:28672
  ds_read_b64_tr_b16 a[138:139], v249 offset:29184
  v_fma_f32 v170, v138, v226, v228
  v_fma_f32 v174, v142, v226, v229
  v_fma_f32 v171, v139, v227, v228
  v_add_f32 v236, v168, v169
  v_mfma_f32_32x32x16_bf16 a[240:255], a[140:143], v[188:191], a[240:255]
  ds_read_b64_tr_b16 a[140:141], v248 offset:28672
  ds_read_b64_tr_b16 a[142:143], v250 offset:29184
  v_exp_f32 v172, v172
  v_exp_f32 v173, v173
  v_mfma_f32_16x16x32_bf16 v[144:147], a[96:99], a[48:51], v[160:163]
  v_exp_f32 v170, v170
  v_mfma_f32_16x16x32_bf16 v[148:151], a[96:99], a[72:75], v[164:167]
  s_waitcnt vmcnt(12)
  ds_read_b128 a[96:99], v245 offset:18432
  v_mfma_f32_16x16x32_bf16 v[144:147], a[100:103], a[52:55], v[144:147]
  v_exp_f32 v174, v174
  v_mfma_f32_16x16x32_bf16 v[148:151], a[100:103], a[76:79], v[148:151]
  ds_read_b128 a[100:103], v246 offset:18432
  v_fma_f32 v175, v143, v227, v229
  v_mfma_f32_16x16x32_bf16 v[144:147], a[104:107], a[56:59], v[144:147]
  v_exp_f32 v171, v171
  v_mfma_f32_16x16x32_bf16 v[148:151], a[104:107], a[80:83], v[148:151]
  ds_read_b128 a[104:107], v245 offset:20480
  v_add_f32 v237, v172, v173
  v_mfma_f32_16x16x32_bf16 v[144:147], a[108:111], a[60:63], v[144:147]
  v_add_f32 v236, v236, v170
  v_add_f32 v237, v237, v174
  v_mfma_f32_16x16x32_bf16 v[148:151], a[108:111], a[84:87], v[148:151]
  s_waitcnt lgkmcnt(3)
  buffer_load_dwordx4 v251, s[8:11], s70 offen nt lds
  v_mfma_f32_16x16x32_bf16 v[144:147], a[112:115], a[64:67], v[144:147]
  s_add_u32 m0, s37, 25600
  ds_read_b128 a[108:111], v246 offset:20480
  v_mfma_f32_16x16x32_bf16 v[148:151], a[112:115], a[88:91], v[148:151]
  ds_read_b128 a[112:115], v245 offset:22528
  v_add_f32 v236, v236, v171
  v_mfma_f32_16x16x32_bf16 v[144:147], a[116:119], a[68:71], v[144:147]
  v_exp_f32 v175, v175
  v_mfma_f32_16x16x32_bf16 v[148:151], a[116:119], a[92:95], v[148:151]
  v_add_f32 v237, v237, v175
  s_waitcnt lgkmcnt(3)
  v_mfma_f32_16x16x32_bf16 v[208:211], a[96:99], a[96:99], 0
  v_max_f32 v253, v236, v237
  v_cmp_lt_f32 vcc, s88, v253
  v_mfma_f32_16x16x32_bf16 v[212:215], a[96:99], v[112:115], 0
  buffer_load_dwordx4 v252, s[8:11], s70 offen nt lds
  v_mfma_f32_16x16x32_bf16 v[216:219], a[168:171], a[96:99], 0
  s_add_u32 m0, s37, 26496
  ds_read_b128 a[116:119], v246 offset:22528
  v_mfma_f32_16x16x32_bf16 v[208:211], a[100:103], a[100:103], v[208:211]
  s_cbranch_vccnz L_tr_9_0
L_ret_9_0:
  v_mfma_f32_16x16x32_bf16 v[212:215], a[100:103], v[116:119], v[212:215]
  v_mul_f32 v168, v168, v224
  v_mul_f32 v169, v169, v225
  v_mfma_f32_16x16x32_bf16 v[216:219], a[168:171], a[100:103], v[216:219]
  v_mul_f32 v172, v172, v224
  s_waitcnt lgkmcnt(2)
  v_mfma_f32_16x16x32_bf16 v[208:211], a[104:107], a[104:107], v[208:211]
  v_mul_f32 v173, v173, v225
  v_mul_f32 v170, v170, v226
  v_mfma_f32_16x16x32_bf16 v[212:215], a[104:107], v[120:123], v[212:215]
  buffer_load_dwordx4 v251, s[8:11], s70 offen offset:128 nt lds
  v_mfma_f32_16x16x32_bf16 v[216:219], a[168:171], a[104:107], v[216:219]
  s_add_u32 m0, s37, 27520
  v_mul_f32 v171, v171, v227
  v_mfma_f32_16x16x32_bf16 v[208:211], a[108:111], a[108:111], v[208:211]
  v_mul_f32 v174, v174, v226
  v_mul_f32 v175, v175, v227
  v_mfma_f32_16x16x32_bf16 v[212:215], a[108:111], v[124:127], v[212:215]
  v_cvt_pk_bf16_f32 v184, v168, v169
  v_cvt_pk_bf16_f32 v186, v172, v173
  v_mfma_f32_16x16x32_bf16 v[216:219], a[168:171], a[108:111], v[216:219]
  v_cvt_pk_bf16_f32 v185, v170, v171
  s_waitcnt lgkmcnt(0)
  v_mfma_f32_16x16x32_bf16 v[208:211], a[112:115], a[112:115], v[208:211]
  v_cvt_pk_bf16_f32 v187, v174, v175
  v_fma_f32 v176, v144, v224, v230
  v_mfma_f32_16x16x32_bf16 v[212:215], a[112:115], v[128:131], v[212:215]
  buffer_load_dwordx4 v252, s[8:11], s70 offen offset:128 nt lds
  v_mfma_f32_16x16x32_bf16 v[216:219], a[168:171], a[112:115], v[216:219]
  v_permlane16_swap_b32 v184, v186
  v_mfma_f32_16x16x32_bf16 v[208:211], a[116:119], a[116:119], v[208:211]
  v_permlane16_swap_b32 v185, v187
  v_mfma_f32_16x16x32_bf16 v[212:215], a[116:119], v[132:135], v[212:215]
  s_add_u32 m0, s37, 28416
  v_fma_f32 v177, v145, v225, v230
  v_mfma_f32_16x16x32_bf16 v[216:219], a[168:171], a[116:119], v[216:219]
  v_fma_f32 v180, v148, v224, v231
  v_fma_f32 v181, v149, v225, v231
  v_mfma_f32_32x32x16_bf16 v[0:15], a[120:123], v[184:187], v[0:15]
  v_cndmask_b32 v242, v208, v209, s[48:49]
  v_cndmask_b32 v243, v210, v211, s[48:49]
  v_cndmask_b32 v242, v242, v243, s[50:51]
  v_cndmask_b32 v243, v212, v213, s[48:49]
  v_cndmask_b32 v244, v214, v215, s[48:49]
  v_cndmask_b32 v243, v243, v244, s[50:51]
  v_fma_f32 v243, v243, 2.0, v240
  v_add_f32 v242, v242, v243
  v_add_f32 v244, v216, v241
  v_fma_f32 v178, v146, v226, v230
  v_mul_f32 v244, v244, v244
  buffer_load_dwordx4 v251, s[8:11], s70 offen offset:256 nt lds
  v_mfma_f32_32x32x16_bf16 v[16:31], a[124:127], v[184:187], v[16:31]
  v_fma_f32 v242, v244, s89, v242
  v_fma_f32 v182, v150, v226, v231
  v_rsq_f32 v242, v242
  v_exp_f32 v176, v176
  v_mfma_f32_32x32x16_bf16 v[32:47], a[128:131], v[184:187], v[32:47]
  v_exp_f32 v177, v177
  v_exp_f32 v180, v180
  v_fma_f32 v179, v147, v227, v230
  s_add_u32 m0, s37, 29440
  v_mfma_f32_32x32x16_bf16 v[48:63], a[132:135], v[184:187], v[48:63]
  v_exp_f32 v181, v181
  v_fma_f32 v183, v151, v227, v231
  v_exp_f32 v178, v178
  v_cndmask_b32 v242, 0, v242, s[52:53]
  v_mfma_f32_32x32x16_bf16 v[64:79], a[136:139], v[184:187], v[64:79]
  v_exp_f32 v182, v182
  v_exp_f32 v179, v179
  v_add_f32 v238, v176, v177
  v_add_f32 v239, v180, v181
  buffer_load_dwordx4 v252, s[8:11], s70 offen offset:256 nt lds
  v_mfma_f32_32x32x16_bf16 v[80:95], a[140:143], v[184:187], v[80:95]
  v_exp_f32 v183, v183
  v_add_f32 v238, v238, v178
  v_add_f32 v239, v239, v182
  v_add_f32 v238, v238, v179
  s_add_u32 m0, s37, 18048
  v_mfma_f32_16x16x4_f32 v[220:223], v242, a172, 0
  v_add_f32 v239, v239, v183
  v_max_f32 v254, v238, v239
  v_cmp_lt_f32 vcc, s88, v254
  v_add_f32 v192, v192, v168
  v_add_f32 v193, v193, v169
  v_add_f32 v196, v196, v172
  v_mfma_f32_16x16x32_bf16 v[136:139], a[96:99], a[0:3], v[152:155]
  s_cbranch_vccnz L_tr_9_1
L_ret_9_1:
  v_mfma_f32_16x16x32_bf16 v[140:143], a[96:99], a[24:27], v[156:159]
  v_mul_f32 v176, v176, v224
  v_mul_f32 v177, v177, v225
  v_mfma_f32_16x16x32_bf16 v[136:139], a[100:103], a[4:7], v[136:139]
  v_mul_f32 v180, v180, v224
  v_mul_f32 v181, v181, v225
  v_mfma_f32_16x16x32_bf16 v[140:143], a[100:103], a[28:31], v[140:143]
  v_mul_f32 v178, v178, v226
  v_mul_f32 v179, v179, v227
  v_mfma_f32_16x16x32_bf16 v[136:139], a[104:107], a[8:11], v[136:139]
  v_mul_f32 v182, v182, v226
  v_mul_f32 v183, v183, v227
  v_mfma_f32_16x16x32_bf16 v[140:143], a[104:107], a[32:35], v[140:143]
  v_cvt_pk_bf16_f32 v188, v176, v177
  v_cvt_pk_bf16_f32 v190, v180, v181
  v_mfma_f32_16x16x32_bf16 v[136:139], a[108:111], a[12:15], v[136:139]
  v_cvt_pk_bf16_f32 v189, v178, v179
  v_cvt_pk_bf16_f32 v191, v182, v183
  v_mfma_f32_16x16x32_bf16 v[140:143], a[108:111], a[36:39], v[140:143]
  v_permlane16_swap_b32 v188, v190
  v_mfma_f32_16x16x32_bf16 v[136:139], a[112:115], a[16:19], v[136:139]
  v_permlane16_swap_b32 v189, v191
  v_mfma_f32_16x16x32_bf16 v[140:143], a[112:115], a[40:43], v[140:143]
  v_add_f32 v197, v197, v173
  v_add_f32 v194, v194, v170
  v_mfma_f32_16x16x32_bf16 v[136:139], a[116:119], a[20:23], v[136:139]
  v_add_f32 v198, v198, v174
  v_add_f32 v195, v195, v171
  v_mfma_f32_16x16x32_bf16 v[140:143], a[116:119], a[44:47], v[140:143]
  v_add_f32 v232, v232, v236
  v_add_f32 v199, v199, v175
  v_mfma_f32_32x32x16_bf16 v[96:111], a[120:123], v[188:191], v[96:111]
  ds_read_b64_tr_b16 a[120:121], v247 offset:18432
  ds_read_b64_tr_b16 a[122:123], v249 offset:18944
  v_fma_f32 v168, v136, v220, v228
  v_fma_f32 v169, v137, v221, v228
  v_fma_f32 v170, v138, v222, v228
  v_fma_f32 v172, v140, v220, v229
  v_mfma_f32_32x32x16_bf16 a[176:191], a[124:127], v[188:191], a[176:191]
  ds_read_b64_tr_b16 a[124:125], v248 offset:18432
  ds_read_b64_tr_b16 a[126:127], v250 offset:18944
  v_fma_f32 v173, v141, v221, v229
  v_exp_f32 v168, v168
  v_fma_f32 v174, v142, v222, v229
  v_mfma_f32_32x32x16_bf16 a[192:207], a[128:131], v[188:191], a[192:207]
  ds_read_b64_tr_b16 a[128:129], v247 offset:20480
  ds_read_b64_tr_b16 a[130:131], v249 offset:20992
  v_exp_f32 v169, v169
  v_exp_f32 v172, v172
  v_mfma_f32_32x32x16_bf16 a[208:223], a[132:135], v[188:191], a[208:223]
  ds_read_b64_tr_b16 a[132:133], v248 offset:20480
  ds_read_b64_tr_b16 a[134:135], v250 offset:20992
  v_exp_f32 v173, v173
  v_fma_f32 v171, v139, v223, v228
  v_add_f32 v233, v233, v237
  v_mfma_f32_32x32x16_bf16 a[224:239], a[136:139], v[188:191], a[224:239]
  ds_read_b64_tr_b16 a[136:137], v247 offset:22528
  ds_read_b64_tr_b16 a[138:139], v249 offset:23040
  v_exp_f32 v170, v170
  v_add_f32 v236, v168, v169
  v_fma_f32 v175, v143, v223, v229
  v_mfma_f32_32x32x16_bf16 a[240:255], a[140:143], v[188:191], a[240:255]
  ds_read_b64_tr_b16 a[140:141], v248 offset:22528
  ds_read_b64_tr_b16 a[142:143], v250 offset:23040
  v_exp_f32 v174, v174
  v_exp_f32 v171, v171
  v_mfma_f32_16x16x32_bf16 v[144:147], a[96:99], a[48:51], v[160:163]
  v_add_f32 v237, v172, v173
  v_add_f32 v236, v236, v170
  v_mfma_f32_16x16x32_bf16 v[148:151], a[96:99], a[72:75], v[164:167]
  s_waitcnt vmcnt(6)
  ds_read_b128 a[96:99], v245 offset:30720
  v_mfma_f32_16x16x32_bf16 v[144:147], a[100:103], a[52:55], v[144:147]
  v_exp_f32 v175, v175
  v_mfma_f32_16x16x32_bf16 v[148:151], a[100:103], a[76:79], v[148:151]
  ds_read_b128 a[100:103], v246 offset:30720
  v_add_f32 v237, v237, v174
  v_mfma_f32_16x16x32_bf16 v[144:147], a[104:107], a[56:59], v[144:147]
  v_add_f32 v236, v236, v171
  v_add_f32 v237, v237, v175
  v_mfma_f32_16x16x32_bf16 v[148:151], a[104:107], a[80:83], v[148:151]
  ds_read_b128 a[104:107], v245 offset:32768
  v_max_f32 v253, v236, v237
  v_mfma_f32_16x16x32_bf16 v[144:147], a[108:111], a[60:63], v[144:147]
  v_cmp_lt_f32 vcc, s88, v253
  v_add_f32 v200, v200, v176
  v_mfma_f32_16x16x32_bf16 v[148:151], a[108:111], a[84:87], v[148:151]
  s_waitcnt lgkmcnt(3)
  buffer_load_dwordx4 v251, s[8:11], s70 offen offset:384 nt lds
  v_mfma_f32_16x16x32_bf16 v[144:147], a[112:115], a[64:67], v[144:147]
  s_add_u32 m0, s37, 19072
  ds_read_b128 a[108:111], v246 offset:32768
  v_mfma_f32_16x16x32_bf16 v[148:151], a[112:115], a[88:91], v[148:151]
  ds_read_b128 a[112:115], v245 offset:34816
  v_add_f32 v201, v201, v177
  v_mfma_f32_16x16x32_bf16 v[144:147], a[116:119], a[68:71], v[144:147]
  s_cbranch_vccnz L_tr_10_0
L_ret_10_0:
  v_mfma_f32_16x16x32_bf16 v[148:151], a[116:119], a[92:95], v[148:151]
  ds_read_b128 a[116:119], v246 offset:34816
  s_waitcnt lgkmcnt(4)
  v_mfma_f32_16x16x32_bf16 v[208:211], a[96:99], a[96:99], 0
  v_mul_f32 v168, v168, v220
  v_mul_f32 v169, v169, v221
  v_mfma_f32_16x16x32_bf16 v[212:215], a[96:99], v[112:115], 0
  buffer_load_dwordx4 v252, s[8:11], s70 offen offset:384 nt lds
  v_mfma_f32_16x16x32_bf16 v[216:219], a[168:171], a[96:99], 0
  s_add_u32 m0, s37, 19968
  v_mul_f32 v172, v172, v220
  v_mfma_f32_16x16x32_bf16 v[208:211], a[100:103], a[100:103], v[208:211]
  v_mul_f32 v173, v173, v221
  v_mul_f32 v170, v170, v222
  v_mfma_f32_16x16x32_bf16 v[212:215], a[100:103], v[116:119], v[212:215]
  v_mul_f32 v171, v171, v223
  v_mul_f32 v174, v174, v222
  v_mfma_f32_16x16x32_bf16 v[216:219], a[168:171], a[100:103], v[216:219]
  v_mul_f32 v175, v175, v223
  s_waitcnt lgkmcnt(2)
  v_mfma_f32_16x16x32_bf16 v[208:211], a[104:107], a[104:107], v[208:211]
  v_cvt_pk_bf16_f32 v184, v168, v169
  v_cvt_pk_bf16_f32 v186, v172, v173
  v_mfma_f32_16x16x32_bf16 v[212:215], a[104:107], v[120:123], v[212:215]
  buffer_load_dwordx4 v251, s[8:11], s70 offen offset:512 nt lds
  v_mfma_f32_16x16x32_bf16 v[216:219], a[168:171], a[104:107], v[216:219]
  s_add_u32 m0, s37, 20992
  v_cvt_pk_bf16_f32 v185, v170, v171
  v_mfma_f32_16x16x32_bf16 v[208:211], a[108:111], a[108:111], v[208:211]
  v_cvt_pk_bf16_f32 v187, v174, v175
  v_add_f32 v204, v204, v180
  v_mfma_f32_16x16x32_bf16 v[212:215], a[108:111], v[124:127], v[212:215]
  v_permlane16_swap_b32 v184, v186
  v_mfma_f32_16x16x32_bf16 v[216:219], a[168:171], a[108:111], v[216:219]
  v_add_f32 v205, v205, v181
  s_waitcnt lgkmcnt(0)
  v_mfma_f32_16x16x32_bf16 v[208:211], a[112:115], a[112:115], v[208:211]
  v_permlane16_swap_b32 v185, v187
  v_mfma_f32_16x16x32_bf16 v[212:215], a[112:115], v[128:131], v[212:215]
  buffer_load_dwordx4 v252, s[8:11], s70 offen offset:512 nt lds
  v_mfma_f32_16x16x32_bf16 v[216:219], a[168:171], a[112:115], v[216:219]
  s_add_u32 m0, s37, 21888
  v_add_f32 v202, v202, v178
  v_mfma_f32_16x16x32_bf16 v[208:211], a[116:119], a[116:119], v[208:211]
  v_add_f32 v206, v206, v182
  v_fma_f32 v176, v144, v220, v230
  v_mfma_f32_16x16x32_bf16 v[212:215], a[116:119], v[132:135], v[212:215]
  v_fma_f32 v177, v145, v221, v230
  v_fma_f32 v180, v148, v220, v231
  v_mfma_f32_16x16x32_bf16 v[216:219], a[168:171], a[116:119], v[216:219]
  v_add_f32 v203, v203, v179
  v_fma_f32 v181, v149, v221, v231
  v_cndmask_b32 v242, v208, v209, s[48:49]
  v_cndmask_b32 v243, v210, v211, s[48:49]
  v_cndmask_b32 v242, v242, v243, s[50:51]
  v_mfma_f32_32x32x16_bf16 v[0:15], a[120:123], v[184:187], v[0:15]
  v_cndmask_b32 v243, v212, v213, s[48:49]
  v_cndmask_b32 v244, v214, v215, s[48:49]
  v_cndmask_b32 v243, v243, v244, s[50:51]
  v_fma_f32 v243, v243, 2.0, v240
  v_add_f32 v242, v242, v243
  v_add_f32 v207, v207, v183
  v_add_f32 v244, v216, v241
  v_fma_f32 v178, v146, v222, v230
  v_mul_f32 v244, v244, v244
  buffer_load_dwordx4 v251, s[8:11], s70 offen offset:640 nt lds
  v_mfma_f32_32x32x16_bf16 v[16:31], a[124:127], v[184:187], v[16:31]
  v_fma_f32 v242, v244, s89, v242
  v_fma_f32 v182, v150, v222, v231
  v_rsq_f32 v242, v242
  v_exp_f32 v176, v176
  v_mfma_f32_32x32x16_bf16 v[32:47], a[128:131], v[184:187], v[32:47]
  v_exp_f32 v177, v177
  v_exp_f32 v180, v180
  v_fma_f32 v179, v147, v223, v230
  v_add_f32 v234, v234, v238
  v_mfma_f32_32x32x16_bf16 v[48:63], a[132:135], v[184:187], v[48:63]
  v_exp_f32 v181, v181
  v_add_f32 v235, v235, v239
  v_fma_f32 v183, v151, v223, v231
  v_exp_f32 v178, v178
  v_mfma_f32_32x32x16_bf16 v[64:79], a[136:139], v[184:187], v[64:79]
  v_exp_f32 v182, v182
  v_exp_f32 v179, v179
  v_cndmask_b32 v242, 0, v242, s[52:53]
  v_add_f32 v238, v176, v177
  v_mfma_f32_32x32x16_bf16 v[80:95], a[140:143], v[184:187], v[80:95]
  v_add_f32 v239, v180, v181
  v_exp_f32 v183, v183
  v_add_f32 v238, v238, v178
  v_add_f32 v239, v239, v182
  v_add_f32 v238, v238, v179
  v_mfma_f32_16x16x4_f32 v[224:227], v242, a172, 0
  s_add_u32 m0, s37, 22912
  v_add_f32 v239, v239, v183
  buffer_load_dwordx4 v252, s[8:11], s70 offen offset:640 nt lds
  v_max_f32 v254, v238, v239
  v_mfma_f32_16x16x32_bf16 v[136:139], a[96:99], a[0:3], v[152:155]
  v_cmp_lt_f32 vcc, s88, v254
  s_add_u32 m0, s37, 30720
  v_mfma_f32_16x16x32_bf16 v[140:143], a[96:99], a[24:27], v[156:159]
  s_cbranch_vccnz L_tr_10_1
L_ret_10_1:
  v_mfma_f32_16x16x32_bf16 v[136:139], a[100:103], a[4:7], v[136:139]
  v_mul_f32 v176, v176, v220
  v_mul_f32 v177, v177, v221
  v_mfma_f32_16x16x32_bf16 v[140:143], a[100:103], a[28:31], v[140:143]
  v_mul_f32 v180, v180, v220
  v_mul_f32 v181, v181, v221
  v_mfma_f32_16x16x32_bf16 v[136:139], a[104:107], a[8:11], v[136:139]
  v_mul_f32 v178, v178, v222
  v_mul_f32 v179, v179, v223
  v_mfma_f32_16x16x32_bf16 v[140:143], a[104:107], a[32:35], v[140:143]
  v_mul_f32 v182, v182, v222
  v_mul_f32 v183, v183, v223
  v_mfma_f32_16x16x32_bf16 v[136:139], a[108:111], a[12:15], v[136:139]
  v_cvt_pk_bf16_f32 v188, v176, v177
  v_cvt_pk_bf16_f32 v190, v180, v181
  v_mfma_f32_16x16x32_bf16 v[140:143], a[108:111], a[36:39], v[140:143]
  v_cvt_pk_bf16_f32 v189, v178, v179
  v_cvt_pk_bf16_f32 v191, v182, v183
  v_mfma_f32_16x16x32_bf16 v[136:139], a[112:115], a[16:19], v[136:139]
  v_permlane16_swap_b32 v188, v190
  v_mfma_f32_16x16x32_bf16 v[140:143], a[112:115], a[40:43], v[140:143]
  v_permlane16_swap_b32 v189, v191
  v_mfma_f32_16x16x32_bf16 v[136:139], a[116:119], a[20:23], v[136:139]
  ds_read_b128 v[112:115], v245 offset:0
  v_add_f32 v192, v192, v168
  v_mfma_f32_16x16x32_bf16 v[140:143], a[116:119], a[44:47], v[140:143]
  ds_read_b128 v[116:119], v246 offset:0
  v_add_f32 v193, v193, v169
  v_mfma_f32_32x32x16_bf16 v[96:111], a[120:123], v[188:191], v[96:111]
  ds_read_b64_tr_b16 a[120:121], v247 offset:30720
  ds_read_b64_tr_b16 a[122:123], v249 offset:31232
  v_add_f32 v196, v196, v172
  ds_read_b128 v[120:123], v245 offset:2048
  v_add_f32 v197, v197, v173
  v_fma_f32 v168, v136, v224, v228
  v_mfma_f32_32x32x16_bf16 a[176:191], a[124:127], v[188:191], a[176:191]
  ds_read_b64_tr_b16 a[124:125], v248 offset:30720
  ds_read_b64_tr_b16 a[126:127], v250 offset:31232
  v_fma_f32 v169, v137, v225, v228
  v_add_f32 v194, v194, v170
  ds_read_b128 v[124:127], v246 offset:2048
  v_add_f32 v198, v198, v174
  v_mfma_f32_32x32x16_bf16 a[192:207], a[128:131], v[188:191], a[192:207]
  ds_read_b64_tr_b16 a[128:129], v247 offset:32768
  ds_read_b64_tr_b16 a[130:131], v249 offset:33280
  v_add_f32 v195, v195, v171
  v_add_f32 v199, v199, v175
  v_fma_f32 v172, v140, v224, v229
  v_fma_f32 v173, v141, v225, v229
  v_mfma_f32_32x32x16_bf16 a[208:223], a[132:135], v[188:191], a[208:223]
  ds_read_b64_tr_b16 a[132:133], v248 offset:32768
  ds_read_b64_tr_b16 a[134:135], v250 offset:33280
  ds_read_b128 v[128:131], v245 offset:4096
  v_exp_f32 v168, v168
  v_fma_f32 v170, v138, v226, v228
  v_mfma_f32_32x32x16_bf16 a[224:239], a[136:139], v[188:191], a[224:239]
  ds_read_b64_tr_b16 a[136:137], v247 offset:34816
  ds_read_b64_tr_b16 a[138:139], v249 offset:35328
  v_exp_f32 v169, v169
  v_add_f32 v232, v232, v236
  v_fma_f32 v174, v142, v226, v229
  v_mfma_f32_32x32x16_bf16 a[240:255], a[140:143], v[188:191], a[240:255]
  ds_read_b64_tr_b16 a[140:141], v248 offset:34816
  ds_read_b64_tr_b16 a[142:143], v250 offset:35328
  v_fma_f32 v171, v139, v227, v228
  ds_read_b128 v[132:135], v246 offset:4096
  v_fma_f32 v175, v143, v227, v229
  v_add_f32 v233, v233, v237
  v_mfma_f32_16x16x32_bf16 v[144:147], a[96:99], a[48:51], v[160:163]
  v_exp_f32 v172, v172
  v_mfma_f32_16x16x32_bf16 v[148:151], a[96:99], a[72:75], v[164:167]
  v_exp_f32 v173, v173
  v_mfma_f32_16x16x32_bf16 v[144:147], a[100:103], a[52:55], v[144:147]
  v_exp_f32 v170, v170
  v_mfma_f32_16x16x32_bf16 v[148:151], a[100:103], a[76:79], v[148:151]
  v_add_f32 v236, v168, v169
  v_add_f32 v237, v172, v173
  v_mfma_f32_16x16x32_bf16 v[144:147], a[104:107], a[56:59], v[144:147]
  v_exp_f32 v174, v174
  v_mfma_f32_16x16x32_bf16 v[148:151], a[104:107], a[80:83], v[148:151]
  v_exp_f32 v171, v171
  v_mfma_f32_16x16x32_bf16 v[144:147], a[108:111], a[60:63], v[144:147]
  v_exp_f32 v175, v175
  v_mfma_f32_16x16x32_bf16 v[148:151], a[108:111], a[84:87], v[148:151]
  s_waitcnt lgkmcnt(1)
  buffer_load_dwordx4 v251, s[8:11], s71 offen nt lds
  v_mfma_f32_16x16x32_bf16 v[144:147], a[112:115], a[64:67], v[144:147]
  s_add_u32 m0, s37, 31744
  v_add_f32 v236, v236, v170
  v_mfma_f32_16x16x32_bf16 v[148:151], a[112:115], a[88:91], v[148:151]
  v_add_f32 v237, v237, v174
  v_add_f32 v236, v236, v171
  v_mfma_f32_16x16x32_bf16 v[144:147], a[116:119], a[68:71], v[144:147]
  s_waitcnt vmcnt(7)
  ds_read_b128 a[96:99], v245 offset:24576
  v_mfma_f32_16x16x32_bf16 v[148:151], a[116:119], a[92:95], v[148:151]
  v_add_f32 v237, v237, v175
  v_max_f32 v253, v236, v237
  v_mfma_f32_16x16x32_bf16 v[152:155], v[112:115], a[0:3], 0
  v_cmp_lt_f32 vcc, s88, v253
  ds_read_b128 a[100:103], v246 offset:24576
  v_mfma_f32_16x16x32_bf16 v[156:159], v[112:115], a[24:27], 0
  buffer_load_dwordx4 v252, s[8:11], s71 offen nt lds
  v_mfma_f32_16x16x32_bf16 v[160:163], v[112:115], a[48:51], 0
  s_add_u32 m0, s37, 32640
  ds_read_b128 a[104:107], v245 offset:26624
  v_mfma_f32_16x16x32_bf16 v[164:167], v[112:115], a[72:75], 0
  s_cbranch_vccnz L_tr_11_0
L_ret_11_0:
  v_mfma_f32_16x16x32_bf16 v[152:155], v[116:119], a[4:7], v[152:155]
  ds_read_b128 a[108:111], v246 offset:26624
  v_mul_f32 v168, v168, v224
  v_mfma_f32_16x16x32_bf16 v[156:159], v[116:119], a[28:31], v[156:159]
  v_mul_f32 v169, v169, v225
  v_mul_f32 v172, v172, v224
  v_mfma_f32_16x16x32_bf16 v[160:163], v[116:119], a[52:55], v[160:163]
  v_mul_f32 v173, v173, v225
  v_mul_f32 v170, v170, v226
  v_mfma_f32_16x16x32_bf16 v[164:167], v[116:119], a[76:79], v[164:167]
  buffer_load_dwordx4 v251, s[8:11], s71 offen offset:128 nt lds
  v_mfma_f32_16x16x32_bf16 v[152:155], v[120:123], a[8:11], v[152:155]
  s_add_u32 m0, s37, 33664
  v_mul_f32 v171, v171, v227
  v_mfma_f32_16x16x32_bf16 v[156:159], v[120:123], a[32:35], v[156:159]
  v_mul_f32 v174, v174, v226
  v_mul_f32 v175, v175, v227
  v_mfma_f32_16x16x32_bf16 v[160:163], v[120:123], a[56:59], v[160:163]
  ds_read_b128 a[112:115], v245 offset:28672
  v_cvt_pk_bf16_f32 v184, v168, v169
  v_mfma_f32_16x16x32_bf16 v[164:167], v[120:123], a[80:83], v[164:167]
  v_cvt_pk_bf16_f32 v186, v172, v173
  v_cvt_pk_bf16_f32 v185, v170, v171
  v_mfma_f32_16x16x32_bf16 v[152:155], v[124:127], a[12:15], v[152:155]
  v_cvt_pk_bf16_f32 v187, v174, v175
  ds_read_b128 a[116:119], v246 offset:28672
  v_mfma_f32_16x16x32_bf16 v[156:159], v[124:127], a[36:39], v[156:159]
  buffer_load_dwordx4 v252, s[8:11], s71 offen offset:128 nt lds
  v_mfma_f32_16x16x32_bf16 v[160:163], v[124:127], a[60:63], v[160:163]
  s_add_u32 m0, s37, 34560
  v_add_f32 v200, v200, v176
  v_mfma_f32_16x16x32_bf16 v[164:167], v[124:127], a[84:87], v[164:167]
  v_add_f32 v201, v201, v177
  ds_read_b64 v[240:241], v246 offset:36864
  v_mfma_f32_16x16x32_bf16 v[152:155], v[128:131], a[16:19], v[152:155]
  v_permlane16_swap_b32 v184, v186
  v_mfma_f32_16x16x32_bf16 v[156:159], v[128:131], a[40:43], v[156:159]
  v_permlane16_swap_b32 v185, v187
  v_mfma_f32_16x16x32_bf16 v[160:163], v[128:131], a[64:67], v[160:163]
  v_add_f32 v204, v204, v180
  v_add_f32 v205, v205, v181
  v_mfma_f32_16x16x32_bf16 v[164:167], v[128:131], a[88:91], v[164:167]
  buffer_load_dwordx4 v251, s[8:11], s71 offen offset:256 nt lds
  s_waitcnt lgkmcnt(2)
  v_mfma_f32_16x16x32_bf16 v[152:155], v[132:135], a[20:23], v[152:155]
  s_add_u32 m0, s37, 35584
  v_fma_f32 v176, v144, v224, v230
  v_mfma_f32_16x16x32_bf16 v[156:159], v[132:135], a[44:47], v[156:159]
  v_fma_f32 v177, v145, v225, v230
  v_add_f32 v202, v202, v178
  v_mfma_f32_16x16x32_bf16 v[160:163], v[132:135], a[68:71], v[160:163]
  v_add_f32 v206, v206, v182
  v_add_f32 v203, v203, v179
  v_mfma_f32_16x16x32_bf16 v[164:167], v[132:135], a[92:95], v[164:167]
  v_fma_f32 v180, v148, v224, v231
  v_fma_f32 v181, v149, v225, v231
  v_mfma_f32_16x16x32_bf16 v[208:211], a[96:99], a[96:99], 0
  v_exp_f32 v176, v176
  buffer_load_dwordx4 v252, s[8:11], s71 offen offset:256 nt lds
  v_mfma_f32_16x16x32_bf16 v[212:215], a[96:99], v[112:115], 0
  s_add_u32 m0, s37, 12288
  v_fma_f32 v178, v146, v226, v230
  v_mfma_f32_16x16x32_bf16 v[216:219], a[168:171], a[96:99], 0
  v_exp_f32 v177, v177
  v_mfma_f32_16x16x32_bf16 v[208:211], a[100:103], a[100:103], v[208:211]
  v_add_f32 v234, v234, v238
  v_add_f32 v207, v207, v183
  v_mfma_f32_16x16x32_bf16 v[212:215], a[100:103], v[116:119], v[212:215]
  v_fma_f32 v182, v150, v226, v231
  v_fma_f32 v179, v147, v227, v230
  v_mfma_f32_16x16x32_bf16 v[216:219], a[168:171], a[100:103], v[216:219]
  v_exp_f32 v180, v180
  v_mfma_f32_16x16x32_bf16 v[208:211], a[104:107], a[104:107], v[208:211]
  buffer_load_dwordx4 v255, s[32:35], s41 offen lds
  v_mfma_f32_16x16x32_bf16 v[212:215], a[104:107], v[120:123], v[212:215]
  v_exp_f32 v181, v181
  v_mfma_f32_16x16x32_bf16 v[216:219], a[168:171], a[104:107], v[216:219]
  v_exp_f32 v178, v178
  v_mfma_f32_16x16x32_bf16 v[208:211], a[108:111], a[108:111], v[208:211]
  v_add_f32 v235, v235, v239
  v_add_f32 v238, v176, v177
  v_mfma_f32_16x16x32_bf16 v[212:215], a[108:111], v[124:127], v[212:215]
  v_fma_f32 v183, v151, v227, v231
  v_add_f32 v239, v180, v181
  v_mfma_f32_16x16x32_bf16 v[216:219], a[168:171], a[108:111], v[216:219]
  v_exp_f32 v182, v182
  v_mfma_f32_16x16x32_bf16 v[208:211], a[112:115], a[112:115], v[208:211]
  buffer_load_dwordx4 v255, s[32:35], s41 offen offset:1024 lds
  v_mfma_f32_16x16x32_bf16 v[212:215], a[112:115], v[128:131], v[212:215]
  v_exp_f32 v179, v179
  v_mfma_f32_16x16x32_bf16 v[216:219], a[168:171], a[112:115], v[216:219]
  v_add_f32 v238, v238, v178
  s_waitcnt lgkmcnt(0)
  v_mfma_f32_16x16x32_bf16 v[208:211], a[116:119], a[116:119], v[208:211]
  v_exp_f32 v183, v183
  v_mfma_f32_16x16x32_bf16 v[212:215], a[116:119], v[132:135], v[212:215]
  v_add_f32 v239, v239, v182
  v_add_f32 v238, v238, v179
  v_mfma_f32_16x16x32_bf16 v[216:219], a[168:171], a[116:119], v[216:219]
  v_add_f32 v239, v239, v183
  v_max_f32 v254, v238, v239
  v_mfma_f32_32x32x16_bf16 v[0:15], a[120:123], v[184:187], v[0:15]
  v_cndmask_b32 v242, v208, v209, s[48:49]
  v_cndmask_b32 v243, v210, v211, s[48:49]
  v_cndmask_b32 v242, v242, v243, s[50:51]
  v_cndmask_b32 v243, v212, v213, s[48:49]
  v_cndmask_b32 v244, v214, v215, s[48:49]
  v_cndmask_b32 v243, v243, v244, s[50:51]
  v_fma_f32 v243, v243, 2.0, v240
  v_add_f32 v242, v242, v243
  v_add_f32 v244, v216, v241
  v_mul_f32 v244, v244, v244
  buffer_load_dwordx4 v255, s[32:35], s41 offen offset:2048 lds
  v_mfma_f32_32x32x16_bf16 v[16:31], a[124:127], v[184:187], v[16:31]
  v_fma_f32 v242, v244, s89, v242
  v_rsq_f32 v242, v242
  v_cmp_lt_f32 vcc, s88, v254
  v_cndmask_b32 v242, 0, v242, s[52:53]
  v_add_f32 v192, v192, v168
  v_mfma_f32_32x32x16_bf16 v[32:47], a[128:131], v[184:187], v[32:47]
  s_cbranch_vccnz L_tr_11_1
L_ret_11_1:
  buffer_load_dwordx4 v255, s[32:35], s41 offen offset:3072 lds
  s_add_u32 s41, s41, 4096
  v_mfma_f32_32x32x16_bf16 v[48:63], a[132:135], v[184:187], v[48:63]
  s_add_u32 m0, s37, 16384
  v_mul_f32 v176, v176, v224
  v_mul_f32 v177, v177, v225
  v_mul_f32 v180, v180, v224
  v_mul_f32 v181, v181, v225
  v_mul_f32 v178, v178, v226
  v_mfma_f32_32x32x16_bf16 v[64:79], a[136:139], v[184:187], v[64:79]
  buffer_load_dwordx4 v255, s[32:35], s41 offen lds
  v_mul_f32 v179, v179, v227
  v_mul_f32 v182, v182, v226
  v_mul_f32 v183, v183, v227
  v_mfma_f32_32x32x16_bf16 v[80:95], a[140:143], v[184:187], v[80:95]
  v_cvt_pk_bf16_f32 v188, v176, v177
  v_cvt_pk_bf16_f32 v190, v180, v181
  v_cvt_pk_bf16_f32 v189, v178, v179
  v_cvt_pk_bf16_f32 v191, v182, v183
  v_permlane16_swap_b32 v188, v190
  v_mfma_f32_16x16x4_f32 v[220:223], v242, a172, 0
  buffer_load_dwordx4 v255, s[32:35], s41 offen offset:1024 lds
  s_add_u32 m0, s37, 24192
  v_permlane16_swap_b32 v189, v191
  v_mfma_f32_16x16x32_bf16 v[136:139], a[96:99], a[0:3], v[152:155]
  v_add_f32 v193, v193, v169
  v_add_f32 v196, v196, v172
  v_mfma_f32_16x16x32_bf16 v[140:143], a[96:99], a[24:27], v[156:159]
  v_add_f32 v197, v197, v173
  v_add_f32 v194, v194, v170
  v_mfma_f32_16x16x32_bf16 v[136:139], a[100:103], a[4:7], v[136:139]
  v_add_f32 v195, v195, v171
  v_add_f32 v198, v198, v174
  v_mfma_f32_16x16x32_bf16 v[140:143], a[100:103], a[28:31], v[140:143]
  v_add_f32 v199, v199, v175
  v_cvt_pk_bf16_f32 v208, v192, v193
  v_mfma_f32_16x16x32_bf16 v[136:139], a[104:107], a[8:11], v[136:139]
  v_cvt_pk_bf16_f32 v210, v196, v197
  v_cvt_pk_bf16_f32 v209, v194, v195
  v_mfma_f32_16x16x32_bf16 v[140:143], a[104:107], a[32:35], v[140:143]
  v_cvt_pk_bf16_f32 v211, v198, v199
  v_add_f32 v200, v200, v176
  v_mfma_f32_16x16x32_bf16 v[136:139], a[108:111], a[12:15], v[136:139]
  v_permlane16_swap_b32 v208, v210
  v_mfma_f32_16x16x32_bf16 v[140:143], a[108:111], a[36:39], v[140:143]
  v_permlane16_swap_b32 v209, v211
  v_mfma_f32_16x16x32_bf16 v[136:139], a[112:115], a[16:19], v[136:139]
  v_add_f32 v201, v201, v177
  v_add_f32 v204, v204, v180
  v_mfma_f32_16x16x32_bf16 v[140:143], a[112:115], a[40:43], v[140:143]
  v_add_f32 v205, v205, v181
  v_add_f32 v202, v202, v178
  v_mfma_f32_16x16x32_bf16 v[136:139], a[116:119], a[20:23], v[136:139]
  v_add_f32 v203, v203, v179
  v_cvt_pk_bf16_f32 v212, v200, v201
  v_mfma_f32_16x16x32_bf16 v[140:143], a[116:119], a[44:47], v[140:143]
  v_cvt_pk_bf16_f32 v214, v204, v205
  v_add_f32 v206, v206, v182
  v_mfma_f32_32x32x16_bf16 v[96:111], a[120:123], v[188:191], v[96:111]
  ds_read_b64_tr_b16 a[120:121], v247 offset:24576
  ds_read_b64_tr_b16 a[122:123], v249 offset:25088
  v_add_f32 v207, v207, v183
  v_cvt_pk_bf16_f32 v213, v202, v203
  v_cvt_pk_bf16_f32 v215, v206, v207
  v_fma_f32 v168, v136, v220, v228
  v_mfma_f32_32x32x16_bf16 a[176:191], a[124:127], v[188:191], a[176:191]
  ds_read_b64_tr_b16 a[124:125], v248 offset:24576
  ds_read_b64_tr_b16 a[126:127], v250 offset:25088
  v_permlane16_swap_b32 v212, v214
  v_permlane16_swap_b32 v213, v215
  v_mfma_f32_32x32x16_bf16 a[192:207], a[128:131], v[188:191], a[192:207]
  ds_read_b64_tr_b16 a[128:129], v247 offset:26624
  ds_read_b64_tr_b16 a[130:131], v249 offset:27136
  v_fma_f32 v169, v137, v221, v228
  v_fma_f32 v172, v140, v220, v229
  v_fma_f32 v173, v141, v221, v229
  v_fma_f32 v170, v138, v222, v228
  v_mfma_f32_32x32x16_bf16 a[208:223], a[132:135], v[188:191], a[208:223]
  ds_read_b64_tr_b16 a[132:133], v248 offset:26624
  ds_read_b64_tr_b16 a[134:135], v250 offset:27136
  v_exp_f32 v168, v168
  v_exp_f32 v169, v169
  v_mfma_f32_32x32x16_bf16 a[224:239], a[136:139], v[188:191], a[224:239]
  ds_read_b64_tr_b16 a[136:137], v247 offset:28672
  ds_read_b64_tr_b16 a[138:139], v249 offset:29184
  v_add_f32 v232, v232, v236
  v_fma_f32 v174, v142, v222, v229
  v_exp_f32 v172, v172
  v_mfma_f32_32x32x16_bf16 a[240:255], a[140:143], v[188:191], a[240:255]
  ds_read_b64_tr_b16 a[140:141], v248 offset:28672
  ds_read_b64_tr_b16 a[142:143], v250 offset:29184
  v_exp_f32 v173, v173
  v_exp_f32 v170, v170
  v_mfma_f32_16x16x32_bf16 v[144:147], a[96:99], a[48:51], v[160:163]
  v_fma_f32 v171, v139, v223, v228
  v_add_f32 v233, v233, v237
  v_mfma_f32_16x16x32_bf16 v[148:151], a[96:99], a[72:75], v[164:167]
  s_waitcnt vmcnt(12)
  ds_read_b128 a[96:99], v245 offset:18432
  v_mfma_f32_16x16x32_bf16 v[144:147], a[100:103], a[52:55], v[144:147]
  v_add_f32 v236, v168, v169
  v_fma_f32 v175, v143, v223, v229
  v_mfma_f32_16x16x32_bf16 v[148:151], a[100:103], a[76:79], v[148:151]
  ds_read_b128 a[100:103], v246 offset:18432
  v_add_f32 v237, v172, v173
  v_mfma_f32_16x16x32_bf16 v[144:147], a[104:107], a[56:59], v[144:147]
  v_exp_f32 v174, v174
  v_mfma_f32_16x16x32_bf16 v[148:151], a[104:107], a[80:83], v[148:151]
  ds_read_b128 a[104:107], v245 offset:20480
  v_add_f32 v236, v236, v170
  v_mfma_f32_16x16x32_bf16 v[144:147], a[108:111], a[60:63], v[144:147]
  v_exp_f32 v171, v171
  v_mfma_f32_16x16x32_bf16 v[148:151], a[108:111], a[84:87], v[148:151]
  s_waitcnt lgkmcnt(3)
  buffer_load_dwordx4 v251, s[8:11], s71 offen offset:384 nt lds
  v_mfma_f32_16x16x32_bf16 v[144:147], a[112:115], a[64:67], v[144:147]
  s_add_u32 m0, s37, 25216
  ds_read_b128 a[108:111], v246 offset:20480
  v_mfma_f32_16x16x32_bf16 v[148:151], a[112:115], a[88:91], v[148:151]
  ds_read_b128 a[112:115], v245 offset:22528
  v_add_f32 v237, v237, v174
  v_mfma_f32_16x16x32_bf16 v[144:147], a[116:119], a[68:71], v[144:147]
  v_exp_f32 v175, v175
  v_mfma_f32_16x16x32_bf16 v[148:151], a[116:119], a[92:95], v[148:151]
  v_add_f32 v236, v236, v171
  v_add_f32 v237, v237, v175
  v_mfma_f32_32x32x16_bf16 v[0:15], a[144:147], v[208:211], v[0:15]
  buffer_load_dwordx4 v252, s[8:11], s71 offen offset:384 nt lds
  s_add_u32 m0, s37, 26112
  v_max_f32 v253, v236, v237
  v_cmp_lt_f32 vcc, s88, v253
  v_mfma_f32_32x32x16_bf16 v[16:31], a[148:151], v[208:211], v[16:31]
  ds_read_b128 a[116:119], v246 offset:22528
  v_fma_f32 v176, v144, v220, v230
  v_fma_f32 v177, v145, v221, v230
  v_fma_f32 v180, v148, v220, v231
  v_fma_f32 v181, v149, v221, v231
  v_fma_f32 v178, v146, v222, v230
  v_mfma_f32_32x32x16_bf16 v[32:47], a[152:155], v[208:211], v[32:47]
  buffer_load_dwordx4 v251, s[8:11], s71 offen offset:512 nt lds
  s_add_u32 m0, s37, 27136
  v_fma_f32 v182, v150, v222, v231
  v_fma_f32 v179, v147, v223, v230
  v_mfma_f32_32x32x16_bf16 v[48:63], a[156:159], v[208:211], v[48:63]
  v_exp_f32 v176, v176
  v_exp_f32 v177, v177
  v_exp_f32 v180, v180
  v_mfma_f32_32x32x16_bf16 v[64:79], a[160:163], v[208:211], v[64:79]
  buffer_load_dwordx4 v252, s[8:11], s71 offen offset:512 nt lds
  s_add_u32 m0, s37, 28032
  v_exp_f32 v181, v181
  v_mfma_f32_32x32x16_bf16 v[80:95], a[164:167], v[208:211], v[80:95]
  s_cbranch_vccnz L_tr_12_0
L_ret_12_0:
  v_mul_f32 v192, v168, v220
  v_mul_f32 v193, v169, v221
  v_mul_f32 v196, v172, v220
  v_mul_f32 v197, v173, v221
  v_mfma_f32_32x32x16_bf16 v[96:111], a[144:147], v[212:215], v[96:111]
  buffer_load_dwordx4 v251, s[8:11], s71 offen offset:640 nt lds
  s_add_u32 m0, s37, 29056
  v_mul_f32 v194, v170, v222
  v_mul_f32 v195, v171, v223
  v_mfma_f32_32x32x16_bf16 a[176:191], a[148:151], v[212:215], a[176:191]
  v_mul_f32 v198, v174, v222
  v_mul_f32 v199, v175, v223
  v_cvt_pk_bf16_f32 v184, v192, v193
  v_cvt_pk_bf16_f32 v186, v196, v197
  v_cvt_pk_bf16_f32 v185, v194, v195
  v_cvt_pk_bf16_f32 v187, v198, v199
  v_mfma_f32_32x32x16_bf16 a[192:207], a[152:155], v[212:215], a[192:207]
  buffer_load_dwordx4 v252, s[8:11], s71 offen offset:640 nt lds
  s_add_u32 m0, s37, 18432
  v_permlane16_swap_b32 v184, v186
  v_mfma_f32_32x32x16_bf16 a[208:223], a[156:159], v[212:215], a[208:223]
  v_permlane16_swap_b32 v185, v187
  v_add_f32 v234, v234, v238
  v_add_f32 v235, v235, v239
  v_fma_f32 v183, v151, v223, v231
  v_add_f32 v238, v176, v177
  v_mfma_f32_32x32x16_bf16 a[224:239], a[160:163], v[212:215], a[224:239]
  v_exp_f32 v178, v178
  v_exp_f32 v182, v182
  v_exp_f32 v179, v179
  v_mfma_f32_32x32x16_bf16 a[240:255], a[164:167], v[212:215], a[240:255]
  v_add_f32 v239, v180, v181
  v_exp_f32 v183, v183
  v_add_f32 v238, v238, v178
  v_add_f32 v239, v239, v182
  s_waitcnt lgkmcnt(0)
  v_mfma_f32_16x16x32_bf16 v[208:211], a[96:99], a[96:99], 0
  v_add_f32 v238, v238, v179
  v_add_f32 v239, v239, v183
  v_mfma_f32_16x16x32_bf16 v[212:215], a[96:99], v[112:115], 0
  v_max_f32 v254, v238, v239
  v_cmp_lt_f32 vcc, s88, v254
  v_mfma_f32_16x16x32_bf16 v[216:219], a[168:171], a[96:99], 0
  v_add_f32 v232, v232, v236
  v_add_f32 v233, v233, v237
  v_mfma_f32_16x16x32_bf16 v[208:211], a[100:103], a[100:103], v[208:211]
  s_cbranch_vccnz L_tr_12_1
L_ret_12_1:
  v_mfma_f32_16x16x32_bf16 v[212:215], a[100:103], v[116:119], v[212:215]
  v_mul_f32 v200, v176, v220
  v_mul_f32 v201, v177, v221
  v_mfma_f32_16x16x32_bf16 v[216:219], a[168:171], a[100:103], v[216:219]
  v_mul_f32 v204, v180, v220
  v_mul_f32 v205, v181, v221
  v_mfma_f32_16x16x32_bf16 v[208:211], a[104:107], a[104:107], v[208:211]
  v_mul_f32 v202, v178, v222
  v_mul_f32 v203, v179, v223
  v_mfma_f32_16x16x32_bf16 v[212:215], a[104:107], v[120:123], v[212:215]
  v_mul_f32 v206, v182, v222
  v_mul_f32 v207, v183, v223
  v_mfma_f32_16x16x32_bf16 v[216:219], a[168:171], a[104:107], v[216:219]
  v_cvt_pk_bf16_f32 v188, v200, v201
  v_cvt_pk_bf16_f32 v190, v204, v205
  v_mfma_f32_16x16x32_bf16 v[208:211], a[108:111], a[108:111], v[208:211]
  v_cvt_pk_bf16_f32 v189, v202, v203
  v_cvt_pk_bf16_f32 v191, v206, v207
  v_mfma_f32_16x16x32_bf16 v[212:215], a[108:111], v[124:127], v[212:215]
  v_permlane16_swap_b32 v188, v190
  v_mfma_f32_16x16x32_bf16 v[216:219], a[168:171], a[108:111], v[216:219]
  v_permlane16_swap_b32 v189, v191
  v_mfma_f32_16x16x32_bf16 v[208:211], a[112:115], a[112:115], v[208:211]
  v_add_f32 v234, v234, v238
  v_add_f32 v235, v235, v239
  v_mfma_f32_16x16x32_bf16 v[212:215], a[112:115], v[128:131], v[212:215]
  ds_read_b64_tr_b16 a[144:145], v247 offset:0
  ds_read_b64_tr_b16 a[146:147], v249 offset:512
  v_mfma_f32_16x16x32_bf16 v[216:219], a[168:171], a[112:115], v[216:219]
  ds_read_b64_tr_b16 a[148:149], v248 offset:0
  ds_read_b64_tr_b16 a[150:151], v250 offset:512
  v_mfma_f32_16x16x32_bf16 v[208:211], a[116:119], a[116:119], v[208:211]
  ds_read_b64_tr_b16 a[152:153], v247 offset:2048
  ds_read_b64_tr_b16 a[154:155], v249 offset:2560
  v_mfma_f32_16x16x32_bf16 v[212:215], a[116:119], v[132:135], v[212:215]
  ds_read_b64_tr_b16 a[156:157], v248 offset:2048
  ds_read_b64_tr_b16 a[158:159], v250 offset:2560
  v_mfma_f32_16x16x32_bf16 v[216:219], a[168:171], a[116:119], v[216:219]
  ds_read_b64_tr_b16 a[160:161], v247 offset:4096
  ds_read_b64_tr_b16 a[162:163], v249 offset:4608
  v_cndmask_b32 v242, v208, v209, s[48:49]
  v_cndmask_b32 v243, v210, v211, s[48:49]
  v_cndmask_b32 v242, v242, v243, s[50:51]
  v_mfma_f32_32x32x16_bf16 v[0:15], a[120:123], v[184:187], v[0:15]
  v_cndmask_b32 v243, v212, v213, s[48:49]
  v_cndmask_b32 v244, v214, v215, s[48:49]
  v_cndmask_b32 v243, v243, v244, s[50:51]
  v_fma_f32 v243, v243, 2.0, v240
  v_add_f32 v242, v242, v243
  v_add_f32 v244, v216, v241
  v_mul_f32 v244, v244, v244
  v_mfma_f32_32x32x16_bf16 v[16:31], a[124:127], v[184:187], v[16:31]
  v_fma_f32 v242, v244, s89, v242
  v_rsq_f32 v242, v242
  ds_read_b64_tr_b16 a[164:165], v248 offset:4096
  v_cndmask_b32 v242, 0, v242, s[52:53]
  ds_read_b64_tr_b16 a[166:167], v250 offset:4608
  v_mfma_f32_32x32x16_bf16 v[32:47], a[128:131], v[184:187], v[32:47]
  v_mfma_f32_32x32x16_bf16 v[48:63], a[132:135], v[184:187], v[48:63]
  v_mfma_f32_32x32x16_bf16 v[64:79], a[136:139], v[184:187], v[64:79]
  v_mfma_f32_32x32x16_bf16 v[80:95], a[140:143], v[184:187], v[80:95]
  v_mfma_f32_16x16x4_f32 v[224:227], v242, a172, 0
  v_mfma_f32_16x16x32_bf16 v[136:139], a[96:99], a[0:3], v[152:155]
  v_mfma_f32_16x16x32_bf16 v[140:143], a[96:99], a[24:27], v[156:159]
  v_mfma_f32_16x16x32_bf16 v[136:139], a[100:103], a[4:7], v[136:139]
  v_mfma_f32_16x16x32_bf16 v[140:143], a[100:103], a[28:31], v[140:143]
  v_mfma_f32_16x16x32_bf16 v[136:139], a[104:107], a[8:11], v[136:139]
  v_mfma_f32_16x16x32_bf16 v[140:143], a[104:107], a[32:35], v[140:143]
  v_mfma_f32_16x16x32_bf16 v[136:139], a[108:111], a[12:15], v[136:139]
  v_mfma_f32_16x16x32_bf16 v[140:143], a[108:111], a[36:39], v[140:143]
  v_mfma_f32_16x16x32_bf16 v[136:139], a[112:115], a[16:19], v[136:139]
  v_mfma_f32_16x16x32_bf16 v[140:143], a[112:115], a[40:43], v[140:143]
  v_mfma_f32_16x16x32_bf16 v[136:139], a[116:119], a[20:23], v[136:139]
  v_mfma_f32_16x16x32_bf16 v[140:143], a[116:119], a[44:47], v[140:143]
  v_mfma_f32_32x32x16_bf16 v[96:111], a[120:123], v[188:191], v[96:111]
  ds_read_b64_tr_b16 a[120:121], v247 offset:18432
  ds_read_b64_tr_b16 a[122:123], v249 offset:18944
  v_mfma_f32_32x32x16_bf16 a[176:191], a[124:127], v[188:191], a[176:191]
  ds_read_b64_tr_b16 a[124:125], v248 offset:18432
  ds_read_b64_tr_b16 a[126:127], v250 offset:18944
  v_mfma_f32_32x32x16_bf16 a[192:207], a[128:131], v[188:191], a[192:207]
  v_fma_f32 v168, v136, v224, v228
  v_fma_f32 v169, v137, v225, v228
  ds_read_b64_tr_b16 a[128:129], v247 offset:20480
  ds_read_b64_tr_b16 a[130:131], v249 offset:20992
  v_fma_f32 v172, v140, v224, v229
  v_fma_f32 v173, v141, v225, v229
  v_mfma_f32_32x32x16_bf16 a[208:223], a[132:135], v[188:191], a[208:223]
  ds_read_b64_tr_b16 a[132:133], v248 offset:20480
  ds_read_b64_tr_b16 a[134:135], v250 offset:20992
  v_fma_f32 v170, v138, v226, v228
  v_exp_f32 v168, v168
  v_fma_f32 v174, v142, v226, v229
  v_mfma_f32_32x32x16_bf16 a[224:239], a[136:139], v[188:191], a[224:239]
  ds_read_b64_tr_b16 a[136:137], v247 offset:22528
  ds_read_b64_tr_b16 a[138:139], v249 offset:23040
  v_exp_f32 v169, v169
  v_fma_f32 v171, v139, v227, v228
  v_add_f32 v236, v168, v169
  v_mfma_f32_32x32x16_bf16 a[240:255], a[140:143], v[188:191], a[240:255]
  ds_read_b64_tr_b16 a[140:141], v248 offset:22528
  ds_read_b64_tr_b16 a[142:143], v250 offset:23040
  v_exp_f32 v172, v172
  v_exp_f32 v173, v173
  v_mfma_f32_16x16x32_bf16 v[144:147], a[96:99], a[48:51], v[160:163]
  v_exp_f32 v170, v170
  v_mfma_f32_16x16x32_bf16 v[148:151], a[96:99], a[72:75], v[164:167]
  s_waitcnt vmcnt(12)
  ds_read_b128 a[96:99], v245 offset:30720
  v_mfma_f32_16x16x32_bf16 v[144:147], a[100:103], a[52:55], v[144:147]
  v_fma_f32 v175, v143, v227, v229
  v_add_f32 v237, v172, v173
  v_mfma_f32_16x16x32_bf16 v[148:151], a[100:103], a[76:79], v[148:151]
  ds_read_b128 a[100:103], v246 offset:30720
  v_add_f32 v236, v236, v170
  v_mfma_f32_16x16x32_bf16 v[144:147], a[104:107], a[56:59], v[144:147]
  v_exp_f32 v174, v174
  v_mfma_f32_16x16x32_bf16 v[148:151], a[104:107], a[80:83], v[148:151]
  ds_read_b128 a[104:107], v245 offset:32768
  v_add_f32 v237, v237, v174
  v_mfma_f32_16x16x32_bf16 v[144:147], a[108:111], a[60:63], v[144:147]
  v_exp_f32 v171, v171
  v_mfma_f32_16x16x32_bf16 v[148:151], a[108:111], a[84:87], v[148:151]
  ds_read_b128 a[108:111], v246 offset:32768
  s_waitcnt lgkmcnt(4)
  buffer_load_dwordx4 v255, s[32:35], s42 offen lds
  v_mfma_f32_16x16x32_bf16 v[144:147], a[112:115], a[64:67], v[144:147]
  v_exp_f32 v175, v175
  v_mfma_f32_16x16x32_bf16 v[148:151], a[112:115], a[88:91], v[148:151]
  ds_read_b128 a[112:115], v245 offset:34816
  v_add_f32 v236, v236, v171
  v_mfma_f32_16x16x32_bf16 v[144:147], a[116:119], a[68:71], v[144:147]
  v_add_f32 v237, v237, v175
  v_max_f32 v253, v236, v237
  v_mfma_f32_16x16x32_bf16 v[148:151], a[116:119], a[92:95], v[148:151]
  v_cmp_lt_f32 vcc, s88, v253
  s_waitcnt lgkmcnt(3)
  v_mfma_f32_16x16x32_bf16 v[208:211], a[96:99], a[96:99], 0
  ds_read_b128 a[116:119], v246 offset:34816
  v_mfma_f32_16x16x32_bf16 v[212:215], a[96:99], v[112:115], 0
  buffer_load_dwordx4 v255, s[32:35], s42 offen offset:1024 lds
  v_mfma_f32_16x16x32_bf16 v[216:219], a[168:171], a[96:99], 0
  s_cbranch_vccnz L_tr_13_0
L_ret_13_0:
  v_mfma_f32_16x16x32_bf16 v[208:211], a[100:103], a[100:103], v[208:211]
  v_mul_f32 v168, v168, v224
  v_mul_f32 v169, v169, v225
  v_mfma_f32_16x16x32_bf16 v[212:215], a[100:103], v[116:119], v[212:215]
  v_mul_f32 v172, v172, v224
  v_mul_f32 v173, v173, v225
  v_mfma_f32_16x16x32_bf16 v[216:219], a[168:171], a[100:103], v[216:219]
  v_mul_f32 v170, v170, v226
  s_waitcnt lgkmcnt(1)
  v_mfma_f32_16x16x32_bf16 v[208:211], a[104:107], a[104:107], v[208:211]
  v_mul_f32 v171, v171, v227
  v_mul_f32 v174, v174, v226
  v_mfma_f32_16x16x32_bf16 v[212:215], a[104:107], v[120:123], v[212:215]
  buffer_load_dwordx4 v255, s[32:35], s42 offen offset:2048 lds
  v_mfma_f32_16x16x32_bf16 v[216:219], a[168:171], a[104:107], v[216:219]
  v_mul_f32 v175, v175, v227
  v_cvt_pk_bf16_f32 v184, v168, v169
  v_mfma_f32_16x16x32_bf16 v[208:211], a[108:111], a[108:111], v[208:211]
  v_cvt_pk_bf16_f32 v186, v172, v173
  v_cvt_pk_bf16_f32 v185, v170, v171
  v_mfma_f32_16x16x32_bf16 v[212:215], a[108:111], v[124:127], v[212:215]
  v_cvt_pk_bf16_f32 v187, v174, v175
  v_fma_f32 v176, v144, v224, v230
  v_mfma_f32_16x16x32_bf16 v[216:219], a[168:171], a[108:111], v[216:219]
  v_permlane16_swap_b32 v184, v186
  v_mfma_f32_16x16x32_bf16 v[208:211], a[112:115], a[112:115], v[208:211]
  v_permlane16_swap_b32 v185, v187
  v_mfma_f32_16x16x32_bf16 v[212:215], a[112:115], v[128:131], v[212:215]
  buffer_load_dwordx4 v255, s[32:35], s42 offen offset:3072 lds
  v_mfma_f32_16x16x32_bf16 v[216:219], a[168:171], a[112:115], v[216:219]
  s_add_u32 s42, s42, 4096
  s_waitcnt lgkmcnt(0)
  v_mfma_f32_16x16x32_bf16 v[208:211], a[116:119], a[116:119], v[208:211]
  s_add_u32 m0, s37, 22528
  v_fma_f32 v177, v145, v225, v230
  v_mfma_f32_16x16x32_bf16 v[212:215], a[116:119], v[132:135], v[212:215]
  v_fma_f32 v180, v148, v224, v231
  v_fma_f32 v181, v149, v225, v231
  v_mfma_f32_16x16x32_bf16 v[216:219], a[168:171], a[116:119], v[216:219]
  v_fma_f32 v178, v146, v226, v230
  v_fma_f32 v182, v150, v226, v231
  v_cndmask_b32 v242, v208, v209, s[48:49]
  v_cndmask_b32 v243, v210, v211, s[48:49]
  v_cndmask_b32 v242, v242, v243, s[50:51]
  v_cndmask_b32 v243, v212, v213, s[48:49]
  v_cndmask_b32 v244, v214, v215, s[48:49]
  buffer_load_dwordx4 v255, s[32:35], s42 offen lds
  v_mfma_f32_32x32x16_bf16 v[0:15], a[120:123], v[184:187], v[0:15]
  v_cndmask_b32 v243, v243, v244, s[50:51]
  v_fma_f32 v243, v243, 2.0, v240
  v_add_f32 v242, v242, v243
  v_add_f32 v244, v216, v241
  v_mul_f32 v244, v244, v244
  v_fma_f32 v242, v244, s89, v242
  v_mfma_f32_32x32x16_bf16 v[16:31], a[124:127], v[184:187], v[16:31]
  v_rsq_f32 v242, v242
  buffer_load_dwordx4 v255, s[32:35], s42 offen offset:1024 lds
  v_fma_f32 v179, v147, v227, v230
  v_mfma_f32_32x32x16_bf16 v[32:47], a[128:131], v[184:187], v[32:47]
  v_exp_f32 v176, v176
  v_exp_f32 v177, v177
  v_exp_f32 v180, v180
  v_mfma_f32_32x32x16_bf16 v[48:63], a[132:135], v[184:187], v[48:63]
  v_exp_f32 v181, v181
  v_fma_f32 v183, v151, v227, v231
  v_cndmask_b32 v242, 0, v242, s[52:53]
  v_exp_f32 v178, v178
  v_mfma_f32_32x32x16_bf16 v[64:79], a[136:139], v[184:187], v[64:79]
  v_exp_f32 v182, v182
  v_exp_f32 v179, v179
  v_add_f32 v238, v176, v177
  v_add_f32 v239, v180, v181
  v_mfma_f32_32x32x16_bf16 v[80:95], a[140:143], v[184:187], v[80:95]
  v_exp_f32 v183, v183
  v_add_f32 v238, v238, v178
  v_add_f32 v239, v239, v182
  v_add_f32 v238, v238, v179
  v_add_f32 v239, v239, v183
  v_mfma_f32_16x16x4_f32 v[220:223], v242, a172, 0
  v_max_f32 v254, v238, v239
  v_cmp_lt_f32 vcc, s88, v254
  v_add_f32 v192, v192, v168
  v_add_f32 v193, v193, v169
  v_add_f32 v196, v196, v172
  v_add_f32 v197, v197, v173
  v_mfma_f32_16x16x32_bf16 v[136:139], a[96:99], a[0:3], v[152:155]
  s_cbranch_vccnz L_tr_13_1
L_ret_13_1:
  v_mfma_f32_16x16x32_bf16 v[140:143], a[96:99], a[24:27], v[156:159]
  v_mul_f32 v176, v176, v224
  v_mul_f32 v177, v177, v225
  v_mfma_f32_16x16x32_bf16 v[136:139], a[100:103], a[4:7], v[136:139]
  v_mul_f32 v180, v180, v224
  v_mul_f32 v181, v181, v225
  v_mfma_f32_16x16x32_bf16 v[140:143], a[100:103], a[28:31], v[140:143]
  v_mul_f32 v178, v178, v226
  v_mul_f32 v179, v179, v227
  v_mfma_f32_16x16x32_bf16 v[136:139], a[104:107], a[8:11], v[136:139]
  v_mul_f32 v182, v182, v226
  v_mul_f32 v183, v183, v227
  v_mfma_f32_16x16x32_bf16 v[140:143], a[104:107], a[32:35], v[140:143]
  v_cvt_pk_bf16_f32 v188, v176, v177
  v_cvt_pk_bf16_f32 v190, v180, v181
  v_mfma_f32_16x16x32_bf16 v[136:139], a[108:111], a[12:15], v[136:139]
  v_cvt_pk_bf16_f32 v189, v178, v179
  v_cvt_pk_bf16_f32 v191, v182, v183
  v_mfma_f32_16x16x32_bf16 v[140:143], a[108:111], a[36:39], v[140:143]
  v_permlane16_swap_b32 v188, v190
  v_mfma_f32_16x16x32_bf16 v[136:139], a[112:115], a[16:19], v[136:139]
  v_permlane16_swap_b32 v189, v191
  v_mfma_f32_16x16x32_bf16 v[140:143], a[112:115], a[40:43], v[140:143]
  v_add_f32 v194, v194, v170
  v_add_f32 v198, v198, v174
  v_mfma_f32_16x16x32_bf16 v[136:139], a[116:119], a[20:23], v[136:139]
  v_add_f32 v195, v195, v171
  v_add_f32 v199, v199, v175
  v_mfma_f32_16x16x32_bf16 v[140:143], a[116:119], a[44:47], v[140:143]
  v_add_f32 v232, v232, v236
  v_add_f32 v233, v233, v237
  v_mfma_f32_32x32x16_bf16 v[96:111], a[120:123], v[188:191], v[96:111]
  ds_read_b64_tr_b16 a[120:121], v247 offset:30720
  ds_read_b64_tr_b16 a[122:123], v249 offset:31232
  v_fma_f32 v168, v136, v220, v228
  v_fma_f32 v169, v137, v221, v228
  v_fma_f32 v170, v138, v222, v228
  v_fma_f32 v172, v140, v220, v229
  v_mfma_f32_32x32x16_bf16 a[176:191], a[124:127], v[188:191], a[176:191]
  v_fma_f32 v173, v141, v221, v229
  v_exp_f32 v168, v168
  v_exp_f32 v169, v169
  v_fma_f32 v174, v142, v222, v229
  v_mfma_f32_32x32x16_bf16 a[192:207], a[128:131], v[188:191], a[192:207]
  v_exp_f32 v172, v172
  v_exp_f32 v173, v173
  v_fma_f32 v171, v139, v223, v228
  v_fma_f32 v175, v143, v223, v229
  v_mfma_f32_32x32x16_bf16 a[208:223], a[132:135], v[188:191], a[208:223]
  v_exp_f32 v170, v170
  v_exp_f32 v174, v174
  v_add_f32 v236, v168, v169
  v_add_f32 v237, v172, v173
  v_mfma_f32_32x32x16_bf16 a[224:239], a[136:139], v[188:191], a[224:239]
  v_exp_f32 v171, v171
  v_exp_f32 v175, v175
  v_add_f32 v236, v236, v170
  v_add_f32 v237, v237, v174
  v_mfma_f32_32x32x16_bf16 a[240:255], a[140:143], v[188:191], a[240:255]
  v_add_f32 v236, v236, v171
  v_add_f32 v237, v237, v175
  v_max_f32 v253, v236, v237
  v_cmp_lt_f32 vcc, s88, v253
  ds_read_b64_tr_b16 a[124:125], v248 offset:30720
  ds_read_b64_tr_b16 a[126:127], v250 offset:31232
  v_mfma_f32_16x16x32_bf16 v[144:147], a[96:99], a[48:51], v[160:163]
  s_cbranch_vccnz L_tr_14_0
L_ret_14_0:
  v_mfma_f32_16x16x32_bf16 v[148:151], a[96:99], a[72:75], v[164:167]
  s_waitcnt vmcnt(6)
  ds_read_b128 a[96:99], v245 offset:24576
  v_mfma_f32_16x16x32_bf16 v[144:147], a[100:103], a[52:55], v[144:147]
  v_mul_f32 v168, v168, v220
  v_mul_f32 v169, v169, v221
  v_mfma_f32_16x16x32_bf16 v[148:151], a[100:103], a[76:79], v[148:151]
  ds_read_b128 a[100:103], v246 offset:24576
  v_mul_f32 v172, v172, v220
  v_mfma_f32_16x16x32_bf16 v[144:147], a[104:107], a[56:59], v[144:147]
  v_mul_f32 v173, v173, v221
  v_mul_f32 v170, v170, v222
  v_mfma_f32_16x16x32_bf16 v[148:151], a[104:107], a[80:83], v[148:151]
  ds_read_b128 a[104:107], v245 offset:26624
  v_mul_f32 v171, v171, v223
  v_mfma_f32_16x16x32_bf16 v[144:147], a[108:111], a[60:63], v[144:147]
  v_mul_f32 v174, v174, v222
  v_mul_f32 v175, v175, v223
  v_mfma_f32_16x16x32_bf16 v[148:151], a[108:111], a[84:87], v[148:151]
  ds_read_b128 a[108:111], v246 offset:26624
  v_cvt_pk_bf16_f32 v184, v168, v169
  v_mfma_f32_16x16x32_bf16 v[144:147], a[112:115], a[64:67], v[144:147]
  v_cvt_pk_bf16_f32 v186, v172, v173
  v_cvt_pk_bf16_f32 v185, v170, v171
  v_mfma_f32_16x16x32_bf16 v[148:151], a[112:115], a[88:91], v[148:151]
  ds_read_b128 a[112:115], v245 offset:28672
  v_lshrrev_b32 v245, 4, v255
  v_mfma_f32_16x16x32_bf16 v[144:147], a[116:119], a[68:71], v[144:147]
  v_cvt_pk_bf16_f32 v187, v174, v175
  ds_read_b64_tr_b16 a[128:129], v247 offset:32768
  v_mfma_f32_16x16x32_bf16 v[148:151], a[116:119], a[92:95], v[148:151]
  ds_read_b128 a[116:119], v246 offset:28672
  s_waitcnt lgkmcnt(5)
  v_mfma_f32_16x16x32_bf16 v[208:211], a[96:99], a[96:99], 0
  ds_read_b64_tr_b16 a[130:131], v249 offset:33280
  v_add_f32 v200, v200, v176
  v_mfma_f32_16x16x32_bf16 v[212:215], a[96:99], v[112:115], 0
  ds_read_b64_tr_b16 a[132:133], v248 offset:32768
  ds_read_b64_tr_b16 a[134:135], v250 offset:33280
  v_mfma_f32_16x16x32_bf16 v[216:219], a[168:171], a[96:99], 0
  v_permlane16_swap_b32 v184, v186
  v_mfma_f32_16x16x32_bf16 v[208:211], a[100:103], a[100:103], v[208:211]
  v_permlane16_swap_b32 v185, v187
  v_mfma_f32_16x16x32_bf16 v[212:215], a[100:103], v[116:119], v[212:215]
  v_bfe_u32 v116, v245, 4, 1
  v_lshrrev_b32 v117, 5, v245
  v_mfma_f32_16x16x32_bf16 v[216:219], a[168:171], a[100:103], v[216:219]
  v_and_b32 v118, 15, v245
  s_waitcnt lgkmcnt(5)
  v_mfma_f32_16x16x32_bf16 v[208:211], a[104:107], a[104:107], v[208:211]
  v_mul_u32_u24 v252, 6144, v116
  v_lshl_add_u32 v119, v116, 1, v117
  v_mfma_f32_16x16x32_bf16 v[212:215], a[104:107], v[120:123], v[212:215]
  v_mul_u32_u24 v251, 1536, v117
  v_lshl_add_u32 v255, v118, 4, s37
  v_mfma_f32_16x16x32_bf16 v[216:219], a[168:171], a[104:107], v[216:219]
  v_lshl_add_u32 v252, v117, 8, v252
  v_bfe_u32 v120, v245, 2, 2
  v_mfma_f32_16x16x32_bf16 v[208:211], a[108:111], a[108:111], v[208:211]
  v_and_b32 v121, 3, v245
  v_xor_b32 v122, v116, v245
  v_mfma_f32_16x16x32_bf16 v[212:215], a[108:111], v[124:127], v[212:215]
  v_lshl_add_u32 v119, v119, 8, v255
  v_add_u32 v252, v252, v255
  v_mfma_f32_16x16x32_bf16 v[216:219], a[168:171], a[108:111], v[216:219]
  v_add_f32 v201, v201, v177
  v_mul_u32_u24 v120, 96, v120
  v_mfma_f32_16x16x32_bf16 v[208:211], a[112:115], a[112:115], v[208:211]
  v_add_f32 v204, v204, v180
  ds_read_b64_tr_b16 a[136:137], v247 offset:34816
  v_mfma_f32_16x16x32_bf16 v[212:215], a[112:115], v[128:131], v[212:215]
  ds_read_b64_tr_b16 a[138:139], v249 offset:35328
  v_add_f32 v205, v205, v181
  v_mfma_f32_16x16x32_bf16 v[216:219], a[168:171], a[112:115], v[216:219]
  v_add_f32 v202, v202, v178
  s_waitcnt lgkmcnt(2)
  v_mfma_f32_16x16x32_bf16 v[208:211], a[116:119], a[116:119], v[208:211]
  v_add_f32 v206, v206, v182
  v_fma_f32 v176, v144, v220, v230
  v_mfma_f32_16x16x32_bf16 v[212:215], a[116:119], v[132:135], v[212:215]
  ds_read_b64_tr_b16 a[140:141], v248 offset:34816
  ds_read_b64_tr_b16 a[142:143], v250 offset:35328
  v_mfma_f32_16x16x32_bf16 v[216:219], a[168:171], a[116:119], v[216:219]
  v_fma_f32 v177, v145, v221, v230
  v_add_f32 v203, v203, v179
  v_cndmask_b32 v242, v208, v209, s[48:49]
  v_cndmask_b32 v243, v210, v211, s[48:49]
  v_cndmask_b32 v242, v242, v243, s[50:51]
  v_mfma_f32_32x32x16_bf16 v[0:15], a[120:123], v[184:187], v[0:15]
  v_cndmask_b32 v243, v212, v213, s[48:49]
  v_cndmask_b32 v244, v214, v215, s[48:49]
  v_fma_f32 v180, v148, v220, v231
  v_cndmask_b32 v243, v243, v244, s[50:51]
  v_fma_f32 v181, v149, v221, v231
  v_fma_f32 v243, v243, 2.0, v240
  v_add_f32 v207, v207, v183
  v_add_f32 v242, v242, v243
  v_fma_f32 v178, v146, v222, v230
  v_add_f32 v244, v216, v241
  v_fma_f32 v182, v150, v222, v231
  v_mul_f32 v244, v244, v244
  v_mfma_f32_32x32x16_bf16 v[16:31], a[124:127], v[184:187], v[16:31]
  v_fma_f32 v242, v244, s89, v242
  v_exp_f32 v176, v176
  v_exp_f32 v177, v177
  v_add_f32 v234, v234, v238
  v_fma_f32 v179, v147, v223, v230
  v_mfma_f32_32x32x16_bf16 v[32:47], a[128:131], v[184:187], v[32:47]
  v_exp_f32 v180, v180
  v_exp_f32 v181, v181
  v_add_f32 v235, v235, v239
  v_fma_f32 v183, v151, v223, v231
  v_mfma_f32_32x32x16_bf16 v[48:63], a[132:135], v[184:187], v[48:63]
  v_exp_f32 v178, v178
  v_exp_f32 v182, v182
  v_add_f32 v238, v176, v177
  v_rsq_f32 v242, v242
  s_waitcnt lgkmcnt(0)
  v_mfma_f32_32x32x16_bf16 v[64:79], a[136:139], v[184:187], v[64:79]
  v_exp_f32 v179, v179
  v_add_f32 v239, v180, v181
  v_exp_f32 v183, v183
  v_add_f32 v238, v238, v178
  v_mfma_f32_32x32x16_bf16 v[80:95], a[140:143], v[184:187], v[80:95]
  v_add_f32 v239, v239, v182
  v_cndmask_b32 v242, 0, v242, s[52:53]
  v_add_f32 v238, v238, v179
  v_add_f32 v239, v239, v183
  v_max_f32 v254, v238, v239
  v_cmp_lt_f32 vcc, s88, v254
  v_mfma_f32_16x16x4_f32 v[224:227], v242, a172, 0
  v_mul_u32_u24 v121, 24, v121
  s_cbranch_vccnz L_tr_14_1
L_ret_14_1:
  v_mul_f32 v176, v176, v220
  v_mul_f32 v177, v177, v221
  v_and_b32 v122, 1, v122
  v_mfma_f32_16x16x32_bf16 v[136:139], a[96:99], a[0:3], v[152:155]
  v_mul_f32 v180, v180, v220
  v_mul_f32 v181, v181, v221
  v_mfma_f32_16x16x32_bf16 v[140:143], a[96:99], a[24:27], v[156:159]
  v_mul_f32 v178, v178, v222
  v_mul_f32 v179, v179, v223
  v_mfma_f32_16x16x32_bf16 v[136:139], a[100:103], a[4:7], v[136:139]
  v_mul_f32 v182, v182, v222
  v_mul_f32 v183, v183, v223
  v_mfma_f32_16x16x32_bf16 v[140:143], a[100:103], a[28:31], v[140:143]
  v_cvt_pk_bf16_f32 v188, v176, v177
  v_cvt_pk_bf16_f32 v190, v180, v181
  v_mfma_f32_16x16x32_bf16 v[136:139], a[104:107], a[8:11], v[136:139]
  v_cvt_pk_bf16_f32 v189, v178, v179
  v_cvt_pk_bf16_f32 v191, v182, v183
  v_mfma_f32_16x16x32_bf16 v[140:143], a[104:107], a[32:35], v[140:143]
  v_permlane16_swap_b32 v188, v190
  v_mfma_f32_16x16x32_bf16 v[136:139], a[108:111], a[12:15], v[136:139]
  v_permlane16_swap_b32 v189, v191
  v_mfma_f32_16x16x32_bf16 v[140:143], a[108:111], a[36:39], v[140:143]
  v_add_f32 v192, v192, v168
  v_add_f32 v193, v193, v169
  v_mfma_f32_16x16x32_bf16 v[136:139], a[112:115], a[16:19], v[136:139]
  v_add_f32 v194, v194, v170
  v_add_f32 v195, v195, v171
  v_mfma_f32_16x16x32_bf16 v[140:143], a[112:115], a[40:43], v[140:143]
  v_add_f32 v196, v196, v172
  v_add_f32 v197, v197, v173
  v_mfma_f32_16x16x32_bf16 v[136:139], a[116:119], a[20:23], v[136:139]
  v_add_f32 v199, v199, v175
  v_add_f32 v198, v198, v174
  v_mfma_f32_16x16x32_bf16 v[140:143], a[116:119], a[44:47], v[140:143]
  v_add_f32 v232, v232, v236
  v_add_f32 v233, v233, v237
  v_mfma_f32_32x32x16_bf16 v[96:111], a[120:123], v[188:191], v[96:111]
  v_add3_u32 v120, v120, v121, s37
  v_add_u32 v122, -1, v122
  v_fma_f32 v168, v136, v224, v228
  v_fma_f32 v169, v137, v225, v228
  v_fma_f32 v170, v138, v226, v228
  v_fma_f32 v171, v139, v227, v228
  v_fma_f32 v172, v140, v224, v229
  v_fma_f32 v173, v141, v225, v229
  v_fma_f32 v175, v143, v227, v229
  v_exp_f32 v168, v168
  v_exp_f32 v169, v169
  v_exp_f32 v170, v170
  v_exp_f32 v171, v171
  v_fma_f32 v174, v142, v226, v229
  v_exp_f32 v172, v172
  v_exp_f32 v173, v173
  v_exp_f32 v175, v175
  v_exp_f32 v174, v174
  v_add_f32 v236, v168, v169
  v_add_f32 v236, v236, v170
  v_add_f32 v237, v172, v173
  v_mfma_f32_32x32x16_bf16 a[176:191], a[124:127], v[188:191], a[176:191]
  v_add_f32 v236, v236, v171
  v_add_f32 v237, v237, v174
  v_add_f32 v237, v237, v175
  v_max_f32 v253, v236, v237
  v_cmp_lt_f32 vcc, s88, v253
  v_mul_u32_u24 v121, 384, v116
  v_mfma_f32_32x32x16_bf16 a[192:207], a[128:131], v[188:191], a[192:207]
  s_cbranch_vccnz L_tr_15_0
L_ret_15_0:
  v_mul_f32 v174, v174, v226
  v_mul_f32 v175, v175, v227
  v_add_f32 v198, v198, v174
  v_add_f32 v199, v199, v175
  v_mul_f32 v168, v168, v224
  v_mul_f32 v169, v169, v225
  v_mul_f32 v170, v170, v226
  v_mul_f32 v171, v171, v227
  v_mul_f32 v172, v172, v224
  v_mul_f32 v173, v173, v225
  v_add_f32 v192, v192, v168
  v_add_f32 v193, v193, v169
  v_add_f32 v194, v194, v170
  v_add_f32 v195, v195, v171
  v_add_f32 v196, v196, v172
  v_add_f32 v197, v197, v173
  v_cvt_pk_bf16_f32 v184, v168, v169
  v_cvt_pk_bf16_f32 v186, v172, v173
  v_mfma_f32_32x32x16_bf16 a[208:223], a[132:135], v[188:191], a[208:223]
  v_cvt_pk_bf16_f32 v185, v170, v171
  v_cvt_pk_bf16_f32 v187, v174, v175
  ds_read_b64_tr_b16 a[120:121], v247 offset:24576
  ds_read_b64_tr_b16 a[122:123], v249 offset:25088
  v_cvt_pk_bf16_f32 v152, v192, v193
  v_cvt_pk_bf16_f32 v154, v196, v197
  v_mfma_f32_32x32x16_bf16 a[224:239], a[136:139], v[188:191], a[224:239]
  v_cvt_pk_bf16_f32 v153, v194, v195
  v_cvt_pk_bf16_f32 v155, v198, v199
  ds_read_b64_tr_b16 a[124:125], v248 offset:24576
  ds_read_b64_tr_b16 a[126:127], v250 offset:25088
  ds_read_b64_tr_b16 a[128:129], v247 offset:26624
  ds_read_b64_tr_b16 a[130:131], v249 offset:27136
  v_mfma_f32_32x32x16_bf16 a[240:255], a[140:143], v[188:191], a[240:255]
  ds_read_b64_tr_b16 a[132:133], v248 offset:26624
  ds_read_b64_tr_b16 a[134:135], v250 offset:27136
  ds_read_b64_tr_b16 a[136:137], v247 offset:28672
  ds_read_b64_tr_b16 a[138:139], v249 offset:29184
  ds_read_b64_tr_b16 a[140:141], v248 offset:28672
  ds_read_b64_tr_b16 a[142:143], v250 offset:29184
  v_mfma_f32_16x16x32_bf16 v[144:147], a[96:99], a[48:51], v[160:163]
  v_and_b32 v112, 0x3f803f80, v122
  v_and_b32 v113, 0x3f803f80, v122
  v_mfma_f32_16x16x32_bf16 v[148:151], a[96:99], a[72:75], v[164:167]
  v_permlane16_swap_b32 v184, v186
  v_mfma_f32_16x16x32_bf16 v[144:147], a[100:103], a[52:55], v[144:147]
  v_permlane16_swap_b32 v185, v187
  v_mfma_f32_16x16x32_bf16 v[148:151], a[100:103], a[76:79], v[148:151]
  v_add_f32 v200, v200, v176
  v_and_b32 v114, 0x3f803f80, v122
  v_mfma_f32_16x16x32_bf16 v[144:147], a[104:107], a[56:59], v[144:147]
  v_add_f32 v201, v201, v177
  v_add_f32 v202, v202, v178
  v_mfma_f32_16x16x32_bf16 v[148:151], a[104:107], a[80:83], v[148:151]
  v_add_f32 v203, v203, v179
  v_add_f32 v234, v234, v238
  v_mfma_f32_16x16x32_bf16 v[144:147], a[108:111], a[60:63], v[144:147]
  v_permlane16_swap_b32 v152, v154
  v_mfma_f32_16x16x32_bf16 v[148:151], a[108:111], a[84:87], v[148:151]
  v_permlane16_swap_b32 v153, v155
  v_mfma_f32_16x16x32_bf16 v[144:147], a[112:115], a[64:67], v[144:147]
  v_add_f32 v206, v206, v182
  v_add_f32 v204, v204, v180
  v_mfma_f32_16x16x32_bf16 v[148:151], a[112:115], a[88:91], v[148:151]
  v_add_f32 v205, v205, v181
  v_add_f32 v207, v207, v183
  v_mfma_f32_16x16x32_bf16 v[144:147], a[116:119], a[68:71], v[144:147]
  v_and_b32 v115, 0x3f803f80, v122
  v_add3_u32 v251, v251, v120, v121
  v_mfma_f32_16x16x32_bf16 v[148:151], a[116:119], a[92:95], v[148:151]
  v_add_f32 v235, v235, v239
  s_waitcnt lgkmcnt(0)
  v_mfma_f32_32x32x16_bf16 v[0:15], a[120:123], v[184:187], v[0:15]
  ds_write_b32 v255, v228 offset:36864
  ds_write_b32 v255, v229 offset:37120
  v_fma_f32 v176, v144, v224, v230
  v_fma_f32 v177, v145, v225, v230
  v_fma_f32 v178, v146, v226, v230
  v_fma_f32 v179, v147, v227, v230
  v_exp_f32 v176, v176
  v_exp_f32 v177, v177
  v_exp_f32 v178, v178
  v_fma_f32 v182, v150, v226, v231
  v_add_f32 v238, v176, v177
  v_fma_f32 v180, v148, v224, v231
  v_fma_f32 v181, v149, v225, v231
  v_fma_f32 v183, v151, v227, v231
  v_exp_f32 v182, v182
  v_exp_f32 v180, v180
  v_exp_f32 v181, v181
  v_mfma_f32_32x32x16_bf16 v[0:15], a[144:147], v[152:155], v[0:15]
  v_exp_f32 v179, v179
  v_exp_f32 v183, v183
  v_add_f32 v239, v180, v181
  v_add_f32 v238, v238, v178
  v_mfma_f32_32x32x16_bf16 v[16:31], a[124:127], v[184:187], v[16:31]
  v_add_f32 v239, v239, v182
  v_add_f32 v238, v238, v179
  v_add_f32 v239, v239, v183
  v_max_f32 v254, v238, v239
  v_cmp_lt_f32 vcc, s88, v254
  ds_read_b64_tr_b16 a[0:1], v251 offset:6144
  v_mfma_f32_32x32x16_bf16 v[16:31], a[148:151], v[152:155], v[16:31]
  v_cvt_pk_bf16_f32 v0, v0, v1
  v_cvt_pk_bf16_f32 v1, v2, v3
  v_cvt_pk_bf16_f32 v2, v4, v5
  v_cvt_pk_bf16_f32 v3, v6, v7
  ds_write_b128 v252, v[0:3] offset:24576
  v_cvt_pk_bf16_f32 v8, v8, v9
  v_cvt_pk_bf16_f32 v9, v10, v11
  v_cvt_pk_bf16_f32 v10, v12, v13
  v_cvt_pk_bf16_f32 v11, v14, v15
  s_cbranch_vccnz L_tr_15_1
L_ret_15_1:
  ds_write_b128 v252, v[8:11] offset:25088
  s_and_b32 s47, s36, 1
  v_cvt_pk_bf16_f32 v16, v16, v17
  v_cvt_pk_bf16_f32 v17, v18, v19
  v_cvt_pk_bf16_f32 v18, v20, v21
  v_cvt_pk_bf16_f32 v19, v22, v23
  ds_write_b128 v252, v[16:19] offset:25600
  v_cvt_pk_bf16_f32 v24, v24, v25
  v_cvt_pk_bf16_f32 v25, v26, v27
  v_cvt_pk_bf16_f32 v26, v28, v29
  v_cvt_pk_bf16_f32 v27, v30, v31
  s_lshr_b32 s91, s36, 1
  v_mfma_f32_32x32x16_bf16 v[32:47], a[128:131], v[184:187], v[32:47]
  s_mul_i32 s47, s47, 6144
  s_mul_i32 s91, s91, 24576
  ds_read_b64_tr_b16 a[2:3], v251 offset:6912
  v_mul_f32 v176, v176, v224
  v_mul_f32 v177, v177, v225
  v_mul_f32 v180, v180, v224
  v_mfma_f32_32x32x16_bf16 v[32:47], a[152:155], v[152:155], v[32:47]
  ds_write_b128 v252, v[24:27] offset:26112
  v_mul_f32 v181, v181, v225
  v_mul_f32 v178, v178, v226
  v_mul_f32 v179, v179, v227
  v_mul_f32 v182, v182, v226
  v_mul_f32 v183, v183, v227
  v_mfma_f32_32x32x16_bf16 v[48:63], a[132:135], v[184:187], v[48:63]
  ds_read_b64_tr_b16 a[24:25], v251 offset:6152
  ds_read_b64_tr_b16 a[26:27], v251 offset:6920
  s_sub_u32 s47, s47, s91
  v_add_f32 v200, v200, v176
  v_add_f32 v201, v201, v177
  v_cvt_pk_bf16_f32 v32, v32, v33
  v_cvt_pk_bf16_f32 v33, v34, v35
  v_cvt_pk_bf16_f32 v34, v36, v37
  v_cvt_pk_bf16_f32 v35, v38, v39
  ds_write_b128 v252, v[32:35] offset:26624
  v_cvt_pk_bf16_f32 v40, v40, v41
  v_cvt_pk_bf16_f32 v41, v42, v43
  v_cvt_pk_bf16_f32 v42, v44, v45
  v_cvt_pk_bf16_f32 v43, v46, v47
  v_mfma_f32_32x32x16_bf16 v[48:63], a[156:159], v[152:155], v[48:63]
  v_add_f32 v204, v204, v180
  v_add_f32 v205, v205, v181
  v_add_f32 v202, v202, v178
  v_add_f32 v203, v203, v179
  v_add_f32 v206, v206, v182
  ds_write_b128 v252, v[40:43] offset:27136
  v_mfma_f32_32x32x16_bf16 v[64:79], a[136:139], v[184:187], v[64:79]
  v_add_f32 v207, v207, v183
  v_cvt_pk_bf16_f32 v188, v176, v177
  v_cvt_pk_bf16_f32 v190, v180, v181
  v_cvt_pk_bf16_f32 v189, v178, v179
  v_cvt_pk_bf16_f32 v191, v182, v183
  v_cvt_pk_bf16_f32 v48, v48, v49
  v_cvt_pk_bf16_f32 v49, v50, v51
  v_cvt_pk_bf16_f32 v50, v52, v53
  v_cvt_pk_bf16_f32 v51, v54, v55
  v_cvt_pk_bf16_f32 v56, v56, v57
  ds_write_b128 v252, v[48:51] offset:27648
  v_cvt_pk_bf16_f32 v57, v58, v59
  v_mfma_f32_32x32x16_bf16 v[64:79], a[160:163], v[152:155], v[64:79]
  v_cvt_pk_bf16_f32 v58, v60, v61
  v_cvt_pk_bf16_f32 v59, v62, v63
  ds_read_b64_tr_b16 a[48:49], v251 offset:6160
  s_add_u32 s47, s47, 24576
  v_cvt_pk_bf16_f32 v156, v200, v201
  v_cvt_pk_bf16_f32 v158, v204, v205
  v_mfma_f32_32x32x16_bf16 v[80:95], a[140:143], v[184:187], v[80:95]
  v_cvt_pk_bf16_f32 v157, v202, v203
  v_cvt_pk_bf16_f32 v159, v206, v207
  ds_read_b64_tr_b16 a[50:51], v251 offset:6928
  v_permlane16_swap_b32 v188, v190
  ds_read_b64_tr_b16 a[4:5], v251 offset:9216
  v_cvt_pk_bf16_f32 v64, v64, v65
  v_cvt_pk_bf16_f32 v72, v72, v73
  ds_write_b128 v252, v[56:59] offset:28160
  v_cvt_pk_bf16_f32 v65, v66, v67
  v_cvt_pk_bf16_f32 v73, v74, v75
  v_mfma_f32_32x32x16_bf16 v[80:95], a[164:167], v[152:155], v[80:95]
  v_cvt_pk_bf16_f32 v66, v68, v69
  v_cvt_pk_bf16_f32 v67, v70, v71
  v_cvt_pk_bf16_f32 v74, v76, v77
  v_cvt_pk_bf16_f32 v75, v78, v79
  v_permlane16_swap_b32 v189, v191
  v_mfma_f32_16x16x32_bf16 v[160:163], v[112:115], v[0:3], 0
  ds_write_b128 v252, v[64:67] offset:28672
  s_lshl_b32 s91, s36, 8
  v_mfma_f32_16x16x32_bf16 v[160:163], v[112:115], v[8:11], v[160:163]
  v_permlane16_swap_b32 v156, v158
  v_mfma_f32_16x16x32_bf16 v[160:163], v[112:115], v[16:19], v[160:163]
  v_permlane16_swap_b32 v157, v159
  v_cvt_pk_bf16_f32 v80, v80, v81
  v_cvt_pk_bf16_f32 v88, v88, v89
  v_cvt_pk_bf16_f32 v81, v82, v83
  ds_write_b128 v252, v[72:75] offset:29184
  v_cvt_pk_bf16_f32 v89, v90, v91
  v_cvt_pk_bf16_f32 v82, v84, v85
  v_cvt_pk_bf16_f32 v83, v86, v87
  v_mfma_f32_16x16x32_bf16 v[160:163], v[112:115], v[24:27], v[160:163]
  v_cvt_pk_bf16_f32 v90, v92, v93
  v_cvt_pk_bf16_f32 v91, v94, v95
  v_mfma_f32_32x32x16_bf16 v[96:111], a[120:123], v[188:191], v[96:111]
  s_add_u32 s91, s91, 36864
  s_and_b32 s41, s2, 7
  ds_read_b64_tr_b16 a[6:7], v251 offset:9984
  ds_read_b64_tr_b16 a[28:29], v251 offset:9224
  ds_read_b64_tr_b16 a[30:31], v251 offset:9992
  ds_read_b64_tr_b16 a[52:53], v251 offset:9232
  v_mfma_f32_32x32x16_bf16 v[96:111], a[144:147], v[156:159], v[96:111]
  ds_read_b64_tr_b16 a[54:55], v251 offset:10000
  ds_read_b64_tr_b16 a[8:9], v251 offset:12288
  ds_read_b64_tr_b16 a[10:11], v251 offset:13056
  ds_read_b64_tr_b16 a[32:33], v251 offset:12296
  ds_read_b64_tr_b16 a[34:35], v251 offset:13064
  ds_read_b64_tr_b16 a[56:57], v251 offset:12304
  v_mfma_f32_32x32x16_bf16 a[176:191], a[124:127], v[188:191], a[176:191]
  ds_read_b64_tr_b16 a[58:59], v251 offset:13072
  ds_read_b64_tr_b16 a[12:13], v251 offset:15360
  ds_read_b64_tr_b16 a[14:15], v251 offset:16128
  s_lshr_b32 s42, s2, 7
  ds_read_b64_tr_b16 a[36:37], v251 offset:15368
  v_cvt_pk_bf16_f32 v96, v96, v97
  v_cvt_pk_bf16_f32 v104, v104, v105
  v_cvt_pk_bf16_f32 v97, v98, v99
  v_mfma_f32_32x32x16_bf16 a[176:191], a[148:151], v[156:159], a[176:191]
  v_cvt_pk_bf16_f32 v98, v100, v101
  v_cvt_pk_bf16_f32 v99, v102, v103
  v_cvt_pk_bf16_f32 v105, v106, v107
  v_cvt_pk_bf16_f32 v106, v108, v109
  v_cvt_pk_bf16_f32 v107, v110, v111
  s_lshl1_add_u32 s41, s41, s42
  v_mfma_f32_32x32x16_bf16 a[192:207], a[128:131], v[188:191], a[192:207]
  ds_write_b128 v252, v[80:83] offset:29696
  s_bfe_u32 s42, s2, 0x40003
  v_lshl_add_u32 v247, v245, 4, s47
  ds_read_b64_tr_b16 a[38:39], v251 offset:16136
  ds_read_b64_tr_b16 a[60:61], v251 offset:15376
  v_accvgpr_read_b32 v222, a178
  v_accvgpr_read_b32 v223, a179
  v_cvt_pk_bf16_f32 v21, v222, v223
  v_accvgpr_read_b32 v240, a180
  v_accvgpr_read_b32 v241, a181
  v_cvt_pk_bf16_f32 v22, v240, v241
  v_accvgpr_read_b32 v242, a182
  v_accvgpr_read_b32 v243, a183
  v_cvt_pk_bf16_f32 v23, v242, v243
  v_accvgpr_read_b32 v220, a176
  v_accvgpr_read_b32 v221, a177
  v_cvt_pk_bf16_f32 v20, v220, v221
  v_mfma_f32_32x32x16_bf16 a[192:207], a[152:155], v[156:159], a[192:207]
  ds_write_b128 v252, v[88:91] offset:30208
  v_accvgpr_read_b32 v220, a184
  v_accvgpr_read_b32 v221, a185
  v_accvgpr_read_b32 v222, a186
  v_accvgpr_read_b32 v223, a187
  v_accvgpr_read_b32 v240, a188
  v_accvgpr_read_b32 v241, a189
  v_accvgpr_read_b32 v242, a190
  v_accvgpr_read_b32 v243, a191
  v_cvt_pk_bf16_f32 v29, v222, v223
  v_cvt_pk_bf16_f32 v30, v240, v241
  v_cvt_pk_bf16_f32 v31, v242, v243
  ds_write_b128 v252, v[96:99] offset:0
  v_cvt_pk_bf16_f32 v28, v220, v221
  s_lshl_b32 s42, s42, 4
  s_mul_i32 s47, s41, 6144
  v_mfma_f32_32x32x16_bf16 a[208:223], a[132:135], v[188:191], a[208:223]
  v_accvgpr_read_b32 v222, a194
  v_accvgpr_read_b32 v223, a195
  v_cvt_pk_bf16_f32 v37, v222, v223
  v_accvgpr_read_b32 v240, a196
  v_accvgpr_read_b32 v241, a197
  v_cvt_pk_bf16_f32 v38, v240, v241
  v_accvgpr_read_b32 v242, a198
  ds_write_b128 v252, v[104:107] offset:512
  v_accvgpr_read_b32 v243, a199
  v_cvt_pk_bf16_f32 v39, v242, v243
  v_accvgpr_read_b32 v220, a192
  v_accvgpr_read_b32 v221, a193
  v_and_b32 v246, 15, v245
  v_cvt_pk_bf16_f32 v36, v220, v221
  s_add_u32 s47, s47, s42
  v_mfma_f32_32x32x16_bf16 a[208:223], a[156:159], v[156:159], a[208:223]
  v_accvgpr_read_b32 v220, a200
  v_accvgpr_read_b32 v221, a201
  v_accvgpr_read_b32 v222, a202
  ds_write_b128 v252, v[20:23] offset:1024
  v_accvgpr_read_b32 v223, a203
  v_accvgpr_read_b32 v240, a204
  v_accvgpr_read_b32 v241, a205
  v_accvgpr_read_b32 v242, a206
  v_accvgpr_read_b32 v243, a207
  v_cvt_pk_bf16_f32 v44, v220, v221
  v_cvt_pk_bf16_f32 v45, v222, v223
  v_cvt_pk_bf16_f32 v46, v240, v241
  v_cvt_pk_bf16_f32 v47, v242, v243
  v_lshl_add_u32 v253, v246, 4, s91
  s_lshl_b32 s41, s41, 8
  v_mfma_f32_32x32x16_bf16 a[224:239], a[136:139], v[188:191], a[224:239]
  ds_write_b128 v252, v[28:31] offset:1536
  v_accvgpr_read_b32 v220, a208
  v_accvgpr_read_b32 v221, a209
  v_cvt_pk_bf16_f32 v52, v220, v221
  v_accvgpr_read_b32 v222, a210
  v_accvgpr_read_b32 v223, a211
  v_cvt_pk_bf16_f32 v53, v222, v223
  v_accvgpr_read_b32 v240, a212
  v_accvgpr_read_b32 v241, a213
  v_cvt_pk_bf16_f32 v54, v240, v241
  v_accvgpr_read_b32 v242, a214
  v_accvgpr_read_b32 v243, a215
  v_cvt_pk_bf16_f32 v55, v242, v243
  s_add_u32 s91, s41, s42
  v_mfma_f32_32x32x16_bf16 a[224:239], a[160:163], v[156:159], a[224:239]
  v_accvgpr_read_b32 v220, a216
  v_accvgpr_read_b32 v221, a217
  v_accvgpr_read_b32 v222, a218
  v_accvgpr_read_b32 v223, a219
  v_accvgpr_read_b32 v240, a220
  v_accvgpr_read_b32 v241, a221
  v_accvgpr_read_b32 v242, a222
  v_accvgpr_read_b32 v243, a223
  v_cvt_pk_bf16_f32 v60, v220, v221
  s_lshl2_add_u32 s91, s36, s91
  v_cvt_pk_bf16_f32 v61, v222, v223
  v_cvt_pk_bf16_f32 v62, v240, v241
  ds_write_b128 v252, v[36:39] offset:2048
  v_cvt_pk_bf16_f32 v63, v242, v243
  v_mfma_f32_32x32x16_bf16 a[240:255], a[140:143], v[188:191], a[240:255]
  v_accvgpr_read_b32 v220, a224
  v_accvgpr_read_b32 v221, a225
  s_add_u32 s91, s91, 2097152
  v_cvt_pk_bf16_f32 v68, v220, v221
  v_accvgpr_read_b32 v222, a226
  v_accvgpr_read_b32 v223, a227
  v_cvt_pk_bf16_f32 v69, v222, v223
  v_accvgpr_read_b32 v240, a228
  v_accvgpr_read_b32 v241, a229
  v_cvt_pk_bf16_f32 v70, v240, v241
  v_accvgpr_read_b32 v242, a230
  v_accvgpr_read_b32 v243, a231
  v_cvt_pk_bf16_f32 v71, v242, v243
  s_lshr_b32 s41, s36, 1
  v_mfma_f32_32x32x16_bf16 a[240:255], a[164:167], v[156:159], a[240:255]
  v_accvgpr_read_b32 v220, a232
  v_accvgpr_read_b32 v221, a233
  v_accvgpr_read_b32 v222, a234
  v_accvgpr_read_b32 v223, a235
  v_accvgpr_read_b32 v240, a236
  v_accvgpr_read_b32 v241, a237
  v_accvgpr_read_b32 v242, a238
  v_accvgpr_read_b32 v243, a239
  ds_write_b128 v252, v[44:47] offset:2560
  s_lshl_b32 s41, s41, 10
  v_cvt_pk_bf16_f32 v76, v220, v221
  v_cvt_pk_bf16_f32 v77, v222, v223
  v_cvt_pk_bf16_f32 v78, v240, v241
  v_cvt_pk_bf16_f32 v79, v242, v243
  v_mfma_f32_16x16x32_bf16 v[160:163], v[112:115], v[32:35], v[160:163]
  s_and_b32 s42, s36, 1
  ds_write_b128 v252, v[52:55] offset:3072
  v_mfma_f32_16x16x32_bf16 v[160:163], v[112:115], v[40:43], v[160:163]
  v_accvgpr_read_b32 v220, a240
  v_accvgpr_read_b32 v221, a241
  v_accvgpr_read_b32 v222, a242
  v_accvgpr_read_b32 v223, a243
  v_accvgpr_read_b32 v240, a244
  v_accvgpr_read_b32 v241, a245
  v_accvgpr_read_b32 v242, a246
  v_accvgpr_read_b32 v243, a247
  s_lshl3_add_u32 s41, s42, s41
  ds_write_b128 v252, v[60:63] offset:3584
  v_cvt_pk_bf16_f32 v84, v220, v221
  v_cvt_pk_bf16_f32 v85, v222, v223
  v_cvt_pk_bf16_f32 v86, v240, v241
  v_cvt_pk_bf16_f32 v87, v242, v243
  v_mfma_f32_16x16x32_bf16 v[160:163], v[112:115], v[48:51], v[160:163]
  v_accvgpr_read_b32 v220, a248
  v_accvgpr_read_b32 v221, a249
  v_mfma_f32_16x16x32_bf16 v[160:163], v[112:115], v[56:59], v[160:163]
  v_accvgpr_read_b32 v222, a250
  v_accvgpr_read_b32 v223, a251
  v_mfma_f32_16x16x32_bf16 v[160:163], v[112:115], v[64:67], v[160:163]
  v_accvgpr_read_b32 v240, a252
  v_accvgpr_read_b32 v241, a253
  v_mfma_f32_16x16x32_bf16 v[160:163], v[112:115], v[72:75], v[160:163]
  v_accvgpr_read_b32 v242, a254
  v_accvgpr_read_b32 v243, a255
  v_mfma_f32_16x16x32_bf16 v[160:163], v[112:115], v[80:83], v[160:163]
  s_add_u32 s92, s47, s41
  ds_write_b128 v252, v[68:71] offset:4096
  v_mfma_f32_16x16x32_bf16 v[160:163], v[112:115], v[88:91], v[160:163]
  v_cvt_pk_bf16_f32 v92, v220, v221
  v_cvt_pk_bf16_f32 v93, v222, v223
  v_mfma_f32_16x16x32_bf16 v[164:167], v[112:115], v[96:99], 0
  v_cvt_pk_bf16_f32 v94, v240, v241
  v_cvt_pk_bf16_f32 v95, v242, v243
  v_mfma_f32_16x16x32_bf16 v[164:167], v[112:115], v[104:107], v[164:167]
  s_add_u32 s92, s92, 4096
  v_add_f32 v232, v232, v236
  v_mfma_f32_16x16x32_bf16 v[164:167], v[112:115], v[20:23], v[164:167]
  v_add_f32 v233, v233, v237
  v_add_f32 v234, v234, v238
  v_mfma_f32_16x16x32_bf16 v[164:167], v[112:115], v[28:31], v[164:167]
  v_add_f32 v235, v235, v239
  ds_write_b128 v252, v[92:95] offset:5632
  v_mfma_f32_16x16x32_bf16 v[164:167], v[112:115], v[36:39], v[164:167]
  s_lshl_b32 s41, s36, 10
  ds_read_b64_tr_b16 a[62:63], v251 offset:16144
  v_mfma_f32_16x16x32_bf16 v[164:167], v[112:115], v[44:47], v[164:167]
  ds_write_b128 v252, v[76:79] offset:4608
  v_mul_u32_u24 v249, 98304, v246
  v_mfma_f32_16x16x32_bf16 v[164:167], v[112:115], v[52:55], v[164:167]
  s_waitcnt vmcnt(0)
  ds_read_b64_tr_b16 a[16:17], v251 offset:18432
  v_mfma_f32_16x16x32_bf16 v[164:167], v[112:115], v[60:63], v[164:167]
  ds_read_b64_tr_b16 a[18:19], v251 offset:19200
  ds_read_b64_tr_b16 a[40:41], v251 offset:18440
  v_mfma_f32_16x16x32_bf16 v[164:167], v[112:115], v[68:71], v[164:167]
  ds_read_b64_tr_b16 a[42:43], v251 offset:19208
  ds_read_b64_tr_b16 a[64:65], v251 offset:18448
  v_mfma_f32_16x16x32_bf16 v[164:167], v[112:115], v[76:79], v[164:167]
  v_and_b32 v250, 48, v245
  v_add_u32 v248, 81920, v247
  v_mfma_f32_16x16x32_bf16 v[164:167], v[112:115], v[84:87], v[164:167]
  ds_write_b128 v252, v[84:87] offset:5120
  v_add_u32 v254, 81920, v253
  v_mfma_f32_16x16x32_bf16 v[164:167], v[112:115], v[92:95], v[164:167]
  v_lshl_add_u32 v249, v250, 4, v249
  v_lshlrev_b32 v250, 12, v246
  s_add_u32 s47, s47, s41
  ds_read_b64_tr_b16 a[66:67], v251 offset:19216
  ds_read_b64_tr_b16 a[20:21], v251 offset:21504
  ds_read_b64_tr_b16 a[22:23], v251 offset:22272
  ds_read_b64_tr_b16 a[44:45], v251 offset:21512
  ds_read_b64_tr_b16 a[46:47], v251 offset:22280
  ds_read_b64_tr_b16 a[68:69], v251 offset:21520
  ds_read_b64_tr_b16 a[70:71], v251 offset:22288
  v_permlane32_swap_b32 v232, v233
  v_permlane32_swap_b32 v234, v235
  v_add_f32 v232, v232, v233
  v_add_f32 v234, v234, v235
  s_nop 1
  v_permlane16_swap_b32 v232, v234
  v_add_f32 v232, v232, v234
  ds_write_b32 v255, v160 offset:36872
  ds_write_b32 v255, v161 offset:37128
  ds_write_b32 v255, v164 offset:37384
  ds_write_b32 v255, v165 offset:37640
  ds_write_b32 v255, v230 offset:37376
  ds_write_b32 v255, v231 offset:37632
  ds_write_b32 v119, v232 offset:36868
  s_waitcnt lgkmcnt(0)
  s_barrier
  v_mfma_f32_16x16x32_bf16 v[208:211], a[0:3], a[168:171], 0
  ds_read_b128 v[48:51], v247 offset:0
  ds_read_b128 v[52:55], v247 offset:1024
  v_mfma_f32_16x16x32_bf16 v[212:215], a[24:27], a[168:171], 0
  ds_read_b128 v[56:59], v247 offset:2048
  ds_read_b128 v[60:63], v247 offset:3072
  v_mfma_f32_16x16x32_bf16 v[216:219], a[48:51], a[168:171], 0
  ds_read_b128 v[64:67], v247 offset:4096
  ds_read_b128 v[68:71], v247 offset:5120
  v_mfma_f32_16x16x32_bf16 v[208:211], a[4:7], a[168:171], v[208:211]
  v_mfma_f32_16x16x32_bf16 v[212:215], a[28:31], a[168:171], v[212:215]
  ds_read_b128 v[72:75], v247 offset:40960
  v_mfma_f32_16x16x32_bf16 v[216:219], a[52:55], a[168:171], v[216:219]
  ds_read_b128 v[76:79], v247 offset:41984
  v_mfma_f32_16x16x32_bf16 v[208:211], a[8:11], a[168:171], v[208:211]
  ds_read_b128 v[184:187], v253 offset:0
  v_mfma_f32_16x16x32_bf16 v[212:215], a[32:35], a[168:171], v[212:215]
  ds_read_b128 v[188:191], v253 offset:40960
  v_mfma_f32_16x16x32_bf16 v[216:219], a[56:59], a[168:171], v[216:219]
  ds_read_b128 v[192:195], v254 offset:0
  v_mfma_f32_16x16x32_bf16 v[208:211], a[12:15], a[168:171], v[208:211]
  ds_read_b128 v[196:199], v254 offset:40960
  v_mfma_f32_16x16x32_bf16 v[212:215], a[36:39], a[168:171], v[212:215]
  ds_read_b128 v[80:83], v247 offset:43008
  v_mfma_f32_16x16x32_bf16 v[216:219], a[60:63], a[168:171], v[216:219]
  v_mfma_f32_16x16x32_bf16 v[208:211], a[16:19], a[168:171], v[208:211]
  ds_read_b128 v[84:87], v247 offset:44032
  ds_read_b128 v[88:91], v247 offset:45056
  v_mfma_f32_16x16x32_bf16 v[212:215], a[40:43], a[168:171], v[212:215]
  v_mfma_f32_16x16x32_bf16 v[216:219], a[64:67], a[168:171], v[216:219]
  ds_read_b128 v[92:95], v247 offset:46080
  v_mfma_f32_16x16x32_bf16 v[208:211], a[20:23], a[168:171], v[208:211]
  ds_read_b128 v[96:99], v248 offset:0
  v_mfma_f32_16x16x32_bf16 v[212:215], a[44:47], a[168:171], v[212:215]
  ds_read_b128 v[100:103], v248 offset:1024
  v_mfma_f32_16x16x32_bf16 v[216:219], a[68:71], a[168:171], v[216:219]
  ds_read_b128 v[104:107], v248 offset:2048
  s_waitcnt lgkmcnt(10)
  v_mfma_f32_16x16x32_bf16 v[0:3], a[0:3], v[48:51], 0
  s_waitcnt lgkmcnt(8)
  v_min3_f32 v156, v184, v188, v192
  v_mfma_f32_16x16x32_bf16 v[4:7], a[24:27], v[48:51], 0
  s_waitcnt lgkmcnt(7)
  v_min_f32 v156, v156, v196
  v_mfma_f32_16x16x32_bf16 v[8:11], a[48:51], v[48:51], 0
  v_sub_f32 v184, v156, v184
  v_sub_f32 v188, v156, v188
  v_mfma_f32_16x16x32_bf16 v[0:3], a[4:7], v[52:55], v[0:3]
  v_exp_f32 v184, v184
  v_mfma_f32_16x16x32_bf16 v[4:7], a[28:31], v[52:55], v[4:7]
  v_sub_f32 v192, v156, v192
  v_sub_f32 v196, v156, v196
  v_mfma_f32_16x16x32_bf16 v[8:11], a[52:55], v[52:55], v[8:11]
  v_exp_f32 v188, v188
  v_mfma_f32_16x16x32_bf16 v[0:3], a[8:11], v[56:59], v[0:3]
  v_exp_f32 v192, v192
  v_mfma_f32_16x16x32_bf16 v[4:7], a[32:35], v[56:59], v[4:7]
  v_mul_f32 v157, v184, v185
  v_fma_f32 v157, v188, v189, v157
  v_mfma_f32_16x16x32_bf16 v[8:11], a[56:59], v[56:59], v[8:11]
  v_exp_f32 v196, v196
  v_mfma_f32_16x16x32_bf16 v[0:3], a[12:15], v[60:63], v[0:3]
  v_fma_f32 v157, v192, v193, v157
  v_mul_f32 v158, v184, v186
  v_mfma_f32_16x16x32_bf16 v[4:7], a[36:39], v[60:63], v[4:7]
  v_fma_f32 v157, v196, v197, v157
  v_fma_f32 v158, v188, v190, v158
  v_mfma_f32_16x16x32_bf16 v[8:11], a[60:63], v[60:63], v[8:11]
  v_rcp_f32 v181, v157
  v_mfma_f32_16x16x32_bf16 v[0:3], a[16:19], v[64:67], v[0:3]
  v_fma_f32 v158, v192, v194, v158
  ds_read_b128 v[108:111], v248 offset:3072
  v_mfma_f32_16x16x32_bf16 v[4:7], a[40:43], v[64:67], v[4:7]
  v_fma_f32 v158, v196, v198, v158
  v_mul_f32 v181, 0x415db3d7, v181
  v_mfma_f32_16x16x32_bf16 v[8:11], a[64:67], v[64:67], v[8:11]
  v_mul_f32 v158, 0xbbaaaaab, v158
  ds_read_b128 v[112:115], v248 offset:4096
  v_mfma_f32_16x16x32_bf16 v[0:3], a[20:23], v[68:71], v[0:3]
  v_mul_f32 v158, v158, v181
  ds_read_b128 v[116:119], v248 offset:5120
  v_mfma_f32_16x16x32_bf16 v[4:7], a[44:47], v[68:71], v[4:7]
  ds_read_b128 v[120:123], v248 offset:40960
  v_mul_f32 v184, v181, v184
  v_mfma_f32_16x16x32_bf16 v[8:11], a[68:71], v[68:71], v[8:11]
  v_mul_f32 v176, v216, v158
  ds_read_b128 v[124:127], v248 offset:41984
  v_mfma_f32_16x16x32_bf16 v[12:15], a[0:3], v[72:75], 0
  v_mul_f32 v177, v217, v158
  v_mul_f32 v168, v208, v158
  v_mfma_f32_16x16x32_bf16 v[16:19], a[24:27], v[72:75], 0
  v_mul_f32 v169, v209, v158
  v_mul_f32 v170, v210, v158
  v_mfma_f32_16x16x32_bf16 v[20:23], a[48:51], v[72:75], 0
  v_mul_f32 v171, v211, v158
  ds_read_b128 v[128:131], v248 offset:43008
  v_mfma_f32_16x16x32_bf16 v[12:15], a[4:7], v[76:79], v[12:15]
  v_mul_f32 v172, v212, v158
  v_mul_f32 v173, v213, v158
  v_mfma_f32_16x16x32_bf16 v[16:19], a[28:31], v[76:79], v[16:19]
  v_mul_f32 v174, v214, v158
  v_mul_f32 v175, v215, v158
  v_mfma_f32_16x16x32_bf16 v[20:23], a[52:55], v[76:79], v[20:23]
  ds_read_b128 v[132:135], v248 offset:44032
  s_waitcnt lgkmcnt(5)
  v_mfma_f32_16x16x32_bf16 v[12:15], a[8:11], v[80:83], v[12:15]
  v_mul_f32 v178, v218, v158
  v_mul_f32 v179, v219, v158
  v_mfma_f32_16x16x32_bf16 v[16:19], a[32:35], v[80:83], v[16:19]
  v_mul_f32 v188, v181, v188
  v_fma_f32 v176, v8, v184, v176
  v_mfma_f32_16x16x32_bf16 v[20:23], a[56:59], v[80:83], v[20:23]
  v_fma_f32 v177, v9, v184, v177
  ds_read_b128 v[136:139], v248 offset:45056
  v_mfma_f32_16x16x32_bf16 v[12:15], a[12:15], v[84:87], v[12:15]
  v_fma_f32 v168, v0, v184, v168
  v_fma_f32 v169, v1, v184, v169
  v_mfma_f32_16x16x32_bf16 v[16:19], a[36:39], v[84:87], v[16:19]
  v_fma_f32 v170, v2, v184, v170
  v_fma_f32 v171, v3, v184, v171
  v_mfma_f32_16x16x32_bf16 v[20:23], a[60:63], v[84:87], v[20:23]
  v_fma_f32 v172, v4, v184, v172
  v_fma_f32 v173, v5, v184, v173
  v_mfma_f32_16x16x32_bf16 v[12:15], a[16:19], v[88:91], v[12:15]
  ds_read_b128 v[140:143], v248 offset:46080
  v_fma_f32 v174, v6, v184, v174
  v_mfma_f32_16x16x32_bf16 v[16:19], a[40:43], v[88:91], v[16:19]
  v_fma_f32 v175, v7, v184, v175
  v_fma_f32 v178, v10, v184, v178
  v_mfma_f32_16x16x32_bf16 v[20:23], a[64:67], v[88:91], v[20:23]
  v_log_f32 v180, v157
  v_mfma_f32_16x16x32_bf16 v[12:15], a[20:23], v[92:95], v[12:15]
  v_fma_f32 v179, v11, v184, v179
  v_mul_f32 v192, v181, v192
  v_mfma_f32_16x16x32_bf16 v[16:19], a[44:47], v[92:95], v[16:19]
  v_sub_f32 v180, v180, v156
  buffer_store_dword v180, v250, s[28:31], s91 offen
  v_mfma_f32_16x16x32_bf16 v[20:23], a[68:71], v[92:95], v[20:23]
  v_mul_f32 v196, v181, v196
  v_mfma_f32_16x16x32_bf16 v[24:27], a[0:3], v[96:99], 0
  v_fma_f32 v168, v12, v188, v168
  v_fma_f32 v169, v13, v188, v169
  v_mfma_f32_16x16x32_bf16 v[28:31], a[24:27], v[96:99], 0
  v_fma_f32 v170, v14, v188, v170
  v_fma_f32 v171, v15, v188, v171
  v_mfma_f32_16x16x32_bf16 v[32:35], a[48:51], v[96:99], 0
  v_fma_f32 v176, v20, v188, v176
  v_fma_f32 v177, v21, v188, v177
  v_mfma_f32_16x16x32_bf16 v[24:27], a[4:7], v[100:103], v[24:27]
  v_fma_f32 v172, v16, v188, v172
  v_fma_f32 v173, v17, v188, v173
  v_mfma_f32_16x16x32_bf16 v[28:31], a[28:31], v[100:103], v[28:31]
  v_fma_f32 v174, v18, v188, v174
  v_fma_f32 v175, v19, v188, v175
  v_mfma_f32_16x16x32_bf16 v[32:35], a[52:55], v[100:103], v[32:35]
  v_fma_f32 v178, v22, v188, v178
  v_fma_f32 v179, v23, v188, v179
  v_mfma_f32_16x16x32_bf16 v[24:27], a[8:11], v[104:107], v[24:27]
  v_mfma_f32_16x16x32_bf16 v[28:31], a[32:35], v[104:107], v[28:31]
  v_mfma_f32_16x16x32_bf16 v[32:35], a[56:59], v[104:107], v[32:35]
  v_mfma_f32_16x16x32_bf16 v[24:27], a[12:15], v[108:111], v[24:27]
  v_mfma_f32_16x16x32_bf16 v[28:31], a[36:39], v[108:111], v[28:31]
  v_mfma_f32_16x16x32_bf16 v[32:35], a[60:63], v[108:111], v[32:35]
  v_mfma_f32_16x16x32_bf16 v[24:27], a[16:19], v[112:115], v[24:27]
  v_mfma_f32_16x16x32_bf16 v[28:31], a[40:43], v[112:115], v[28:31]
  v_mfma_f32_16x16x32_bf16 v[32:35], a[64:67], v[112:115], v[32:35]
  s_waitcnt lgkmcnt(0)
  v_mfma_f32_16x16x32_bf16 v[24:27], a[20:23], v[116:119], v[24:27]
  v_mfma_f32_16x16x32_bf16 v[28:31], a[44:47], v[116:119], v[28:31]
  v_mfma_f32_16x16x32_bf16 v[32:35], a[68:71], v[116:119], v[32:35]
  v_mfma_f32_16x16x32_bf16 v[36:39], a[0:3], v[120:123], 0
  v_mfma_f32_16x16x32_bf16 v[40:43], a[24:27], v[120:123], 0
  v_mfma_f32_16x16x32_bf16 v[44:47], a[48:51], v[120:123], 0
  v_mfma_f32_16x16x32_bf16 v[36:39], a[4:7], v[124:127], v[36:39]
  v_mfma_f32_16x16x32_bf16 v[40:43], a[28:31], v[124:127], v[40:43]
  v_mfma_f32_16x16x32_bf16 v[44:47], a[52:55], v[124:127], v[44:47]
  v_fma_f32 v168, v24, v192, v168
  v_fma_f32 v169, v25, v192, v169
  v_mfma_f32_16x16x32_bf16 v[36:39], a[8:11], v[128:131], v[36:39]
  v_fma_f32 v176, v32, v192, v176
  v_fma_f32 v177, v33, v192, v177
  v_mfma_f32_16x16x32_bf16 v[40:43], a[32:35], v[128:131], v[40:43]
  v_fma_f32 v170, v26, v192, v170
  v_fma_f32 v171, v27, v192, v171
  v_mfma_f32_16x16x32_bf16 v[44:47], a[56:59], v[128:131], v[44:47]
  v_fma_f32 v172, v28, v192, v172
  v_fma_f32 v173, v29, v192, v173
  v_mfma_f32_16x16x32_bf16 v[36:39], a[12:15], v[132:135], v[36:39]
  v_fma_f32 v174, v30, v192, v174
  v_fma_f32 v175, v31, v192, v175
  v_mfma_f32_16x16x32_bf16 v[40:43], a[36:39], v[132:135], v[40:43]
  v_fma_f32 v178, v34, v192, v178
  v_fma_f32 v179, v35, v192, v179
  v_mfma_f32_16x16x32_bf16 v[44:47], a[60:63], v[132:135], v[44:47]
  v_mfma_f32_16x16x32_bf16 v[36:39], a[16:19], v[136:139], v[36:39]
  v_mfma_f32_16x16x32_bf16 v[40:43], a[40:43], v[136:139], v[40:43]
  v_mfma_f32_16x16x32_bf16 v[44:47], a[64:67], v[136:139], v[44:47]
  v_mfma_f32_16x16x32_bf16 v[36:39], a[20:23], v[140:143], v[36:39]
  v_mfma_f32_16x16x32_bf16 v[40:43], a[44:47], v[140:143], v[40:43]
  v_mfma_f32_16x16x32_bf16 v[44:47], a[68:71], v[140:143], v[44:47]
  s_nop 5
  v_fma_f32 v168, v36, v196, v168
  v_fma_f32 v169, v37, v196, v169
  v_fma_f32 v176, v44, v196, v176
  v_fma_f32 v177, v45, v196, v177
  v_fma_f32 v170, v38, v196, v170
  v_fma_f32 v171, v39, v196, v171
  v_fma_f32 v172, v40, v196, v172
  v_fma_f32 v173, v41, v196, v173
  v_fma_f32 v174, v42, v196, v174
  v_fma_f32 v175, v43, v196, v175
  v_fma_f32 v178, v46, v196, v178
  v_fma_f32 v179, v47, v196, v179
  v_cvt_pk_bf16_f32 v164, v176, v177
  v_cvt_pk_bf16_f32 v160, v168, v169
  v_cvt_pk_bf16_f32 v161, v170, v171
  v_cvt_pk_bf16_f32 v162, v172, v173
  v_cvt_pk_bf16_f32 v163, v174, v175
  v_cvt_pk_bf16_f32 v165, v178, v179
  buffer_store_dwordx4 v[160:163], v249, s[28:31], s47 offen
  buffer_store_dwordx2 v[164:165], v249, s[28:31], s92 offen
L_end:
  s_endpgm

L_prod:
  s_lshr_b32 s41, s2, 4
  s_lshr_b32 s40, s2, 2
  s_and_b32 s40, s40, 2
  s_and_b32 s47, s2, 1
  s_or_b32 s40, s40, s47
  s_cmp_eq_u32 s36, 3
  s_cbranch_scc1 L_p3
  s_mov_b32 s24, s72
  s_and_b32 s25, s73, 0xffff
  s_mov_b32 s26, 73728
  s_mul_i32 s47, s40, 18432
  s_mul_i32 s91, s36, 6144
  s_add_u32 s47, s47, s91
  s_add_u32 m0, s37, 18432
  s_nop 0
  buffer_load_dwordx4 v255, s[24:27], s47 offen lds
  buffer_load_dwordx4 v255, s[24:27], s47 offen offset:1024 lds
  buffer_load_dwordx4 v255, s[24:27], s47 offen offset:2048 lds
  buffer_load_dwordx4 v255, s[24:27], s47 offen offset:3072 lds
  s_add_u32 m0, s37, 22528
  s_add_u32 s47, s47, 4096
  buffer_load_dwordx4 v255, s[24:27], s47 offen lds
  buffer_load_dwordx4 v255, s[24:27], s47 offen offset:1024 lds
  v_lshrrev_b32 v234, 2, v228
  v_mul_u32_u24 v132, 384, v234
  v_lshl_add_u32 v132, v232, 4, v132
  v_add_u32 v133, 5120, v132
  v_add_u32 v134, 10240, v132
  v_add_u32 v135, 15360, v132
  s_mov_b32 s24, s80
  s_and_b32 s25, s81, 0xffff
  s_mov_b32 s26, 73728
  s_lshl_b32 s47, s41, 6
  s_mul_i32 s91, s36, 24576
  s_add_u32 s47, s47, s91
  s_add_u32 m0, s37, 36864
  s_nop 0
  buffer_load_dwordx4 v132, s[24:27], s47 offen lds
  buffer_load_dwordx4 v133, s[24:27], s47 offen offset:1024 lds
  buffer_load_dwordx4 v134, s[24:27], s47 offen offset:2048 lds
  buffer_load_dwordx4 v135, s[24:27], s47 offen offset:3072 lds
  s_add_u32 m0, s37, 24576
  s_nop 0
  buffer_load_dwordx4 v192, s[12:15], s38 offen nt lds
  s_add_u32 m0, s37, 25600
  s_nop 0
  buffer_load_dwordx4 v193, s[12:15], s38 offen nt lds
  s_add_u32 m0, s37, 26496
  s_nop 0
  buffer_load_dwordx4 v192, s[12:15], s38 offen offset:128 nt lds
  s_add_u32 m0, s37, 27520
  s_nop 0
  buffer_load_dwordx4 v193, s[12:15], s38 offen offset:128 nt lds
  s_waitcnt vmcnt(4)
  s_barrier
  s_add_u32 m0, s37, 28416
  s_nop 0
  buffer_load_dwordx4 v192, s[12:15], s38 offen offset:256 nt lds
  s_add_u32 m0, s37, 29440
  s_nop 0
  buffer_load_dwordx4 v193, s[12:15], s38 offen offset:256 nt lds
  s_add_u32 m0, s37, 30720
  s_nop 0
  buffer_load_dwordx4 v192, s[12:15], s39 offen nt lds
  s_add_u32 m0, s37, 31744
  s_nop 0
  buffer_load_dwordx4 v193, s[12:15], s39 offen nt lds
  s_add_u32 m0, s37, 32640
  s_nop 0
  buffer_load_dwordx4 v192, s[12:15], s39 offen offset:128 nt lds
  s_add_u32 m0, s37, 33664
  s_nop 0
  buffer_load_dwordx4 v193, s[12:15], s39 offen offset:128 nt lds
  s_add_u32 m0, s37, 34560
  s_nop 0
  buffer_load_dwordx4 v192, s[12:15], s39 offen offset:256 nt lds
  s_add_u32 m0, s37, 35584
  s_nop 0
  buffer_load_dwordx4 v193, s[12:15], s39 offen offset:256 nt lds
  s_mov_b32 s8, s66
  s_and_b32 s9, s67, 0xffff
  s_mov_b32 s28, s86
  s_and_b32 s29, s87, 0xffff
  s_mov_b32 s20, s84
  s_and_b32 s21, s85, 0xffff
  s_mov_b32 s32, s76
  s_and_b32 s33, s77, 0xffff
  v_and_b32 v234, 2, v229
  v_lshlrev_b32 v234, 1, v234
  v_lshrrev_b32 v235, 3, v229
  v_or_b32 v234, v234, v235
  v_xor_b32 v235, v231, v235
  v_and_b32 v235, 1, v235
  v_lshlrev_b32 v235, 1, v235
  v_or_b32 v237, v234, v235
  v_and_b32 v234, 1, v229
  v_xor_b32 v237, v237, v234
  v_xor_b32 v234, v230, v237
  v_lshlrev_b32 v234, 4, v234
  v_lshlrev_b32 v235, 7, v229
  v_add_u32 v235, s37, v235
  v_add_u32 v245, v234, v235
  v_xor_b32 v246, 64, v245
  v_lshrrev_b32 v234, 1, v230
  v_xor_b32 v237, v234, v237
  v_lshl_add_u32 v237, v237, 4, v235
  v_and_b32 v236, 1, v230
  v_mul_u32_u24 v236, 6144, v236
  v_add_u32 v199, v237, v236
  v_add_u32 v203, v199, v236
  v_xor_b32 v200, 32, v199
  v_xor_b32 v204, 32, v203
  v_xor_b32 v201, 64, v199
  v_xor_b32 v205, 64, v203
  v_xor_b32 v202, 96, v199
  v_xor_b32 v206, 96, v203
  v_mul_u32_u24 v235, 3, v234
  v_and_b32 v236, 2, v231
  v_lshlrev_b32 v236, 1, v236
  v_or_b32 v235, v235, v236
  v_and_b32 v236, 1, v231
  v_xor_b32 v235, v235, v236
  v_and_b32 v236, 1, v230
  v_lshlrev_b32 v236, 1, v236
  v_lshrrev_b32 v237, 1, v232
  v_or_b32 v236, v236, v237
  v_xor_b32 v235, v235, v236
  v_lshlrev_b32 v235, 4, v235
  v_lshlrev_b32 v236, 3, v234
  v_add_u32 v236, v236, v231
  v_lshlrev_b32 v236, 7, v236
  v_add_u32 v236, v236, v235
  v_and_b32 v235, 1, v232
  v_lshl_add_u32 v236, v235, 3, v236
  v_add_u32 v247, s37, v236
  v_xor_b32 v248, 64, v247
  v_xor_b32 v249, 32, v247
  v_xor_b32 v250, 96, v247
  v_mul_u32_u24 v234, 3072, v234
  v_lshl_add_u32 v234, v231, 7, v234
  v_lshl_add_u32 v234, v235, 5, v234
  v_lshl_add_u32 v234, v237, 3, v234
  v_lshrrev_b32 v235, 1, v231
  v_lshl_add_u32 v234, v235, 6, v234
  v_and_b32 v235, 1, v230
  v_lshl_add_u32 v195, v235, 4, v234
  v_xor_b32 v196, 64, v195
  v_add_u32 v197, 81920, v195
  v_add_u32 v198, 81920, v196
  v_mov_b32 v102, 0
  v_add_u32 v103, s37, v255
  v_mov_b32 v236, 0x3f803f80
  v_mov_b32 v237, 1.0
  v_accvgpr_write_b32 a168, v236
  v_accvgpr_write_b32 a169, v236
  v_accvgpr_write_b32 a170, v236
  v_accvgpr_write_b32 a171, v236
  v_accvgpr_write_b32 a172, v237
  s_mov_b32 s48, 0xaaaaaaaa
  s_mov_b32 s49, 0xaaaaaaaa
  s_mov_b32 s50, 0xcccccccc
  s_mov_b32 s51, 0xcccccccc
  s_mov_b32 s52, 0x00f0000f
  s_mov_b32 s53, 0xf0000f00
  s_mov_b32 s54, 0xffff0000
  s_mov_b32 s55, 0xffff0000
  s_mov_b32 s88, 0x4e800000
  s_mov_b32 s89, 0xbbaaaaab
  s_mov_b32 s90, 0x3afba882
  s_mov_b32 s93, 0
  s_lshr_b32 s46, s2, 3
  s_and_b32 s46, s46, 0
  s_lshr_b32 s91, s46, 2
  s_add_u32 s92, s2, 1
  s_sub_u32 s92, s92, s91
  s_add_u32 s91, s2, s91
  s_mul_i32 s91, s91, 196608
  s_mul_i32 s92, s92, 196608
  s_lshl1_add_u32 s64, s38, s91
  s_lshl1_add_u32 s65, s38, s92
  s_lshl1_add_u32 s66, s39, s91
  s_lshl1_add_u32 s67, s39, s92
  s_lshl1_add_u32 s68, s3, s91
  s_lshl1_add_u32 s69, s3, s92
  s_lshl1_add_u32 s70, s45, s91
  s_lshl1_add_u32 s71, s45, s92
  s_lshl3_add_u32 s92, s36, 0
  s_mul_i32 s47, s92, 3072
  s_mul_i32 s92, s92, 43
  s_lshr_b32 s92, s92, 8
  s_mul_i32 s92, s92, 22528
  s_add_u32 s92, s92, s47
  s_add_u32 m0, s92, 0
  s_nop 0
  buffer_load_dwordx4 v194, s[16:19], s47 offen lds
  s_add_u32 m0, s92, 896
  s_nop 0
  buffer_load_dwordx4 v194, s[16:19], s47 offen offset:128 lds
  s_add_u32 m0, s92, 1792
  s_nop 0
  buffer_load_dwordx4 v194, s[16:19], s47 offen offset:256 lds
  s_lshl3_add_u32 s92, s36, 1
  s_mul_i32 s47, s92, 3072
  s_mul_i32 s92, s92, 43
  s_lshr_b32 s92, s92, 8
  s_mul_i32 s92, s92, 22528
  s_add_u32 s92, s92, s47
  s_add_u32 m0, s92, 0
  s_nop 0
  buffer_load_dwordx4 v194, s[16:19], s47 offen lds
  s_add_u32 m0, s92, 896
  s_nop 0
  buffer_load_dwordx4 v194, s[16:19], s47 offen offset:128 lds
  s_add_u32 m0, s92, 1792
  s_nop 0
  buffer_load_dwordx4 v194, s[16:19], s47 offen offset:256 lds
  s_lshl3_add_u32 s92, s36, 2
  s_mul_i32 s47, s92, 3072
  s_mul_i32 s92, s92, 43
  s_lshr_b32 s92, s92, 8
  s_mul_i32 s92, s92, 22528
  s_add_u32 s92, s92, s47
  s_add_u32 m0, s92, 0
  s_nop 0
  buffer_load_dwordx4 v194, s[16:19], s47 offen lds
  s_add_u32 m0, s92, 896
  s_nop 0
  buffer_load_dwordx4 v194, s[16:19], s47 offen offset:128 lds
  s_add_u32 m0, s92, 1792
  s_nop 0
  buffer_load_dwordx4 v194, s[16:19], s47 offen offset:256 lds
  s_lshl3_add_u32 s92, s36, 3
  s_mul_i32 s47, s92, 3072
  s_mul_i32 s92, s92, 43
  s_lshr_b32 s92, s92, 8
  s_mul_i32 s92, s92, 22528
  s_add_u32 s92, s92, s47
  s_add_u32 m0, s92, 0
  s_nop 0
  buffer_load_dwordx4 v194, s[16:19], s47 offen lds
  s_add_u32 m0, s92, 896
  s_nop 0
  buffer_load_dwordx4 v194, s[16:19], s47 offen offset:128 lds
  s_add_u32 m0, s92, 1792
  s_nop 0
  buffer_load_dwordx4 v194, s[16:19], s47 offen offset:256 lds
  s_lshl3_add_u32 s92, s36, 4
  s_mul_i32 s47, s92, 3072
  s_mul_i32 s92, s92, 43
  s_lshr_b32 s92, s92, 8
  s_mul_i32 s92, s92, 22528
  s_add_u32 s92, s92, s47
  s_add_u32 m0, s92, 0
  s_nop 0
  buffer_load_dwordx4 v194, s[16:19], s47 offen lds
  s_add_u32 m0, s92, 896
  s_nop 0
  buffer_load_dwordx4 v194, s[16:19], s47 offen offset:128 lds
  s_add_u32 m0, s92, 1792
  s_nop 0
  buffer_load_dwordx4 v194, s[16:19], s47 offen offset:256 lds
  s_lshl3_add_u32 s92, s36, 5
  s_mul_i32 s47, s92, 3072
  s_mul_i32 s92, s92, 43
  s_lshr_b32 s92, s92, 8
  s_mul_i32 s92, s92, 22528
  s_add_u32 s92, s92, s47
  s_add_u32 m0, s92, 0
  s_nop 0
  buffer_load_dwordx4 v194, s[16:19], s47 offen lds
  s_add_u32 m0, s92, 896
  s_nop 0
  buffer_load_dwordx4 v194, s[16:19], s47 offen offset:128 lds
  s_add_u32 m0, s92, 1792
  s_nop 0
  buffer_load_dwordx4 v194, s[16:19], s47 offen offset:256 lds
  s_lshl3_add_u32 s92, s36, 6
  s_mul_i32 s47, s92, 3072
  s_mul_i32 s92, s92, 43
  s_lshr_b32 s92, s92, 8
  s_mul_i32 s92, s92, 22528
  s_add_u32 s92, s92, s47
  s_add_u32 m0, s92, 0
  s_nop 0
  buffer_load_dwordx4 v194, s[16:19], s47 offen lds
  s_add_u32 m0, s92, 896
  s_nop 0
  buffer_load_dwordx4 v194, s[16:19], s47 offen offset:128 lds
  s_add_u32 m0, s92, 1792
  s_nop 0
  buffer_load_dwordx4 v194, s[16:19], s47 offen offset:256 lds
  s_lshl3_add_u32 s92, s36, 7
  s_mul_i32 s47, s92, 3072
  s_mul_i32 s92, s92, 43
  s_lshr_b32 s92, s92, 8
  s_mul_i32 s92, s92, 22528
  s_add_u32 s92, s92, s47
  s_add_u32 m0, s92, 0
  s_nop 0
  buffer_load_dwordx4 v194, s[16:19], s47 offen lds
  s_add_u32 m0, s92, 896
  s_nop 0
  buffer_load_dwordx4 v194, s[16:19], s47 offen offset:128 lds
  s_add_u32 m0, s92, 1792
  s_nop 0
  buffer_load_dwordx4 v194, s[16:19], s47 offen offset:256 lds
  s_waitcnt vmcnt(24)
  ds_read_b128 a[176:179], v199 offset:24576
  ds_read_b128 a[180:183], v200 offset:24576
  ds_read_b128 a[184:187], v201 offset:24576
  ds_read_b128 a[188:191], v202 offset:24576
  ds_read_b128 a[192:195], v199 offset:26624
  ds_read_b128 a[196:199], v200 offset:26624
  ds_read_b128 a[200:203], v201 offset:26624
  ds_read_b128 a[204:207], v202 offset:26624
  ds_read_b128 a[208:211], v199 offset:28672
  ds_read_b128 a[212:215], v200 offset:28672
  ds_read_b128 a[216:219], v201 offset:28672
  ds_read_b128 a[220:223], v202 offset:28672
  s_barrier
  s_add_u32 m0, s37, 30720
  s_waitcnt lgkmcnt(0)
  buffer_load_dwordx4 v192, s[12:15], s45 offen nt lds
  s_add_u32 m0, s37, 31744
  s_nop 0
  buffer_load_dwordx4 v193, s[12:15], s45 offen nt lds
  s_add_u32 m0, s37, 32640
  s_nop 0
  buffer_load_dwordx4 v192, s[12:15], s45 offen offset:128 nt lds
  s_add_u32 m0, s37, 33664
  s_nop 0
  buffer_load_dwordx4 v193, s[12:15], s45 offen offset:128 nt lds
  s_add_u32 m0, s37, 34560
  s_nop 0
  buffer_load_dwordx4 v192, s[12:15], s45 offen offset:256 nt lds
  s_add_u32 m0, s37, 35584
  s_nop 0
  buffer_load_dwordx4 v193, s[12:15], s45 offen offset:256 nt lds
  s_waitcnt vmcnt(6)
  s_barrier
L_pend:
  ds_read_b64_tr_b16 v[24:25], v195 offset:0
  ds_read_b64_tr_b16 v[26:27], v195 offset:512
  ds_read_b64_tr_b16 a[96:97], v195 offset:6144
  ds_read_b64_tr_b16 a[98:99], v195 offset:6656
  ds_read_b64_tr_b16 v[28:29], v195 offset:12288
  ds_read_b64_tr_b16 v[30:31], v195 offset:12800
  ds_read_b64_tr_b16 a[100:101], v195 offset:40960
  ds_read_b64_tr_b16 a[102:103], v195 offset:41472
  ds_read_b64_tr_b16 v[32:33], v195 offset:47104
  ds_read_b64_tr_b16 v[34:35], v195 offset:47616
  s_add_u32 m0, s37, 18432
  ds_read_b64_tr_b16 a[104:105], v195 offset:53248
  buffer_load_dwordx4 v192, s[12:15], s3 offen nt lds
  ds_read_b64_tr_b16 a[106:107], v195 offset:53760
  ds_read_b64_tr_b16 v[36:37], v197 offset:0
  ds_read_b64_tr_b16 v[38:39], v197 offset:512
  ds_read_b64_tr_b16 a[108:109], v197 offset:6144
  ds_read_b64_tr_b16 a[110:111], v197 offset:6656
  s_add_u32 m0, s37, 19456
  ds_read_b64_tr_b16 v[40:41], v197 offset:12288
  ds_read_b64_tr_b16 v[42:43], v197 offset:12800
  s_waitcnt lgkmcnt(15)
  v_mfma_f32_32x32x16_bf16 v[152:167], v[24:27], a[176:179], 0
  buffer_load_dwordx4 v193, s[12:15], s3 offen nt lds
  ds_read_b64_tr_b16 a[112:113], v197 offset:40960
  ds_read_b64_tr_b16 a[114:115], v197 offset:41472
  s_waitcnt lgkmcnt(15)
  v_mfma_f32_32x32x16_bf16 v[152:167], a[96:99], a[180:183], v[152:167]
  ds_read_b64_tr_b16 v[44:45], v197 offset:47104
  ds_read_b64_tr_b16 v[46:47], v197 offset:47616
  ds_read_b64_tr_b16 a[116:117], v197 offset:53248
  ds_read_b64_tr_b16 a[118:119], v197 offset:53760
  s_add_u32 m0, s37, 20352
  s_waitcnt lgkmcnt(15)
  v_mfma_f32_32x32x16_bf16 v[152:167], v[28:31], a[184:187], v[152:167]
  buffer_load_dwordx4 v192, s[12:15], s3 offen offset:128 nt lds
  ds_read_b64_tr_b16 v[48:49], v196 offset:0
  ds_read_b64_tr_b16 v[50:51], v196 offset:512
  ds_read_b64_tr_b16 a[120:121], v196 offset:6144
  v_mfma_f32_32x32x16_bf16 v[152:167], a[100:103], a[188:191], v[152:167]
  ds_read_b64_tr_b16 a[122:123], v196 offset:6656
  ds_read_b64_tr_b16 v[52:53], v196 offset:12288
  ds_read_b64_tr_b16 v[54:55], v196 offset:12800
  ds_read_b64_tr_b16 a[124:125], v196 offset:40960
  ds_read_b64_tr_b16 a[126:127], v196 offset:41472
  s_waitcnt lgkmcnt(15)
  v_mfma_f32_32x32x16_bf16 v[152:167], v[32:35], a[192:195], v[152:167]
  s_add_u32 m0, s37, 21376
  ds_read_b64_tr_b16 v[56:57], v196 offset:47104
  buffer_load_dwordx4 v193, s[12:15], s3 offen offset:128 nt lds
  ds_read_b64_tr_b16 v[58:59], v196 offset:47616
  v_mfma_f32_32x32x16_bf16 v[152:167], a[104:107], a[196:199], v[152:167]
  ds_read_b64_tr_b16 a[128:129], v196 offset:53248
  ds_read_b64_tr_b16 a[130:131], v196 offset:53760
  ds_read_b64_tr_b16 v[60:61], v198 offset:0
  ds_read_b64_tr_b16 v[62:63], v198 offset:512
  ds_read_b64_tr_b16 a[132:133], v198 offset:6144
  v_mfma_f32_32x32x16_bf16 v[152:167], v[36:39], a[200:203], v[152:167]
  ds_read_b64_tr_b16 a[134:135], v198 offset:6656
  ds_read_b64_tr_b16 v[64:65], v198 offset:12288
  ds_read_b64_tr_b16 v[66:67], v198 offset:12800
  v_mfma_f32_32x32x16_bf16 v[152:167], a[108:111], a[204:207], v[152:167]
  s_add_u32 m0, s37, 22272
  ds_read_b64_tr_b16 a[136:137], v198 offset:40960
  buffer_load_dwordx4 v192, s[12:15], s3 offen offset:256 nt lds
  s_waitcnt lgkmcnt(15)
  v_mfma_f32_32x32x16_bf16 v[152:167], v[40:43], a[208:211], v[152:167]
  ds_read_b64_tr_b16 a[138:139], v198 offset:41472
  ds_read_b64_tr_b16 v[68:69], v198 offset:47104
  ds_read_b64_tr_b16 v[70:71], v198 offset:47616
  ds_read_b64_tr_b16 a[140:141], v198 offset:53248
  ds_read_b64_tr_b16 a[142:143], v198 offset:53760
  ds_read_b64_tr_b16 v[24:25], v195 offset:1024
  v_mfma_f32_32x32x16_bf16 v[152:167], a[112:115], a[212:215], v[152:167]
  s_add_u32 m0, s37, 23296
  ds_read_b64_tr_b16 v[26:27], v195 offset:1536
  buffer_load_dwordx4 v193, s[12:15], s3 offen offset:256 nt lds
  ds_read_b64_tr_b16 a[0:1], v195 offset:7168
  v_mfma_f32_32x32x16_bf16 v[152:167], v[44:47], a[216:219], v[152:167]
  ds_read_b64_tr_b16 a[2:3], v195 offset:7680
  ds_read_b64_tr_b16 v[28:29], v195 offset:13312
  ds_read_b64_tr_b16 v[30:31], v195 offset:13824
  ds_read_b64_tr_b16 a[24:25], v195 offset:41984
  ds_read_b64_tr_b16 a[26:27], v195 offset:42496
  ds_read_b64_tr_b16 v[32:33], v195 offset:48128
  v_mfma_f32_32x32x16_bf16 v[152:167], a[116:119], a[220:223], v[152:167]
  ds_read_b64_tr_b16 v[34:35], v195 offset:48640
  ds_read_b64_tr_b16 a[48:49], v195 offset:54272
  v_mfma_f32_32x32x16_bf16 v[136:151], v[48:51], a[176:179], 0
  ds_read_b64_tr_b16 a[50:51], v195 offset:54784
  ds_read_b64_tr_b16 v[36:37], v197 offset:1024
  ds_read_b64_tr_b16 v[38:39], v197 offset:1536
  ds_read_b64_tr_b16 a[72:73], v197 offset:7168
  ds_read_b64_tr_b16 a[74:75], v197 offset:7680
  v_mfma_f32_32x32x16_bf16 v[136:151], a[120:123], a[180:183], v[136:151]
  ds_read_b64_tr_b16 v[40:41], v197 offset:13312
  ds_read_b64_tr_b16 v[42:43], v197 offset:13824
  s_waitcnt lgkmcnt(15)
  v_mfma_f32_32x32x16_bf16 v[136:151], v[52:55], a[184:187], v[136:151]
  v_cvt_pk_bf16_f32 v112, v152, v153
  v_cvt_pk_bf16_f32 v0, v160, v161
  v_cvt_pk_bf16_f32 v113, v154, v155
  v_cvt_pk_bf16_f32 v1, v162, v163
  v_cvt_pk_bf16_f32 v114, v156, v157
  v_cvt_pk_bf16_f32 v2, v164, v165
  v_mfma_f32_32x32x16_bf16 v[136:151], a[124:127], a[188:191], v[136:151]
  v_cvt_pk_bf16_f32 v115, v158, v159
  v_cvt_pk_bf16_f32 v3, v166, v167
  s_lshl_b32 s47, s36, 6
  s_mul_i32 s91, s36, 12288
  buffer_load_dwordx4 v[108:111], v102, s[20:23], s47 offen sc1
  s_add_u32 s91, s91, 3145728
  v_mfma_f32_32x32x16_bf16 v[136:151], v[56:59], a[192:195], v[136:151]
  s_add_u32 s92, s91, 4096
  s_add_u32 s46, s91, 8192
  v_permlane16_swap_b32 v112, v0
  v_permlane16_swap_b32 v113, v1
  v_mfma_f32_32x32x16_bf16 v[136:151], a[128:131], a[196:199], v[136:151]
  v_permlane16_swap_b32 v114, v2
  v_permlane16_swap_b32 v115, v3
  buffer_load_dwordx2 v[104:105], v102, s[20:23], s47 offen offset:16 sc1
  ds_read_b64_tr_b16 a[4:5], v197 offset:41984
  v_mfma_f32_32x32x16_bf16 v[136:151], v[60:63], a[200:203], v[136:151]
  ds_read_b64_tr_b16 a[6:7], v197 offset:42496
  ds_read_b64_tr_b16 v[44:45], v197 offset:48128
  ds_read_b64_tr_b16 v[46:47], v197 offset:48640
  ds_read_b64_tr_b16 a[28:29], v197 offset:54272
  ds_read_b64_tr_b16 a[30:31], v197 offset:54784
  ds_read_b64_tr_b16 v[48:49], v196 offset:1024
  v_mfma_f32_32x32x16_bf16 v[136:151], a[132:135], a[204:207], v[136:151]
  ds_read_b64_tr_b16 v[50:51], v196 offset:1536
  ds_read_b64_tr_b16 a[52:53], v196 offset:7168
  ds_read_b64_tr_b16 a[54:55], v196 offset:7680
  ds_read_b64_tr_b16 v[52:53], v196 offset:13312
  ds_read_b64_tr_b16 v[54:55], v196 offset:13824
  buffer_load_dwordx4 v[72:75], v255, s[28:31], s91 offen
  v_mfma_f32_32x32x16_bf16 v[136:151], v[64:67], a[208:211], v[136:151]
  ds_read_b64_tr_b16 a[76:77], v196 offset:41984
  ds_read_b64_tr_b16 a[78:79], v196 offset:42496
  ds_read_b64_tr_b16 v[56:57], v196 offset:48128
  ds_read_b64_tr_b16 v[58:59], v196 offset:48640
  ds_read_b64_tr_b16 a[8:9], v196 offset:54272
  v_mfma_f32_16x16x32_bf16 v[228:231], v[112:115], v[112:115], 0
  ds_read_b64_tr_b16 a[10:11], v196 offset:54784
  ds_read_b64_tr_b16 v[60:61], v198 offset:1024
  v_mfma_f32_16x16x32_bf16 v[232:235], a[168:171], v[112:115], 0
  ds_read_b64_tr_b16 v[62:63], v198 offset:1536
  ds_read_b64_tr_b16 a[32:33], v198 offset:7168
  v_mfma_f32_16x16x32_bf16 v[236:239], v[0:3], v[0:3], 0
  buffer_load_dwordx4 v[168:171], v255, s[28:31], s91 offen offset:1024
  ds_read_b64_tr_b16 a[34:35], v198 offset:7680
  v_mfma_f32_16x16x32_bf16 v[224:227], a[168:171], v[0:3], 0
  ds_read_b64_tr_b16 v[64:65], v198 offset:13312
  ds_read_b64_tr_b16 v[66:67], v198 offset:13824
  v_mfma_f32_32x32x16_bf16 v[136:151], a[136:139], a[212:215], v[136:151]
  ds_read_b64_tr_b16 a[56:57], v198 offset:41984
  ds_read_b64_tr_b16 a[58:59], v198 offset:42496
  v_mfma_f32_32x32x16_bf16 v[136:151], v[68:71], a[216:219], v[136:151]
  buffer_load_dwordx4 v[76:79], v255, s[28:31], s91 offen offset:2048
  ds_read_b64_tr_b16 v[68:69], v198 offset:48128
  ds_read_b64_tr_b16 v[70:71], v198 offset:48640
  ds_read_b64_tr_b16 a[80:81], v198 offset:54272
  ds_read_b64_tr_b16 a[82:83], v198 offset:54784
  ds_read_b64_tr_b16 a[12:13], v195 offset:8192
  v_mfma_f32_32x32x16_bf16 v[136:151], a[140:143], a[220:223], v[136:151]
  ds_read_b64_tr_b16 a[14:15], v195 offset:8704
  ds_read_b64_tr_b16 a[36:37], v195 offset:43008
  ds_read_b64_tr_b16 a[38:39], v195 offset:43520
  v_mfma_f32_32x32x16_bf16 v[152:167], v[24:27], a[176:179], 0
  ds_read_b64_tr_b16 v[24:25], v195 offset:2048
  ds_read_b64_tr_b16 v[26:27], v195 offset:2560
  buffer_load_dwordx4 v[172:175], v255, s[28:31], s91 offen offset:3072
  ds_read_b64_tr_b16 a[60:61], v195 offset:55296
  ds_read_b64_tr_b16 a[62:63], v195 offset:55808
  s_waitcnt lgkmcnt(15)
  v_mfma_f32_32x32x16_bf16 v[152:167], a[0:3], a[180:183], v[152:167]
  ds_read_b64_tr_b16 a[84:85], v197 offset:8192
  v_cvt_pk_bf16_f32 v116, v136, v137
  v_cvt_pk_bf16_f32 v4, v144, v145
  v_cvt_pk_bf16_f32 v117, v138, v139
  v_cvt_pk_bf16_f32 v5, v146, v147
  v_cvt_pk_bf16_f32 v118, v140, v141
  v_mfma_f32_32x32x16_bf16 v[152:167], v[28:31], a[184:187], v[152:167]
  v_cvt_pk_bf16_f32 v6, v148, v149
  v_cvt_pk_bf16_f32 v119, v142, v143
  v_cvt_pk_bf16_f32 v7, v150, v151
  buffer_load_dwordx4 v[80:83], v255, s[28:31], s92 offen
  v_permlane16_swap_b32 v116, v4
  v_mfma_f32_32x32x16_bf16 v[152:167], a[24:27], a[188:191], v[152:167]
  v_permlane16_swap_b32 v117, v5
  v_permlane16_swap_b32 v118, v6
  v_permlane16_swap_b32 v119, v7
  v_mfma_f32_32x32x16_bf16 v[152:167], v[32:35], a[192:195], v[152:167]
  ds_read_b64_tr_b16 v[28:29], v195 offset:14336
  ds_read_b64_tr_b16 v[30:31], v195 offset:14848
  ds_read_b64_tr_b16 v[32:33], v195 offset:49152
  ds_read_b64_tr_b16 v[34:35], v195 offset:49664
  ds_read_b64_tr_b16 a[86:87], v197 offset:8704
  buffer_load_dwordx4 v[176:179], v255, s[28:31], s92 offen offset:1024
  v_mfma_f32_32x32x16_bf16 v[152:167], a[48:51], a[196:199], v[152:167]
  ds_read_b64_tr_b16 a[16:17], v197 offset:43008
  ds_read_b64_tr_b16 a[18:19], v197 offset:43520
  ds_read_b64_tr_b16 a[40:41], v197 offset:55296
  ds_read_b64_tr_b16 a[42:43], v197 offset:55808
  ds_read_b64_tr_b16 a[64:65], v196 offset:8192
  ds_read_b64_tr_b16 a[66:67], v196 offset:8704
  v_mfma_f32_32x32x16_bf16 v[152:167], v[36:39], a[200:203], v[152:167]
  ds_read_b64_tr_b16 v[36:37], v197 offset:2048
  ds_read_b64_tr_b16 v[38:39], v197 offset:2560
  ds_read_b64_tr_b16 a[88:89], v196 offset:43008
  ds_read_b64_tr_b16 a[90:91], v196 offset:43520
  ds_read_b64_tr_b16 a[20:21], v196 offset:55296
  v_mfma_f32_32x32x16_bf16 v[152:167], a[72:75], a[204:207], v[152:167]
  buffer_load_dwordx4 v[84:87], v255, s[28:31], s92 offen offset:2048
  ds_read_b64_tr_b16 a[22:23], v196 offset:55808
  ds_read_b64_tr_b16 a[44:45], v198 offset:8192
  ds_read_b64_tr_b16 a[46:47], v198 offset:8704
  v_mfma_f32_32x32x16_bf16 v[152:167], v[40:43], a[208:211], v[152:167]
  ds_read_b64_tr_b16 v[40:41], v197 offset:14336
  ds_read_b64_tr_b16 v[42:43], v197 offset:14848
  ds_read_b64_tr_b16 a[68:69], v198 offset:43008
  v_mfma_f32_16x16x32_bf16 v[228:231], v[116:119], v[116:119], v[228:231]
  buffer_load_dwordx4 v[180:183], v255, s[28:31], s92 offen offset:3072
  ds_read_b64_tr_b16 a[70:71], v198 offset:43520
  v_mfma_f32_16x16x32_bf16 v[232:235], a[168:171], v[116:119], v[232:235]
  ds_read_b64_tr_b16 a[92:93], v198 offset:55296
  ds_read_b64_tr_b16 a[94:95], v198 offset:55808
  v_mfma_f32_16x16x32_bf16 v[236:239], v[4:7], v[4:7], v[236:239]
  v_mfma_f32_16x16x32_bf16 v[224:227], a[168:171], v[4:7], v[224:227]
  v_mfma_f32_32x32x16_bf16 v[152:167], a[4:7], a[212:215], v[152:167]
  v_mfma_f32_32x32x16_bf16 v[152:167], v[44:47], a[216:219], v[152:167]
  buffer_load_dwordx4 v[88:91], v255, s[28:31], s46 offen
  ds_read_b64_tr_b16 v[44:45], v197 offset:49152
  ds_read_b64_tr_b16 v[46:47], v197 offset:49664
  v_mfma_f32_32x32x16_bf16 v[152:167], a[28:31], a[220:223], v[152:167]
  v_mfma_f32_32x32x16_bf16 v[136:151], v[48:51], a[176:179], 0
  buffer_load_dwordx4 v[184:187], v255, s[28:31], s46 offen offset:1024
  ds_read_b64_tr_b16 v[48:49], v196 offset:2048
  ds_read_b64_tr_b16 v[50:51], v196 offset:2560
  v_mfma_f32_32x32x16_bf16 v[136:151], a[52:55], a[180:183], v[136:151]
  v_mfma_f32_32x32x16_bf16 v[136:151], v[52:55], a[184:187], v[136:151]
  buffer_load_dwordx4 v[92:95], v255, s[28:31], s46 offen offset:2048
  ds_read_b64_tr_b16 v[52:53], v196 offset:14336
  ds_read_b64_tr_b16 v[54:55], v196 offset:14848
  v_mfma_f32_32x32x16_bf16 v[136:151], a[76:79], a[188:191], v[136:151]
  v_mfma_f32_32x32x16_bf16 v[136:151], v[56:59], a[192:195], v[136:151]
  buffer_load_dwordx4 v[188:191], v255, s[28:31], s46 offen offset:3072
  v_cvt_pk_bf16_f32 v120, v152, v153
  v_cvt_pk_bf16_f32 v8, v160, v161
  v_cvt_pk_bf16_f32 v121, v154, v155
  v_cvt_pk_bf16_f32 v9, v162, v163
  v_cvt_pk_bf16_f32 v122, v156, v157
  v_mfma_f32_32x32x16_bf16 v[136:151], a[8:11], a[196:199], v[136:151]
  v_cvt_pk_bf16_f32 v10, v164, v165
  v_cvt_pk_bf16_f32 v123, v158, v159
  v_cvt_pk_bf16_f32 v11, v166, v167
  v_permlane16_swap_b32 v120, v8
  ds_read_b64_tr_b16 v[56:57], v196 offset:49152
  v_mfma_f32_32x32x16_bf16 v[136:151], v[60:63], a[200:203], v[136:151]
  v_permlane16_swap_b32 v121, v9
  v_permlane16_swap_b32 v122, v10
  v_permlane16_swap_b32 v123, v11
  v_mfma_f32_32x32x16_bf16 v[136:151], a[32:35], a[204:207], v[136:151]
  ds_read_b64_tr_b16 v[58:59], v196 offset:49664
  ds_read_b64_tr_b16 v[60:61], v198 offset:2048
  ds_read_b64_tr_b16 v[62:63], v198 offset:2560
  s_waitcnt lgkmcnt(4)
  v_mfma_f32_32x32x16_bf16 v[136:151], v[64:67], a[208:211], v[136:151]
  ds_read_b64_tr_b16 v[64:65], v198 offset:14336
  ds_read_b64_tr_b16 v[66:67], v198 offset:14848
  v_mfma_f32_16x16x32_bf16 v[228:231], v[120:123], v[120:123], v[228:231]
  v_mfma_f32_16x16x32_bf16 v[232:235], a[168:171], v[120:123], v[232:235]
  v_mfma_f32_16x16x32_bf16 v[236:239], v[8:11], v[8:11], v[236:239]
  s_add_u32 m0, s37, 24576
  v_mfma_f32_16x16x32_bf16 v[224:227], a[168:171], v[8:11], v[224:227]
  v_mfma_f32_32x32x16_bf16 v[136:151], a[56:59], a[212:215], v[136:151]
  buffer_load_dwordx4 v251, s[8:11], s64 offen nt lds
  v_mfma_f32_32x32x16_bf16 v[136:151], v[68:71], a[216:219], v[136:151]
  s_add_u32 m0, s37, 25600
  ds_read_b64_tr_b16 v[68:69], v198 offset:49152
  ds_read_b64_tr_b16 v[70:71], v198 offset:49664
  v_mfma_f32_32x32x16_bf16 v[136:151], a[80:83], a[220:223], v[136:151]
  buffer_load_dwordx4 v252, s[8:11], s64 offen nt lds
  v_mfma_f32_32x32x16_bf16 v[152:167], v[24:27], a[176:179], 0
  s_add_u32 m0, s37, 26496
  v_mfma_f32_32x32x16_bf16 v[152:167], a[12:15], a[180:183], v[152:167]
  buffer_load_dwordx4 v251, s[8:11], s64 offen offset:128 nt lds
  v_mfma_f32_32x32x16_bf16 v[152:167], v[28:31], a[184:187], v[152:167]
  v_mfma_f32_32x32x16_bf16 v[152:167], a[36:39], a[188:191], v[152:167]
  s_add_u32 m0, s37, 27520
  v_mfma_f32_32x32x16_bf16 v[152:167], v[32:35], a[192:195], v[152:167]
  buffer_load_dwordx4 v252, s[8:11], s64 offen offset:128 nt lds
  s_add_u32 m0, s37, 28416
  v_mfma_f32_32x32x16_bf16 v[152:167], a[60:63], a[196:199], v[152:167]
  v_cvt_pk_bf16_f32 v124, v136, v137
  v_cvt_pk_bf16_f32 v12, v144, v145
  v_cvt_pk_bf16_f32 v125, v138, v139
  v_cvt_pk_bf16_f32 v13, v146, v147
  v_cvt_pk_bf16_f32 v126, v140, v141
  v_cvt_pk_bf16_f32 v14, v148, v149
  v_mfma_f32_32x32x16_bf16 v[152:167], v[36:39], a[200:203], v[152:167]
  v_cvt_pk_bf16_f32 v127, v142, v143
  buffer_load_dwordx4 v251, s[8:11], s64 offen offset:256 nt lds
  v_cvt_pk_bf16_f32 v15, v150, v151
  s_add_u32 m0, s37, 29440
  v_mfma_f32_32x32x16_bf16 v[152:167], a[84:87], a[204:207], v[152:167]
  v_permlane16_swap_b32 v124, v12
  v_permlane16_swap_b32 v125, v13
  v_permlane16_swap_b32 v126, v14
  v_mfma_f32_32x32x16_bf16 v[152:167], v[40:43], a[208:211], v[152:167]
  v_permlane16_swap_b32 v127, v15
  buffer_load_dwordx4 v252, s[8:11], s64 offen offset:256 nt lds
  s_nop 0
  v_mfma_f32_16x16x32_bf16 v[228:231], v[124:127], v[124:127], v[228:231]
  v_mfma_f32_16x16x32_bf16 v[232:235], a[168:171], v[124:127], v[232:235]
  v_mfma_f32_16x16x32_bf16 v[236:239], v[12:15], v[12:15], v[236:239]
  v_mfma_f32_16x16x32_bf16 v[224:227], a[168:171], v[12:15], v[224:227]
  v_mfma_f32_32x32x16_bf16 v[152:167], a[16:19], a[212:215], v[152:167]
  v_mfma_f32_32x32x16_bf16 v[152:167], v[44:47], a[216:219], v[152:167]
  v_mfma_f32_32x32x16_bf16 v[152:167], a[40:43], a[220:223], v[152:167]
  v_mfma_f32_32x32x16_bf16 v[136:151], v[48:51], a[176:179], 0
  v_mfma_f32_32x32x16_bf16 v[136:151], a[64:67], a[180:183], v[136:151]
  v_mfma_f32_32x32x16_bf16 v[136:151], v[52:55], a[184:187], v[136:151]
  v_mfma_f32_32x32x16_bf16 v[136:151], a[88:91], a[188:191], v[136:151]
  s_waitcnt lgkmcnt(0)
  v_mfma_f32_32x32x16_bf16 v[136:151], v[56:59], a[192:195], v[136:151]
  v_mfma_f32_32x32x16_bf16 v[136:151], a[20:23], a[196:199], v[136:151]
  v_mfma_f32_32x32x16_bf16 v[136:151], v[60:63], a[200:203], v[136:151]
  v_mfma_f32_32x32x16_bf16 v[136:151], a[44:47], a[204:207], v[136:151]
  s_waitcnt vmcnt(20)
  ds_read_b128 a[224:227], v203 offset:18432
  ds_read_b128 a[228:231], v204 offset:18432
  v_cvt_pk_bf16_f32 v128, v152, v153
  v_cvt_pk_bf16_f32 v16, v160, v161
  v_cvt_pk_bf16_f32 v129, v154, v155
  v_cvt_pk_bf16_f32 v17, v162, v163
  v_cvt_pk_bf16_f32 v130, v156, v157
  v_cvt_pk_bf16_f32 v18, v164, v165
  v_cvt_pk_bf16_f32 v131, v158, v159
  v_cvt_pk_bf16_f32 v19, v166, v167
  v_permlane16_swap_b32 v128, v16
  v_permlane16_swap_b32 v129, v17
  v_permlane16_swap_b32 v130, v18
  v_mfma_f32_32x32x16_bf16 v[136:151], v[64:67], a[208:211], v[136:151]
  v_permlane16_swap_b32 v131, v19
  ds_read_b128 a[232:235], v205 offset:18432
  ds_read_b128 a[236:239], v206 offset:18432
  ds_read_b128 a[240:243], v203 offset:20480
  ds_read_b128 a[244:247], v204 offset:20480
  v_mfma_f32_16x16x32_bf16 v[228:231], v[128:131], v[128:131], v[228:231]
  ds_read_b128 a[248:251], v205 offset:20480
  ds_read_b128 a[252:255], v206 offset:20480
  v_mfma_f32_16x16x32_bf16 v[232:235], a[168:171], v[128:131], v[232:235]
  ds_read_b128 a[144:147], v203 offset:22528
  ds_read_b128 a[148:151], v204 offset:22528
  v_mfma_f32_16x16x32_bf16 v[236:239], v[16:19], v[16:19], v[236:239]
  ds_read_b128 a[152:155], v205 offset:22528
  ds_read_b128 a[156:159], v206 offset:22528
  v_mfma_f32_16x16x32_bf16 v[224:227], a[168:171], v[16:19], v[224:227]
  v_mfma_f32_32x32x16_bf16 v[136:151], a[68:71], a[212:215], v[136:151]
  v_mfma_f32_32x32x16_bf16 v[136:151], v[68:71], a[216:219], v[136:151]
  v_mfma_f32_32x32x16_bf16 v[136:151], a[92:95], a[220:223], v[136:151]
  s_nop 11
  v_cvt_pk_bf16_f32 v132, v136, v137
  v_cvt_pk_bf16_f32 v20, v144, v145
  v_cvt_pk_bf16_f32 v133, v138, v139
  v_cvt_pk_bf16_f32 v21, v146, v147
  v_cvt_pk_bf16_f32 v134, v140, v141
  v_cvt_pk_bf16_f32 v22, v148, v149
  v_cvt_pk_bf16_f32 v135, v142, v143
  v_cvt_pk_bf16_f32 v23, v150, v151
  v_permlane16_swap_b32 v132, v20
  v_permlane16_swap_b32 v133, v21
  v_permlane16_swap_b32 v134, v22
  v_permlane16_swap_b32 v135, v23
  s_nop 1
  v_mfma_f32_16x16x32_bf16 v[228:231], v[132:135], v[132:135], v[228:231]
  v_mfma_f32_16x16x32_bf16 v[232:235], a[168:171], v[132:135], v[232:235]
  v_mfma_f32_16x16x32_bf16 v[236:239], v[20:23], v[20:23], v[236:239]
  v_mfma_f32_16x16x32_bf16 v[224:227], a[168:171], v[20:23], v[224:227]
  s_nop 4
  v_cndmask_b32 v240, v228, v229, s[48:49]
  v_cndmask_b32 v243, v230, v231, s[48:49]
  v_cndmask_b32 v240, v240, v243, s[50:51]
  v_add_f32 v240, s90, v240
  v_cndmask_b32 v96, v236, v237, s[48:49]
  v_cndmask_b32 v243, v238, v239, s[48:49]
  v_mov_b32 v241, v232
  v_cndmask_b32 v96, v96, v243, s[50:51]
  v_add_f32 v96, s90, v96
  v_mov_b32 v97, v224
  s_waitcnt lgkmcnt(0)
  s_branch L_join
L_p3:
  s_mov_b32 s28, s86
  s_and_b32 s29, s87, 0xffff
  s_mul_i32 s43, s40, 12288
  s_lshl_b32 s91, s41, 11
  s_add_u32 s43, s43, s91
  s_add_u32 s43, s43, 3145728
  s_mov_b32 s24, s64
  s_and_b32 s25, s65, 0xffff
  s_mov_b32 s26, 6144
  v_mul_u32_u24 v136, 384, v229
  v_lshl_add_u32 v136, v230, 4, v136
  buffer_load_ubyte v158, v255, s[28:31], s43 offen sc1
  buffer_load_ubyte v159, v255, s[28:31], s43 offen offset:1024 sc1
  buffer_load_dwordx4 a[96:99], v136, s[24:27], 0 offen
  buffer_load_dwordx4 a[100:103], v136, s[24:27], 0 offen offset:64
  buffer_load_dwordx4 a[104:107], v136, s[24:27], 0 offen offset:128
  buffer_load_dwordx4 a[108:111], v136, s[24:27], 0 offen offset:192
  buffer_load_dwordx4 a[112:115], v136, s[24:27], 0 offen offset:256
  buffer_load_dwordx4 a[116:119], v136, s[24:27], 0 offen offset:320
  v_lshlrev_b32 v234, 3, v231
  v_add_u32 v234, v234, v232
  v_mul_u32_u24 v234, 96, v234
  v_lshl_add_u32 v138, v230, 4, v234
  v_lshl_add_u32 v139, v230, 3, v234
  s_mov_b32 s24, s74
  s_and_b32 s25, s75, 0xffff
  s_mov_b32 s26, 73728
  s_mul_i32 s47, s40, 18432
  s_mul_i32 s91, s41, 3072
  s_add_u32 s47, s47, s91
  buffer_load_dwordx4 v[176:179], v138, s[24:27], s47 offen
  buffer_load_dwordx2 v[184:185], v139, s[24:27], s47 offen offset:64
  buffer_load_dwordx4 v[180:183], v138, s[24:27], s47 offen offset:384
  buffer_load_dwordx2 v[186:187], v139, s[24:27], s47 offen offset:448
  s_add_u32 m0, s37, 24576
  s_nop 0
  buffer_load_dwordx4 v192, s[12:15], s38 offen nt lds
  s_add_u32 m0, s37, 25600
  s_nop 0
  buffer_load_dwordx4 v193, s[12:15], s38 offen nt lds
  s_add_u32 m0, s37, 26496
  s_nop 0
  buffer_load_dwordx4 v192, s[12:15], s38 offen offset:128 nt lds
  s_add_u32 m0, s37, 27520
  s_nop 0
  buffer_load_dwordx4 v193, s[12:15], s38 offen offset:128 nt lds
  s_add_u32 m0, s37, 28416
  s_nop 0
  buffer_load_dwordx4 v192, s[12:15], s38 offen offset:256 nt lds
  s_add_u32 m0, s37, 29440
  s_nop 0
  buffer_load_dwordx4 v193, s[12:15], s38 offen offset:256 nt lds
  s_add_u32 m0, s37, 30720
  s_nop 0
  buffer_load_dwordx4 v192, s[12:15], s39 offen nt lds
  s_add_u32 m0, s37, 31744
  s_nop 0
  buffer_load_dwordx4 v193, s[12:15], s39 offen nt lds
  s_add_u32 m0, s37, 32640
  s_nop 0
  buffer_load_dwordx4 v192, s[12:15], s39 offen offset:128 nt lds
  s_add_u32 m0, s37, 33664
  s_nop 0
  buffer_load_dwordx4 v193, s[12:15], s39 offen offset:128 nt lds
  s_add_u32 m0, s37, 34560
  s_nop 0
  buffer_load_dwordx4 v192, s[12:15], s39 offen offset:256 nt lds
  s_add_u32 m0, s37, 35584
  s_nop 0
  buffer_load_dwordx4 v193, s[12:15], s39 offen offset:256 nt lds
  v_lshlrev_b32 v234, 3, v230
  v_add_u32 v234, v234, v231
  v_mul_u32_u24 v235, 96, v234
  v_lshl_add_u32 v235, v232, 3, v235
  v_add_u32 v140, 18432, v235
  v_lshl_add_u32 v142, v232, 3, v140
  v_add_u32 v141, 81920, v140
  v_add_u32 v143, 81920, v142
  v_lshlrev_b32 v234, 6, v234
  v_lshl_add_u32 v234, v232, 4, v234
  v_add_u32 v156, 36864, v234
  v_add_u32 v157, 81920, v156
  s_mov_b32 s20, s84
  s_and_b32 s21, s85, 0xffff
  s_lshl_b32 s40, s40, 6
  s_lshl_b32 s41, s41, 2
  s_add_u32 s91, s40, s41
  s_movk_i32 s92, 0xff
  s_mov_b32 s42, 0
  v_mov_b32 v235, 0
  s_waitcnt vmcnt(22)
  L_nn:
  s_add_u32 s42, s42, 1
  v_cmp_eq_u32 vcc, s42, v158
  v_cmp_eq_u32_e64 s[6:7], s42, v159
  s_or_b64 vcc, vcc, s[6:7]
  s_cbranch_scc1 L_nn
  v_mov_b32 v234, s42
  s_barrier
  ds_read_b64_tr_b16 a[0:1], v142 offset:0
  ds_read_b64_tr_b16 a[2:3], v142 offset:384
  ds_read_b64_tr_b16 a[4:5], v142 offset:8
  ds_read_b64_tr_b16 a[6:7], v142 offset:392
  ds_read_b64_tr_b16 a[8:9], v140 offset:64
  ds_read_b64_tr_b16 a[10:11], v140 offset:448
  ds_read_b64_tr_b16 a[12:13], v142 offset:3072
  ds_read_b64_tr_b16 a[14:15], v142 offset:3456
  ds_read_b64_tr_b16 a[16:17], v142 offset:3080
  ds_read_b64_tr_b16 a[18:19], v142 offset:3464
  ds_read_b64_tr_b16 a[20:21], v140 offset:3136
  ds_read_b64_tr_b16 a[22:23], v140 offset:3520
  ds_read_b64_tr_b16 a[24:25], v142 offset:40960
  ds_read_b64_tr_b16 a[26:27], v142 offset:41344
  ds_read_b64_tr_b16 a[28:29], v142 offset:40968
  ds_read_b64_tr_b16 a[30:31], v142 offset:41352
  ds_read_b64_tr_b16 a[32:33], v140 offset:41024
  ds_read_b64_tr_b16 a[34:35], v140 offset:41408
  ds_read_b64_tr_b16 a[36:37], v142 offset:44032
  ds_read_b64_tr_b16 a[38:39], v142 offset:44416
  ds_read_b64_tr_b16 a[40:41], v142 offset:44040
  ds_read_b64_tr_b16 a[42:43], v142 offset:44424
  ds_read_b64_tr_b16 a[44:45], v140 offset:44096
  ds_read_b64_tr_b16 a[46:47], v140 offset:44480
  ds_read_b64_tr_b16 a[48:49], v143 offset:0
  s_waitcnt vmcnt(21) lgkmcnt(15)
  v_mfma_f32_16x16x32_bf16 v[144:147], a[0:3], a[96:99], 0
  ds_read_b64_tr_b16 a[50:51], v143 offset:384
  ds_read_b64_tr_b16 a[52:53], v143 offset:8
  v_mfma_f32_16x16x32_bf16 v[148:151], a[4:7], a[96:99], 0
  ds_read_b64_tr_b16 a[54:55], v143 offset:392
  ds_read_b64_tr_b16 a[56:57], v141 offset:64
  ds_read_b64_tr_b16 a[58:59], v141 offset:448
  v_mfma_f32_16x16x32_bf16 v[152:155], a[8:11], a[96:99], 0
  ds_read_b64_tr_b16 a[60:61], v143 offset:3072
  s_waitcnt vmcnt(20)
  v_mfma_f32_16x16x32_bf16 v[144:147], a[12:15], a[100:103], v[144:147]
  ds_read_b64_tr_b16 a[62:63], v143 offset:3456
  ds_read_b64_tr_b16 a[64:65], v143 offset:3080
  ds_read_b64_tr_b16 a[66:67], v143 offset:3464
  v_mfma_f32_16x16x32_bf16 v[148:151], a[16:19], a[100:103], v[148:151]
  ds_read_b64_tr_b16 a[68:69], v141 offset:3136
  s_waitcnt lgkmcnt(15)
  v_mfma_f32_16x16x32_bf16 v[152:155], a[20:23], a[100:103], v[152:155]
  ds_read_b64_tr_b16 a[70:71], v141 offset:3520
  s_waitcnt vmcnt(19)
  v_mfma_f32_16x16x32_bf16 v[144:147], a[24:27], a[104:107], v[144:147]
  v_mfma_f32_16x16x32_bf16 v[148:151], a[28:31], a[104:107], v[148:151]
  v_mfma_f32_16x16x32_bf16 v[152:155], a[32:35], a[104:107], v[152:155]
  s_waitcnt vmcnt(18)
  v_mfma_f32_16x16x32_bf16 v[144:147], a[36:39], a[108:111], v[144:147]
  ds_read_b64_tr_b16 a[120:121], v156 offset:0
  s_waitcnt lgkmcnt(15)
  v_mfma_f32_16x16x32_bf16 v[148:151], a[40:43], a[108:111], v[148:151]
  ds_read_b64_tr_b16 a[122:123], v156 offset:256
  s_waitcnt lgkmcnt(14)
  v_mfma_f32_16x16x32_bf16 v[152:155], a[44:47], a[108:111], v[152:155]
  ds_read_b64_tr_b16 a[124:125], v156 offset:8
  ds_read_b64_tr_b16 a[126:127], v156 offset:264
  s_waitcnt vmcnt(17) lgkmcnt(14)
  v_mfma_f32_16x16x32_bf16 v[144:147], a[48:51], a[112:115], v[144:147]
  ds_read_b64_tr_b16 a[128:129], v156 offset:2048
  ds_read_b64_tr_b16 a[130:131], v156 offset:2304
  s_waitcnt lgkmcnt(14)
  v_mfma_f32_16x16x32_bf16 v[148:151], a[52:55], a[112:115], v[148:151]
  ds_read_b64_tr_b16 a[132:133], v156 offset:2056
  ds_read_b64_tr_b16 a[134:135], v156 offset:2312
  s_waitcnt lgkmcnt(14)
  v_mfma_f32_16x16x32_bf16 v[152:155], a[56:59], a[112:115], v[152:155]
  ds_read_b64_tr_b16 a[136:137], v156 offset:40960
  ds_read_b64_tr_b16 a[138:139], v156 offset:41216
  s_waitcnt vmcnt(16) lgkmcnt(14)
  v_mfma_f32_16x16x32_bf16 v[144:147], a[60:63], a[116:119], v[144:147]
  ds_read_b64_tr_b16 a[140:141], v156 offset:40968
  ds_read_b64_tr_b16 a[142:143], v156 offset:41224
  s_waitcnt lgkmcnt(14)
  v_mfma_f32_16x16x32_bf16 v[148:151], a[64:67], a[116:119], v[148:151]
  ds_read_b64_tr_b16 a[144:145], v156 offset:43008
  ds_read_b64_tr_b16 a[146:147], v156 offset:43264
  s_waitcnt lgkmcnt(14)
  v_mfma_f32_16x16x32_bf16 v[152:155], a[68:71], a[116:119], v[152:155]
  ds_read_b64_tr_b16 a[148:149], v156 offset:43016
  ds_read_b64_tr_b16 a[150:151], v156 offset:43272
  s_waitcnt lgkmcnt(14)
  v_mfma_f32_16x16x32_bf16 v[160:163], a[120:123], a[96:99], 0
  ds_read_b64_tr_b16 a[152:153], v157 offset:0
  ds_read_b64_tr_b16 a[154:155], v157 offset:256
  s_waitcnt lgkmcnt(14)
  v_mfma_f32_16x16x32_bf16 v[164:167], a[124:127], a[96:99], 0
  ds_read_b64_tr_b16 a[156:157], v157 offset:8
  ds_read_b64_tr_b16 a[158:159], v157 offset:264
  s_waitcnt lgkmcnt(14)
  v_mfma_f32_16x16x32_bf16 v[160:163], a[128:131], a[100:103], v[160:163]
  ds_read_b64_tr_b16 a[160:161], v157 offset:2048
  ds_read_b64_tr_b16 a[162:163], v157 offset:2304
  s_waitcnt lgkmcnt(14)
  v_mfma_f32_16x16x32_bf16 v[164:167], a[132:135], a[100:103], v[164:167]
  ds_read_b64_tr_b16 a[164:165], v157 offset:2056
  ds_read_b64_tr_b16 a[166:167], v157 offset:2312
  s_waitcnt lgkmcnt(14)
  v_mfma_f32_16x16x32_bf16 v[160:163], a[136:139], a[104:107], v[160:163]
  v_add_f32 v152, v152, v152
  s_waitcnt lgkmcnt(12)
  v_mfma_f32_16x16x32_bf16 v[164:167], a[140:143], a[104:107], v[164:167]
  v_add_f32 v153, v153, v153
  v_add_f32 v154, v154, v154
  v_add_f32 v155, v155, v155
  s_waitcnt lgkmcnt(10)
  v_mfma_f32_16x16x32_bf16 v[160:163], a[144:147], a[108:111], v[160:163]
  v_add_f32 v144, v144, v144
  s_waitcnt lgkmcnt(8)
  v_mfma_f32_16x16x32_bf16 v[164:167], a[148:151], a[108:111], v[164:167]
  v_add_f32 v145, v145, v145
  v_cvt_pk_bf16_f32 v172, v152, v153
  v_cvt_pk_bf16_f32 v173, v154, v155
  s_waitcnt lgkmcnt(6)
  v_mfma_f32_16x16x32_bf16 v[160:163], a[152:155], a[112:115], v[160:163]
  v_add_f32 v146, v146, v146
  s_waitcnt lgkmcnt(4)
  v_mfma_f32_16x16x32_bf16 v[164:167], a[156:159], a[112:115], v[164:167]
  v_add_f32 v147, v147, v147
  v_add_f32 v148, v148, v148
  v_add_f32 v149, v149, v149
  s_waitcnt lgkmcnt(2)
  v_mfma_f32_16x16x32_bf16 v[160:163], a[160:163], a[116:119], v[160:163]
  v_add_f32 v150, v150, v150
  s_waitcnt lgkmcnt(0)
  v_mfma_f32_16x16x32_bf16 v[164:167], a[164:167], a[116:119], v[164:167]
  v_add_f32 v151, v151, v151
  v_cvt_pk_bf16_f32 v168, v144, v145
  v_cvt_pk_bf16_f32 v169, v146, v147
  s_waitcnt vmcnt(14)
  v_mfma_f32_16x16x16_bf16 v[120:123], v[184:185], v[172:173], 0
  v_cvt_pk_bf16_f32 v170, v148, v149
  s_waitcnt vmcnt(12)
  v_mfma_f32_16x16x16_bf16 v[124:127], v[186:187], v[172:173], 0
  v_cvt_pk_bf16_f32 v171, v150, v151
  s_nop 1
  v_mfma_f32_16x16x32_bf16 v[160:163], v[176:179], v[168:171], v[160:163]
  v_mfma_f32_16x16x32_bf16 v[164:167], v[180:183], v[168:171], v[164:167]
  s_nop 6
  v_add_f32 v160, v160, v120
  v_add_f32 v161, v161, v121
  v_add_f32 v162, v162, v122
  v_add_f32 v163, v163, v123
  v_mul_f32 v160, 0x3fb8aa3b, v160
  v_mul_f32 v161, 0x3fb8aa3b, v161
  v_mul_f32 v162, 0x3fb8aa3b, v162
  v_mul_f32 v163, 0x3fb8aa3b, v163
  v_bfi_b32 v160, s92, v234, v160
  buffer_store_dwordx4 v[160:163], v255, s[28:31], s43 offen sc1
  v_add_f32 v165, v165, v125
  v_add_f32 v166, v166, v126
  v_mul_f32 v165, 0x3fb8aa3b, v165
  v_add_f32 v164, v164, v124
  v_add_f32 v167, v167, v127
  v_mul_f32 v166, 0x3fb8aa3b, v166
  v_mul_f32 v164, 0x3fb8aa3b, v164
  v_mul_f32 v167, 0x3fb8aa3b, v167
  v_bfi_b32 v164, s92, v234, v164
  buffer_store_dwordx4 v[164:167], v255, s[28:31], s43 offen offset:1024 sc1
  s_mov_b64 exec, 1
  buffer_store_dword v234, v235, s[20:23], s91 offen sc1
  s_mov_b64 exec, -1
  s_mov_b32 s8, s66
  s_and_b32 s9, s67, 0xffff
  s_mov_b32 s28, s86
  s_and_b32 s29, s87, 0xffff
  s_mov_b32 s20, s84
  s_and_b32 s21, s85, 0xffff
  s_mov_b32 s32, s76
  s_and_b32 s33, s77, 0xffff
  v_and_b32 v234, 2, v229
  v_lshlrev_b32 v234, 1, v234
  v_lshrrev_b32 v235, 3, v229
  v_or_b32 v234, v234, v235
  v_xor_b32 v235, v231, v235
  v_and_b32 v235, 1, v235
  v_lshlrev_b32 v235, 1, v235
  v_or_b32 v237, v234, v235
  v_and_b32 v234, 1, v229
  v_xor_b32 v237, v237, v234
  v_xor_b32 v234, v230, v237
  v_lshlrev_b32 v234, 4, v234
  v_lshlrev_b32 v235, 7, v229
  v_add_u32 v235, s37, v235
  v_add_u32 v245, v234, v235
  v_xor_b32 v246, 64, v245
  v_lshrrev_b32 v234, 1, v230
  v_xor_b32 v237, v234, v237
  v_lshl_add_u32 v237, v237, 4, v235
  v_and_b32 v236, 1, v230
  v_mul_u32_u24 v236, 6144, v236
  v_add_u32 v199, v237, v236
  v_add_u32 v203, v199, v236
  v_xor_b32 v200, 32, v199
  v_xor_b32 v204, 32, v203
  v_xor_b32 v201, 64, v199
  v_xor_b32 v205, 64, v203
  v_xor_b32 v202, 96, v199
  v_xor_b32 v206, 96, v203
  v_mul_u32_u24 v235, 3, v234
  v_and_b32 v236, 2, v231
  v_lshlrev_b32 v236, 1, v236
  v_or_b32 v235, v235, v236
  v_and_b32 v236, 1, v231
  v_xor_b32 v235, v235, v236
  v_and_b32 v236, 1, v230
  v_lshlrev_b32 v236, 1, v236
  v_lshrrev_b32 v237, 1, v232
  v_or_b32 v236, v236, v237
  v_xor_b32 v235, v235, v236
  v_lshlrev_b32 v235, 4, v235
  v_lshlrev_b32 v236, 3, v234
  v_add_u32 v236, v236, v231
  v_lshlrev_b32 v236, 7, v236
  v_add_u32 v236, v236, v235
  v_and_b32 v235, 1, v232
  v_lshl_add_u32 v236, v235, 3, v236
  v_add_u32 v247, s37, v236
  v_xor_b32 v248, 64, v247
  v_xor_b32 v249, 32, v247
  v_xor_b32 v250, 96, v247
  v_mul_u32_u24 v234, 3072, v234
  v_lshl_add_u32 v234, v231, 7, v234
  v_lshl_add_u32 v234, v235, 5, v234
  v_lshl_add_u32 v234, v237, 3, v234
  v_lshrrev_b32 v235, 1, v231
  v_lshl_add_u32 v234, v235, 6, v234
  v_and_b32 v235, 1, v230
  v_lshl_add_u32 v195, v235, 4, v234
  v_xor_b32 v196, 64, v195
  v_add_u32 v197, 81920, v195
  v_add_u32 v198, 81920, v196
  v_mov_b32 v102, 0
  v_add_u32 v103, s37, v255
  v_mov_b32 v236, 0x3f803f80
  v_mov_b32 v237, 1.0
  v_accvgpr_write_b32 a168, v236
  v_accvgpr_write_b32 a169, v236
  v_accvgpr_write_b32 a170, v236
  v_accvgpr_write_b32 a171, v236
  v_accvgpr_write_b32 a172, v237
  s_mov_b32 s48, 0xaaaaaaaa
  s_mov_b32 s49, 0xaaaaaaaa
  s_mov_b32 s50, 0xcccccccc
  s_mov_b32 s51, 0xcccccccc
  s_mov_b32 s52, 0x00f0000f
  s_mov_b32 s53, 0xf0000f00
  s_mov_b32 s54, 0xffff0000
  s_mov_b32 s55, 0xffff0000
  s_mov_b32 s88, 0x4e800000
  s_mov_b32 s89, 0xbbaaaaab
  s_mov_b32 s90, 0x3afba882
  s_mov_b32 s93, 0
  s_lshr_b32 s46, s2, 3
  s_and_b32 s46, s46, 0
  s_lshr_b32 s91, s46, 2
  s_add_u32 s92, s2, 1
  s_sub_u32 s92, s92, s91
  s_add_u32 s91, s2, s91
  s_mul_i32 s91, s91, 196608
  s_mul_i32 s92, s92, 196608
  s_lshl1_add_u32 s64, s38, s91
  s_lshl1_add_u32 s65, s38, s92
  s_lshl1_add_u32 s66, s39, s91
  s_lshl1_add_u32 s67, s39, s92
  s_lshl1_add_u32 s68, s3, s91
  s_lshl1_add_u32 s69, s3, s92
  s_lshl1_add_u32 s70, s45, s91
  s_lshl1_add_u32 s71, s45, s92
  s_waitcnt vmcnt(3)
  ds_read_b128 a[176:179], v199 offset:24576
  ds_read_b128 a[180:183], v200 offset:24576
  ds_read_b128 a[184:187], v201 offset:24576
  ds_read_b128 a[188:191], v202 offset:24576
  ds_read_b128 a[192:195], v199 offset:26624
  ds_read_b128 a[196:199], v200 offset:26624
  ds_read_b128 a[200:203], v201 offset:26624
  ds_read_b128 a[204:207], v202 offset:26624
  ds_read_b128 a[208:211], v199 offset:28672
  ds_read_b128 a[212:215], v200 offset:28672
  ds_read_b128 a[216:219], v201 offset:28672
  ds_read_b128 a[220:223], v202 offset:28672
  s_barrier
  s_add_u32 m0, s37, 30720
  s_waitcnt lgkmcnt(0)
  buffer_load_dwordx4 v192, s[12:15], s45 offen nt lds
  s_add_u32 m0, s37, 31744
  s_nop 0
  buffer_load_dwordx4 v193, s[12:15], s45 offen nt lds
  s_add_u32 m0, s37, 32640
  s_nop 0
  buffer_load_dwordx4 v192, s[12:15], s45 offen offset:128 nt lds
  s_add_u32 m0, s37, 33664
  s_nop 0
  buffer_load_dwordx4 v193, s[12:15], s45 offen offset:128 nt lds
  s_add_u32 m0, s37, 34560
  s_nop 0
  buffer_load_dwordx4 v192, s[12:15], s45 offen offset:256 nt lds
  s_add_u32 m0, s37, 35584
  s_nop 0
  buffer_load_dwordx4 v193, s[12:15], s45 offen offset:256 nt lds
  s_waitcnt vmcnt(6)
  s_barrier
  s_branch L_pend
L_spin:
  buffer_load_dwordx4 v[108:111], v102, s[20:23], s47 offen sc1
  buffer_load_dwordx2 v[104:105], v102, s[20:23], s47 offen offset:16 sc1
  buffer_load_dwordx4 v[72:75], v255, s[28:31], s91 offen sc1
  buffer_load_dwordx4 v[168:171], v255, s[28:31], s91 offen offset:1024 sc1
  buffer_load_dwordx4 v[76:79], v255, s[28:31], s91 offen offset:2048 sc1
  buffer_load_dwordx4 v[172:175], v255, s[28:31], s91 offen offset:3072 sc1
  buffer_load_dwordx4 v[80:83], v255, s[28:31], s92 offen sc1
  buffer_load_dwordx4 v[176:179], v255, s[28:31], s92 offen offset:1024 sc1
  buffer_load_dwordx4 v[84:87], v255, s[28:31], s92 offen offset:2048 sc1
  buffer_load_dwordx4 v[180:183], v255, s[28:31], s92 offen offset:3072 sc1
  buffer_load_dwordx4 v[88:91], v255, s[28:31], s46 offen sc1
  buffer_load_dwordx4 v[184:187], v255, s[28:31], s46 offen offset:1024 sc1
  buffer_load_dwordx4 v[92:95], v255, s[28:31], s46 offen offset:2048 sc1
  buffer_load_dwordx4 v[188:191], v255, s[28:31], s46 offen offset:3072 sc1
  s_add_u32 s93, s93, 1
  s_waitcnt vmcnt(0)
  v_xor_b32 v107, v72, v108
  v_xor_b32 v106, v168, v108
  v_or_b32 v207, v107, v106
  v_xor_b32 v107, v76, v109
  v_xor_b32 v106, v172, v109
  v_or3_b32 v207, v207, v107, v106
  v_xor_b32 v107, v80, v110
  v_xor_b32 v106, v176, v110
  v_or3_b32 v207, v207, v107, v106
  v_xor_b32 v107, v84, v111
  v_xor_b32 v106, v180, v111
  v_or3_b32 v207, v207, v107, v106
  v_xor_b32 v107, v88, v104
  v_xor_b32 v106, v184, v104
  v_or3_b32 v207, v207, v107, v106
  v_xor_b32 v107, v92, v105
  v_xor_b32 v106, v188, v105
  v_or3_b32 v207, v207, v107, v106
  v_min3_u32 v107, v108, v109, v110
  v_min3_u32 v107, v107, v111, v104
  v_min_u32 v107, v107, v105
  v_and_b32 v207, 0xff, v207
  v_cmp_eq_u32_e64 s[6:7], 0, v107
  v_cmp_ne_u32 vcc, 0, v207
  s_cmp_gt_u32 s93, 0x20000
  s_cbranch_scc1 L_pok
  s_or_b64 vcc, vcc, s[6:7]
  s_cbranch_scc1 L_spin
  s_branch L_pok
L_tr_2_0:
  s_mov_b32 s46, 0
  s_branch L_slow_0_0
L_tr_4_0:
  s_mov_b32 s46, 1
  s_branch L_slow_0_0
L_tr_6_0:
  s_mov_b32 s46, 2
  s_branch L_slow_0_0
L_tr_8_0:
  s_mov_b32 s46, 3
  s_branch L_slow_0_0
L_tr_10_0:
  s_mov_b32 s46, 4
  s_branch L_slow_0_0
L_tr_12_0:
  s_mov_b32 s46, 5
  s_branch L_slow_0_0
L_tr_14_0:
  s_mov_b32 s46, 6
  s_branch L_slow_0_0
L_slow_0_0:
  s_nop 15
  s_nop 3
  v_mul_f32 v168, v136, v220
  v_mul_f32 v169, v137, v221
  v_mul_f32 v170, v138, v222
  v_mul_f32 v171, v139, v223
  v_max3_f32 v236, v168, v169, v170
  v_max_f32 v236, v236, v171
  v_mul_f32 v172, v140, v220
  v_mul_f32 v173, v141, v221
  v_mul_f32 v174, v142, v222
  v_mul_f32 v175, v143, v223
  v_max3_f32 v237, v172, v173, v174
  v_max_f32 v237, v237, v175
  v_mov_b32 v168, v236
  s_nop 1
  v_permlane32_swap_b32 v236, v168
  v_max_f32 v236, v236, v168
  v_mov_b32 v168, v236
  s_nop 1
  v_permlane16_swap_b32 v236, v168
  v_max_f32 v236, v236, v168
  v_min_f32 v236, v228, -v236
  v_sub_f32 v169, v236, v228
  v_exp_f32 v169, v169
  v_mov_b32 v228, v236
  v_mul_f32 v232, v232, v169
  v_mul_f32 v192, v192, v169
  v_mul_f32 v193, v193, v169
  v_mul_f32 v194, v194, v169
  v_mul_f32 v195, v195, v169
  v_mov_b32 v172, v237
  s_nop 1
  v_permlane32_swap_b32 v237, v172
  v_max_f32 v237, v237, v172
  v_mov_b32 v172, v237
  s_nop 1
  v_permlane16_swap_b32 v237, v172
  v_max_f32 v237, v237, v172
  v_min_f32 v237, v229, -v237
  v_sub_f32 v173, v237, v229
  v_exp_f32 v173, v173
  v_mov_b32 v229, v237
  v_mul_f32 v233, v233, v173
  v_mul_f32 v196, v196, v173
  v_mul_f32 v197, v197, v173
  v_mul_f32 v198, v198, v173
  v_mul_f32 v199, v199, v173
  v_cndmask_b32 v170, v169, v173, s[54:55]
  v_mul_f32 v0, v0, v170
  v_mul_f32 v1, v1, v170
  v_mul_f32 v2, v2, v170
  v_mul_f32 v3, v3, v170
  v_mul_f32 v4, v4, v170
  v_mul_f32 v5, v5, v170
  v_mul_f32 v6, v6, v170
  v_mul_f32 v7, v7, v170
  v_mul_f32 v8, v8, v170
  v_mul_f32 v9, v9, v170
  v_mul_f32 v10, v10, v170
  v_mul_f32 v11, v11, v170
  v_mul_f32 v12, v12, v170
  v_mul_f32 v13, v13, v170
  v_mul_f32 v14, v14, v170
  v_mul_f32 v15, v15, v170
  v_mul_f32 v16, v16, v170
  v_mul_f32 v17, v17, v170
  v_mul_f32 v18, v18, v170
  v_mul_f32 v19, v19, v170
  v_mul_f32 v20, v20, v170
  v_mul_f32 v21, v21, v170
  v_mul_f32 v22, v22, v170
  v_mul_f32 v23, v23, v170
  v_mul_f32 v24, v24, v170
  v_mul_f32 v25, v25, v170
  v_mul_f32 v26, v26, v170
  v_mul_f32 v27, v27, v170
  v_mul_f32 v28, v28, v170
  v_mul_f32 v29, v29, v170
  v_mul_f32 v30, v30, v170
  v_mul_f32 v31, v31, v170
  v_mul_f32 v32, v32, v170
  v_mul_f32 v33, v33, v170
  v_mul_f32 v34, v34, v170
  v_mul_f32 v35, v35, v170
  v_mul_f32 v36, v36, v170
  v_mul_f32 v37, v37, v170
  v_mul_f32 v38, v38, v170
  v_mul_f32 v39, v39, v170
  v_mul_f32 v40, v40, v170
  v_mul_f32 v41, v41, v170
  v_mul_f32 v42, v42, v170
  v_mul_f32 v43, v43, v170
  v_mul_f32 v44, v44, v170
  v_mul_f32 v45, v45, v170
  v_mul_f32 v46, v46, v170
  v_mul_f32 v47, v47, v170
  v_mul_f32 v48, v48, v170
  v_mul_f32 v49, v49, v170
  v_mul_f32 v50, v50, v170
  v_mul_f32 v51, v51, v170
  v_mul_f32 v52, v52, v170
  v_mul_f32 v53, v53, v170
  v_mul_f32 v54, v54, v170
  v_mul_f32 v55, v55, v170
  v_mul_f32 v56, v56, v170
  v_mul_f32 v57, v57, v170
  v_mul_f32 v58, v58, v170
  v_mul_f32 v59, v59, v170
  v_mul_f32 v60, v60, v170
  v_mul_f32 v61, v61, v170
  v_mul_f32 v62, v62, v170
  v_mul_f32 v63, v63, v170
  v_mul_f32 v64, v64, v170
  v_mul_f32 v65, v65, v170
  v_mul_f32 v66, v66, v170
  v_mul_f32 v67, v67, v170
  v_mul_f32 v68, v68, v170
  v_mul_f32 v69, v69, v170
  v_mul_f32 v70, v70, v170
  v_mul_f32 v71, v71, v170
  v_mul_f32 v72, v72, v170
  v_mul_f32 v73, v73, v170
  v_mul_f32 v74, v74, v170
  v_mul_f32 v75, v75, v170
  v_mul_f32 v76, v76, v170
  v_mul_f32 v77, v77, v170
  v_mul_f32 v78, v78, v170
  v_mul_f32 v79, v79, v170
  v_mul_f32 v80, v80, v170
  v_mul_f32 v81, v81, v170
  v_mul_f32 v82, v82, v170
  v_mul_f32 v83, v83, v170
  v_mul_f32 v84, v84, v170
  v_mul_f32 v85, v85, v170
  v_mul_f32 v86, v86, v170
  v_mul_f32 v87, v87, v170
  v_mul_f32 v88, v88, v170
  v_mul_f32 v89, v89, v170
  v_mul_f32 v90, v90, v170
  v_mul_f32 v91, v91, v170
  v_mul_f32 v92, v92, v170
  v_mul_f32 v93, v93, v170
  v_mul_f32 v94, v94, v170
  v_mul_f32 v95, v95, v170
  v_fma_f32 v168, v136, v220, v228
  v_fma_f32 v169, v137, v221, v228
  v_fma_f32 v170, v138, v222, v228
  v_fma_f32 v171, v139, v223, v228
  v_fma_f32 v172, v140, v220, v229
  v_fma_f32 v173, v141, v221, v229
  v_fma_f32 v174, v142, v222, v229
  v_fma_f32 v175, v143, v223, v229
  v_exp_f32 v168, v168
  v_exp_f32 v169, v169
  v_exp_f32 v170, v170
  v_exp_f32 v171, v171
  v_exp_f32 v172, v172
  v_exp_f32 v173, v173
  v_exp_f32 v174, v174
  v_exp_f32 v175, v175
  s_nop 0
  v_add_f32 v236, v168, v169
  v_add_f32 v236, v236, v170
  v_add_f32 v236, v236, v171
  v_add_f32 v237, v172, v173
  v_add_f32 v237, v237, v174
  v_add_f32 v237, v237, v175
  s_nop 3
  s_cmp_eq_u32 s46, 0
  s_cbranch_scc1 L_ret_2_0
  s_cmp_eq_u32 s46, 1
  s_cbranch_scc1 L_ret_4_0
  s_cmp_eq_u32 s46, 2
  s_cbranch_scc1 L_ret_6_0
  s_cmp_eq_u32 s46, 3
  s_cbranch_scc1 L_ret_8_0
  s_cmp_eq_u32 s46, 4
  s_cbranch_scc1 L_ret_10_0
  s_cmp_eq_u32 s46, 5
  s_cbranch_scc1 L_ret_12_0
  s_branch L_ret_14_0
L_tr_1_0:
  s_mov_b32 s46, 0
  s_branch L_slow_0_1
L_tr_3_0:
  s_mov_b32 s46, 1
  s_branch L_slow_0_1
L_tr_5_0:
  s_mov_b32 s46, 2
  s_branch L_slow_0_1
L_tr_7_0:
  s_mov_b32 s46, 3
  s_branch L_slow_0_1
L_tr_9_0:
  s_mov_b32 s46, 4
  s_branch L_slow_0_1
L_tr_11_0:
  s_mov_b32 s46, 5
  s_branch L_slow_0_1
L_tr_13_0:
  s_mov_b32 s46, 6
  s_branch L_slow_0_1
L_tr_15_0:
  s_mov_b32 s46, 7
  s_branch L_slow_0_1
L_slow_0_1:
  s_nop 15
  s_nop 3
  v_mul_f32 v168, v136, v224
  v_mul_f32 v169, v137, v225
  v_mul_f32 v170, v138, v226
  v_mul_f32 v171, v139, v227
  v_max3_f32 v236, v168, v169, v170
  v_max_f32 v236, v236, v171
  v_mul_f32 v172, v140, v224
  v_mul_f32 v173, v141, v225
  v_mul_f32 v174, v142, v226
  v_mul_f32 v175, v143, v227
  v_max3_f32 v237, v172, v173, v174
  v_max_f32 v237, v237, v175
  v_mov_b32 v168, v236
  s_nop 1
  v_permlane32_swap_b32 v236, v168
  v_max_f32 v236, v236, v168
  v_mov_b32 v168, v236
  s_nop 1
  v_permlane16_swap_b32 v236, v168
  v_max_f32 v236, v236, v168
  v_min_f32 v236, v228, -v236
  v_sub_f32 v169, v236, v228
  v_exp_f32 v169, v169
  v_mov_b32 v228, v236
  v_mul_f32 v232, v232, v169
  v_mul_f32 v192, v192, v169
  v_mul_f32 v193, v193, v169
  v_mul_f32 v194, v194, v169
  v_mul_f32 v195, v195, v169
  v_mov_b32 v172, v237
  s_nop 1
  v_permlane32_swap_b32 v237, v172
  v_max_f32 v237, v237, v172
  v_mov_b32 v172, v237
  s_nop 1
  v_permlane16_swap_b32 v237, v172
  v_max_f32 v237, v237, v172
  v_min_f32 v237, v229, -v237
  v_sub_f32 v173, v237, v229
  v_exp_f32 v173, v173
  v_mov_b32 v229, v237
  v_mul_f32 v233, v233, v173
  v_mul_f32 v196, v196, v173
  v_mul_f32 v197, v197, v173
  v_mul_f32 v198, v198, v173
  v_mul_f32 v199, v199, v173
  v_cndmask_b32 v170, v169, v173, s[54:55]
  v_mul_f32 v0, v0, v170
  v_mul_f32 v1, v1, v170
  v_mul_f32 v2, v2, v170
  v_mul_f32 v3, v3, v170
  v_mul_f32 v4, v4, v170
  v_mul_f32 v5, v5, v170
  v_mul_f32 v6, v6, v170
  v_mul_f32 v7, v7, v170
  v_mul_f32 v8, v8, v170
  v_mul_f32 v9, v9, v170
  v_mul_f32 v10, v10, v170
  v_mul_f32 v11, v11, v170
  v_mul_f32 v12, v12, v170
  v_mul_f32 v13, v13, v170
  v_mul_f32 v14, v14, v170
  v_mul_f32 v15, v15, v170
  v_mul_f32 v16, v16, v170
  v_mul_f32 v17, v17, v170
  v_mul_f32 v18, v18, v170
  v_mul_f32 v19, v19, v170
  v_mul_f32 v20, v20, v170
  v_mul_f32 v21, v21, v170
  v_mul_f32 v22, v22, v170
  v_mul_f32 v23, v23, v170
  v_mul_f32 v24, v24, v170
  v_mul_f32 v25, v25, v170
  v_mul_f32 v26, v26, v170
  v_mul_f32 v27, v27, v170
  v_mul_f32 v28, v28, v170
  v_mul_f32 v29, v29, v170
  v_mul_f32 v30, v30, v170
  v_mul_f32 v31, v31, v170
  v_mul_f32 v32, v32, v170
  v_mul_f32 v33, v33, v170
  v_mul_f32 v34, v34, v170
  v_mul_f32 v35, v35, v170
  v_mul_f32 v36, v36, v170
  v_mul_f32 v37, v37, v170
  v_mul_f32 v38, v38, v170
  v_mul_f32 v39, v39, v170
  v_mul_f32 v40, v40, v170
  v_mul_f32 v41, v41, v170
  v_mul_f32 v42, v42, v170
  v_mul_f32 v43, v43, v170
  v_mul_f32 v44, v44, v170
  v_mul_f32 v45, v45, v170
  v_mul_f32 v46, v46, v170
  v_mul_f32 v47, v47, v170
  v_mul_f32 v48, v48, v170
  v_mul_f32 v49, v49, v170
  v_mul_f32 v50, v50, v170
  v_mul_f32 v51, v51, v170
  v_mul_f32 v52, v52, v170
  v_mul_f32 v53, v53, v170
  v_mul_f32 v54, v54, v170
  v_mul_f32 v55, v55, v170
  v_mul_f32 v56, v56, v170
  v_mul_f32 v57, v57, v170
  v_mul_f32 v58, v58, v170
  v_mul_f32 v59, v59, v170
  v_mul_f32 v60, v60, v170
  v_mul_f32 v61, v61, v170
  v_mul_f32 v62, v62, v170
  v_mul_f32 v63, v63, v170
  v_mul_f32 v64, v64, v170
  v_mul_f32 v65, v65, v170
  v_mul_f32 v66, v66, v170
  v_mul_f32 v67, v67, v170
  v_mul_f32 v68, v68, v170
  v_mul_f32 v69, v69, v170
  v_mul_f32 v70, v70, v170
  v_mul_f32 v71, v71, v170
  v_mul_f32 v72, v72, v170
  v_mul_f32 v73, v73, v170
  v_mul_f32 v74, v74, v170
  v_mul_f32 v75, v75, v170
  v_mul_f32 v76, v76, v170
  v_mul_f32 v77, v77, v170
  v_mul_f32 v78, v78, v170
  v_mul_f32 v79, v79, v170
  v_mul_f32 v80, v80, v170
  v_mul_f32 v81, v81, v170
  v_mul_f32 v82, v82, v170
  v_mul_f32 v83, v83, v170
  v_mul_f32 v84, v84, v170
  v_mul_f32 v85, v85, v170
  v_mul_f32 v86, v86, v170
  v_mul_f32 v87, v87, v170
  v_mul_f32 v88, v88, v170
  v_mul_f32 v89, v89, v170
  v_mul_f32 v90, v90, v170
  v_mul_f32 v91, v91, v170
  v_mul_f32 v92, v92, v170
  v_mul_f32 v93, v93, v170
  v_mul_f32 v94, v94, v170
  v_mul_f32 v95, v95, v170
  v_fma_f32 v168, v136, v224, v228
  v_fma_f32 v169, v137, v225, v228
  v_fma_f32 v170, v138, v226, v228
  v_fma_f32 v171, v139, v227, v228
  v_fma_f32 v172, v140, v224, v229
  v_fma_f32 v173, v141, v225, v229
  v_fma_f32 v174, v142, v226, v229
  v_fma_f32 v175, v143, v227, v229
  v_exp_f32 v168, v168
  v_exp_f32 v169, v169
  v_exp_f32 v170, v170
  v_exp_f32 v171, v171
  v_exp_f32 v172, v172
  v_exp_f32 v173, v173
  v_exp_f32 v174, v174
  v_exp_f32 v175, v175
  s_nop 0
  v_add_f32 v236, v168, v169
  v_add_f32 v236, v236, v170
  v_add_f32 v236, v236, v171
  v_add_f32 v237, v172, v173
  v_add_f32 v237, v237, v174
  v_add_f32 v237, v237, v175
  s_nop 3
  s_cmp_eq_u32 s46, 0
  s_cbranch_scc1 L_ret_1_0
  s_cmp_eq_u32 s46, 1
  s_cbranch_scc1 L_ret_3_0
  s_cmp_eq_u32 s46, 2
  s_cbranch_scc1 L_ret_5_0
  s_cmp_eq_u32 s46, 3
  s_cbranch_scc1 L_ret_7_0
  s_cmp_eq_u32 s46, 4
  s_cbranch_scc1 L_ret_9_0
  s_cmp_eq_u32 s46, 5
  s_cbranch_scc1 L_ret_11_0
  s_cmp_eq_u32 s46, 6
  s_cbranch_scc1 L_ret_13_0
  s_branch L_ret_15_0
L_tr_2_1:
  s_mov_b32 s46, 0
  s_branch L_slow_1_0
L_tr_4_1:
  s_mov_b32 s46, 1
  s_branch L_slow_1_0
L_tr_6_1:
  s_mov_b32 s46, 2
  s_branch L_slow_1_0
L_tr_8_1:
  s_mov_b32 s46, 3
  s_branch L_slow_1_0
L_tr_10_1:
  s_mov_b32 s46, 4
  s_branch L_slow_1_0
L_tr_12_1:
  s_mov_b32 s46, 5
  s_branch L_slow_1_0
L_tr_14_1:
  s_mov_b32 s46, 6
  s_branch L_slow_1_0
L_slow_1_0:
  s_nop 15
  s_nop 3
  v_mul_f32 v176, v144, v220
  v_mul_f32 v177, v145, v221
  v_mul_f32 v178, v146, v222
  v_mul_f32 v179, v147, v223
  v_max3_f32 v238, v176, v177, v178
  v_max_f32 v238, v238, v179
  v_mul_f32 v180, v148, v220
  v_mul_f32 v181, v149, v221
  v_mul_f32 v182, v150, v222
  v_mul_f32 v183, v151, v223
  v_max3_f32 v239, v180, v181, v182
  v_max_f32 v239, v239, v183
  v_mov_b32 v176, v238
  s_nop 1
  v_permlane32_swap_b32 v238, v176
  v_max_f32 v238, v238, v176
  v_mov_b32 v176, v238
  s_nop 1
  v_permlane16_swap_b32 v238, v176
  v_max_f32 v238, v238, v176
  v_min_f32 v238, v230, -v238
  v_sub_f32 v177, v238, v230
  v_exp_f32 v177, v177
  v_mov_b32 v230, v238
  v_mul_f32 v234, v234, v177
  v_mul_f32 v200, v200, v177
  v_mul_f32 v201, v201, v177
  v_mul_f32 v202, v202, v177
  v_mul_f32 v203, v203, v177
  v_mov_b32 v180, v239
  s_nop 1
  v_permlane32_swap_b32 v239, v180
  v_max_f32 v239, v239, v180
  v_mov_b32 v180, v239
  s_nop 1
  v_permlane16_swap_b32 v239, v180
  v_max_f32 v239, v239, v180
  v_min_f32 v239, v231, -v239
  v_sub_f32 v181, v239, v231
  v_exp_f32 v181, v181
  v_mov_b32 v231, v239
  v_mul_f32 v235, v235, v181
  v_mul_f32 v204, v204, v181
  v_mul_f32 v205, v205, v181
  v_mul_f32 v206, v206, v181
  v_mul_f32 v207, v207, v181
  v_cndmask_b32 v178, v177, v181, s[54:55]
  v_mul_f32 v96, v96, v178
  v_mul_f32 v97, v97, v178
  v_mul_f32 v98, v98, v178
  v_mul_f32 v99, v99, v178
  v_mul_f32 v100, v100, v178
  v_mul_f32 v101, v101, v178
  v_mul_f32 v102, v102, v178
  v_mul_f32 v103, v103, v178
  v_mul_f32 v104, v104, v178
  v_mul_f32 v105, v105, v178
  v_mul_f32 v106, v106, v178
  v_mul_f32 v107, v107, v178
  v_mul_f32 v108, v108, v178
  v_mul_f32 v109, v109, v178
  v_mul_f32 v110, v110, v178
  v_mul_f32 v111, v111, v178
  v_accvgpr_read_b32 v176, a176
  v_mul_f32 v176, v176, v178
  v_accvgpr_write_b32 a176, v176
  v_accvgpr_read_b32 v179, a177
  v_mul_f32 v179, v179, v178
  v_accvgpr_write_b32 a177, v179
  v_accvgpr_read_b32 v180, a178
  v_mul_f32 v180, v180, v178
  v_accvgpr_write_b32 a178, v180
  v_accvgpr_read_b32 v182, a179
  v_mul_f32 v182, v182, v178
  v_accvgpr_write_b32 a179, v182
  v_accvgpr_read_b32 v183, a180
  v_mul_f32 v183, v183, v178
  v_accvgpr_write_b32 a180, v183
  v_accvgpr_read_b32 v176, a181
  v_mul_f32 v176, v176, v178
  v_accvgpr_write_b32 a181, v176
  v_accvgpr_read_b32 v179, a182
  v_mul_f32 v179, v179, v178
  v_accvgpr_write_b32 a182, v179
  v_accvgpr_read_b32 v180, a183
  v_mul_f32 v180, v180, v178
  v_accvgpr_write_b32 a183, v180
  v_accvgpr_read_b32 v182, a184
  v_mul_f32 v182, v182, v178
  v_accvgpr_write_b32 a184, v182
  v_accvgpr_read_b32 v183, a185
  v_mul_f32 v183, v183, v178
  v_accvgpr_write_b32 a185, v183
  v_accvgpr_read_b32 v176, a186
  v_mul_f32 v176, v176, v178
  v_accvgpr_write_b32 a186, v176
  v_accvgpr_read_b32 v179, a187
  v_mul_f32 v179, v179, v178
  v_accvgpr_write_b32 a187, v179
  v_accvgpr_read_b32 v180, a188
  v_mul_f32 v180, v180, v178
  v_accvgpr_write_b32 a188, v180
  v_accvgpr_read_b32 v182, a189
  v_mul_f32 v182, v182, v178
  v_accvgpr_write_b32 a189, v182
  v_accvgpr_read_b32 v183, a190
  v_mul_f32 v183, v183, v178
  v_accvgpr_write_b32 a190, v183
  v_accvgpr_read_b32 v176, a191
  v_mul_f32 v176, v176, v178
  v_accvgpr_write_b32 a191, v176
  v_accvgpr_read_b32 v179, a192
  v_mul_f32 v179, v179, v178
  v_accvgpr_write_b32 a192, v179
  v_accvgpr_read_b32 v180, a193
  v_mul_f32 v180, v180, v178
  v_accvgpr_write_b32 a193, v180
  v_accvgpr_read_b32 v182, a194
  v_mul_f32 v182, v182, v178
  v_accvgpr_write_b32 a194, v182
  v_accvgpr_read_b32 v183, a195
  v_mul_f32 v183, v183, v178
  v_accvgpr_write_b32 a195, v183
  v_accvgpr_read_b32 v176, a196
  v_mul_f32 v176, v176, v178
  v_accvgpr_write_b32 a196, v176
  v_accvgpr_read_b32 v179, a197
  v_mul_f32 v179, v179, v178
  v_accvgpr_write_b32 a197, v179
  v_accvgpr_read_b32 v180, a198
  v_mul_f32 v180, v180, v178
  v_accvgpr_write_b32 a198, v180
  v_accvgpr_read_b32 v182, a199
  v_mul_f32 v182, v182, v178
  v_accvgpr_write_b32 a199, v182
  v_accvgpr_read_b32 v183, a200
  v_mul_f32 v183, v183, v178
  v_accvgpr_write_b32 a200, v183
  v_accvgpr_read_b32 v176, a201
  v_mul_f32 v176, v176, v178
  v_accvgpr_write_b32 a201, v176
  v_accvgpr_read_b32 v179, a202
  v_mul_f32 v179, v179, v178
  v_accvgpr_write_b32 a202, v179
  v_accvgpr_read_b32 v180, a203
  v_mul_f32 v180, v180, v178
  v_accvgpr_write_b32 a203, v180
  v_accvgpr_read_b32 v182, a204
  v_mul_f32 v182, v182, v178
  v_accvgpr_write_b32 a204, v182
  v_accvgpr_read_b32 v183, a205
  v_mul_f32 v183, v183, v178
  v_accvgpr_write_b32 a205, v183
  v_accvgpr_read_b32 v176, a206
  v_mul_f32 v176, v176, v178
  v_accvgpr_write_b32 a206, v176
  v_accvgpr_read_b32 v179, a207
  v_mul_f32 v179, v179, v178
  v_accvgpr_write_b32 a207, v179
  v_accvgpr_read_b32 v180, a208
  v_mul_f32 v180, v180, v178
  v_accvgpr_write_b32 a208, v180
  v_accvgpr_read_b32 v182, a209
  v_mul_f32 v182, v182, v178
  v_accvgpr_write_b32 a209, v182
  v_accvgpr_read_b32 v183, a210
  v_mul_f32 v183, v183, v178
  v_accvgpr_write_b32 a210, v183
  v_accvgpr_read_b32 v176, a211
  v_mul_f32 v176, v176, v178
  v_accvgpr_write_b32 a211, v176
  v_accvgpr_read_b32 v179, a212
  v_mul_f32 v179, v179, v178
  v_accvgpr_write_b32 a212, v179
  v_accvgpr_read_b32 v180, a213
  v_mul_f32 v180, v180, v178
  v_accvgpr_write_b32 a213, v180
  v_accvgpr_read_b32 v182, a214
  v_mul_f32 v182, v182, v178
  v_accvgpr_write_b32 a214, v182
  v_accvgpr_read_b32 v183, a215
  v_mul_f32 v183, v183, v178
  v_accvgpr_write_b32 a215, v183
  v_accvgpr_read_b32 v176, a216
  v_mul_f32 v176, v176, v178
  v_accvgpr_write_b32 a216, v176
  v_accvgpr_read_b32 v179, a217
  v_mul_f32 v179, v179, v178
  v_accvgpr_write_b32 a217, v179
  v_accvgpr_read_b32 v180, a218
  v_mul_f32 v180, v180, v178
  v_accvgpr_write_b32 a218, v180
  v_accvgpr_read_b32 v182, a219
  v_mul_f32 v182, v182, v178
  v_accvgpr_write_b32 a219, v182
  v_accvgpr_read_b32 v183, a220
  v_mul_f32 v183, v183, v178
  v_accvgpr_write_b32 a220, v183
  v_accvgpr_read_b32 v176, a221
  v_mul_f32 v176, v176, v178
  v_accvgpr_write_b32 a221, v176
  v_accvgpr_read_b32 v179, a222
  v_mul_f32 v179, v179, v178
  v_accvgpr_write_b32 a222, v179
  v_accvgpr_read_b32 v180, a223
  v_mul_f32 v180, v180, v178
  v_accvgpr_write_b32 a223, v180
  v_accvgpr_read_b32 v182, a224
  v_mul_f32 v182, v182, v178
  v_accvgpr_write_b32 a224, v182
  v_accvgpr_read_b32 v183, a225
  v_mul_f32 v183, v183, v178
  v_accvgpr_write_b32 a225, v183
  v_accvgpr_read_b32 v176, a226
  v_mul_f32 v176, v176, v178
  v_accvgpr_write_b32 a226, v176
  v_accvgpr_read_b32 v179, a227
  v_mul_f32 v179, v179, v178
  v_accvgpr_write_b32 a227, v179
  v_accvgpr_read_b32 v180, a228
  v_mul_f32 v180, v180, v178
  v_accvgpr_write_b32 a228, v180
  v_accvgpr_read_b32 v182, a229
  v_mul_f32 v182, v182, v178
  v_accvgpr_write_b32 a229, v182
  v_accvgpr_read_b32 v183, a230
  v_mul_f32 v183, v183, v178
  v_accvgpr_write_b32 a230, v183
  v_accvgpr_read_b32 v176, a231
  v_mul_f32 v176, v176, v178
  v_accvgpr_write_b32 a231, v176
  v_accvgpr_read_b32 v179, a232
  v_mul_f32 v179, v179, v178
  v_accvgpr_write_b32 a232, v179
  v_accvgpr_read_b32 v180, a233
  v_mul_f32 v180, v180, v178
  v_accvgpr_write_b32 a233, v180
  v_accvgpr_read_b32 v182, a234
  v_mul_f32 v182, v182, v178
  v_accvgpr_write_b32 a234, v182
  v_accvgpr_read_b32 v183, a235
  v_mul_f32 v183, v183, v178
  v_accvgpr_write_b32 a235, v183
  v_accvgpr_read_b32 v176, a236
  v_mul_f32 v176, v176, v178
  v_accvgpr_write_b32 a236, v176
  v_accvgpr_read_b32 v179, a237
  v_mul_f32 v179, v179, v178
  v_accvgpr_write_b32 a237, v179
  v_accvgpr_read_b32 v180, a238
  v_mul_f32 v180, v180, v178
  v_accvgpr_write_b32 a238, v180
  v_accvgpr_read_b32 v182, a239
  v_mul_f32 v182, v182, v178
  v_accvgpr_write_b32 a239, v182
  v_accvgpr_read_b32 v183, a240
  v_mul_f32 v183, v183, v178
  v_accvgpr_write_b32 a240, v183
  v_accvgpr_read_b32 v176, a241
  v_mul_f32 v176, v176, v178
  v_accvgpr_write_b32 a241, v176
  v_accvgpr_read_b32 v179, a242
  v_mul_f32 v179, v179, v178
  v_accvgpr_write_b32 a242, v179
  v_accvgpr_read_b32 v180, a243
  v_mul_f32 v180, v180, v178
  v_accvgpr_write_b32 a243, v180
  v_accvgpr_read_b32 v182, a244
  v_mul_f32 v182, v182, v178
  v_accvgpr_write_b32 a244, v182
  v_accvgpr_read_b32 v183, a245
  v_mul_f32 v183, v183, v178
  v_accvgpr_write_b32 a245, v183
  v_accvgpr_read_b32 v176, a246
  v_mul_f32 v176, v176, v178
  v_accvgpr_write_b32 a246, v176
  v_accvgpr_read_b32 v179, a247
  v_mul_f32 v179, v179, v178
  v_accvgpr_write_b32 a247, v179
  v_accvgpr_read_b32 v180, a248
  v_mul_f32 v180, v180, v178
  v_accvgpr_write_b32 a248, v180
  v_accvgpr_read_b32 v182, a249
  v_mul_f32 v182, v182, v178
  v_accvgpr_write_b32 a249, v182
  v_accvgpr_read_b32 v183, a250
  v_mul_f32 v183, v183, v178
  v_accvgpr_write_b32 a250, v183
  v_accvgpr_read_b32 v176, a251
  v_mul_f32 v176, v176, v178
  v_accvgpr_write_b32 a251, v176
  v_accvgpr_read_b32 v179, a252
  v_mul_f32 v179, v179, v178
  v_accvgpr_write_b32 a252, v179
  v_accvgpr_read_b32 v180, a253
  v_mul_f32 v180, v180, v178
  v_accvgpr_write_b32 a253, v180
  v_accvgpr_read_b32 v182, a254
  v_mul_f32 v182, v182, v178
  v_accvgpr_write_b32 a254, v182
  v_accvgpr_read_b32 v183, a255
  v_mul_f32 v183, v183, v178
  v_accvgpr_write_b32 a255, v183
  v_fma_f32 v176, v144, v220, v230
  v_fma_f32 v177, v145, v221, v230
  v_fma_f32 v178, v146, v222, v230
  v_fma_f32 v179, v147, v223, v230
  v_fma_f32 v180, v148, v220, v231
  v_fma_f32 v181, v149, v221, v231
  v_fma_f32 v182, v150, v222, v231
  v_fma_f32 v183, v151, v223, v231
  v_exp_f32 v176, v176
  v_exp_f32 v177, v177
  v_exp_f32 v178, v178
  v_exp_f32 v179, v179
  v_exp_f32 v180, v180
  v_exp_f32 v181, v181
  v_exp_f32 v182, v182
  v_exp_f32 v183, v183
  s_nop 0
  v_add_f32 v238, v176, v177
  v_add_f32 v238, v238, v178
  v_add_f32 v238, v238, v179
  v_add_f32 v239, v180, v181
  v_add_f32 v239, v239, v182
  v_add_f32 v239, v239, v183
  s_nop 3
  s_cmp_eq_u32 s46, 0
  s_cbranch_scc1 L_ret_2_1
  s_cmp_eq_u32 s46, 1
  s_cbranch_scc1 L_ret_4_1
  s_cmp_eq_u32 s46, 2
  s_cbranch_scc1 L_ret_6_1
  s_cmp_eq_u32 s46, 3
  s_cbranch_scc1 L_ret_8_1
  s_cmp_eq_u32 s46, 4
  s_cbranch_scc1 L_ret_10_1
  s_cmp_eq_u32 s46, 5
  s_cbranch_scc1 L_ret_12_1
  s_branch L_ret_14_1
L_tr_1_1:
  s_mov_b32 s46, 0
  s_branch L_slow_1_1
L_tr_3_1:
  s_mov_b32 s46, 1
  s_branch L_slow_1_1
L_tr_5_1:
  s_mov_b32 s46, 2
  s_branch L_slow_1_1
L_tr_7_1:
  s_mov_b32 s46, 3
  s_branch L_slow_1_1
L_tr_9_1:
  s_mov_b32 s46, 4
  s_branch L_slow_1_1
L_tr_11_1:
  s_mov_b32 s46, 5
  s_branch L_slow_1_1
L_tr_13_1:
  s_mov_b32 s46, 6
  s_branch L_slow_1_1
L_tr_15_1:
  s_mov_b32 s46, 7
  s_branch L_slow_1_1
L_slow_1_1:
  s_nop 15
  s_nop 3
  v_mul_f32 v176, v144, v224
  v_mul_f32 v177, v145, v225
  v_mul_f32 v178, v146, v226
  v_mul_f32 v179, v147, v227
  v_max3_f32 v238, v176, v177, v178
  v_max_f32 v238, v238, v179
  v_mul_f32 v180, v148, v224
  v_mul_f32 v181, v149, v225
  v_mul_f32 v182, v150, v226
  v_mul_f32 v183, v151, v227
  v_max3_f32 v239, v180, v181, v182
  v_max_f32 v239, v239, v183
  v_mov_b32 v176, v238
  s_nop 1
  v_permlane32_swap_b32 v238, v176
  v_max_f32 v238, v238, v176
  v_mov_b32 v176, v238
  s_nop 1
  v_permlane16_swap_b32 v238, v176
  v_max_f32 v238, v238, v176
  v_min_f32 v238, v230, -v238
  v_sub_f32 v177, v238, v230
  v_exp_f32 v177, v177
  v_mov_b32 v230, v238
  v_mul_f32 v234, v234, v177
  v_mul_f32 v200, v200, v177
  v_mul_f32 v201, v201, v177
  v_mul_f32 v202, v202, v177
  v_mul_f32 v203, v203, v177
  v_mov_b32 v180, v239
  s_nop 1
  v_permlane32_swap_b32 v239, v180
  v_max_f32 v239, v239, v180
  v_mov_b32 v180, v239
  s_nop 1
  v_permlane16_swap_b32 v239, v180
  v_max_f32 v239, v239, v180
  v_min_f32 v239, v231, -v239
  v_sub_f32 v181, v239, v231
  v_exp_f32 v181, v181
  v_mov_b32 v231, v239
  v_mul_f32 v235, v235, v181
  v_mul_f32 v204, v204, v181
  v_mul_f32 v205, v205, v181
  v_mul_f32 v206, v206, v181
  v_mul_f32 v207, v207, v181
  v_cndmask_b32 v178, v177, v181, s[54:55]
  v_mul_f32 v96, v96, v178
  v_mul_f32 v97, v97, v178
  v_mul_f32 v98, v98, v178
  v_mul_f32 v99, v99, v178
  v_mul_f32 v100, v100, v178
  v_mul_f32 v101, v101, v178
  v_mul_f32 v102, v102, v178
  v_mul_f32 v103, v103, v178
  v_mul_f32 v104, v104, v178
  v_mul_f32 v105, v105, v178
  v_mul_f32 v106, v106, v178
  v_mul_f32 v107, v107, v178
  v_mul_f32 v108, v108, v178
  v_mul_f32 v109, v109, v178
  v_mul_f32 v110, v110, v178
  v_mul_f32 v111, v111, v178
  v_accvgpr_read_b32 v176, a176
  v_mul_f32 v176, v176, v178
  v_accvgpr_write_b32 a176, v176
  v_accvgpr_read_b32 v179, a177
  v_mul_f32 v179, v179, v178
  v_accvgpr_write_b32 a177, v179
  v_accvgpr_read_b32 v180, a178
  v_mul_f32 v180, v180, v178
  v_accvgpr_write_b32 a178, v180
  v_accvgpr_read_b32 v182, a179
  v_mul_f32 v182, v182, v178
  v_accvgpr_write_b32 a179, v182
  v_accvgpr_read_b32 v183, a180
  v_mul_f32 v183, v183, v178
  v_accvgpr_write_b32 a180, v183
  v_accvgpr_read_b32 v176, a181
  v_mul_f32 v176, v176, v178
  v_accvgpr_write_b32 a181, v176
  v_accvgpr_read_b32 v179, a182
  v_mul_f32 v179, v179, v178
  v_accvgpr_write_b32 a182, v179
  v_accvgpr_read_b32 v180, a183
  v_mul_f32 v180, v180, v178
  v_accvgpr_write_b32 a183, v180
  v_accvgpr_read_b32 v182, a184
  v_mul_f32 v182, v182, v178
  v_accvgpr_write_b32 a184, v182
  v_accvgpr_read_b32 v183, a185
  v_mul_f32 v183, v183, v178
  v_accvgpr_write_b32 a185, v183
  v_accvgpr_read_b32 v176, a186
  v_mul_f32 v176, v176, v178
  v_accvgpr_write_b32 a186, v176
  v_accvgpr_read_b32 v179, a187
  v_mul_f32 v179, v179, v178
  v_accvgpr_write_b32 a187, v179
  v_accvgpr_read_b32 v180, a188
  v_mul_f32 v180, v180, v178
  v_accvgpr_write_b32 a188, v180
  v_accvgpr_read_b32 v182, a189
  v_mul_f32 v182, v182, v178
  v_accvgpr_write_b32 a189, v182
  v_accvgpr_read_b32 v183, a190
  v_mul_f32 v183, v183, v178
  v_accvgpr_write_b32 a190, v183
  v_accvgpr_read_b32 v176, a191
  v_mul_f32 v176, v176, v178
  v_accvgpr_write_b32 a191, v176
  v_accvgpr_read_b32 v179, a192
  v_mul_f32 v179, v179, v178
  v_accvgpr_write_b32 a192, v179
  v_accvgpr_read_b32 v180, a193
  v_mul_f32 v180, v180, v178
  v_accvgpr_write_b32 a193, v180
  v_accvgpr_read_b32 v182, a194
  v_mul_f32 v182, v182, v178
  v_accvgpr_write_b32 a194, v182
  v_accvgpr_read_b32 v183, a195
  v_mul_f32 v183, v183, v178
  v_accvgpr_write_b32 a195, v183
  v_accvgpr_read_b32 v176, a196
  v_mul_f32 v176, v176, v178
  v_accvgpr_write_b32 a196, v176
  v_accvgpr_read_b32 v179, a197
  v_mul_f32 v179, v179, v178
  v_accvgpr_write_b32 a197, v179
  v_accvgpr_read_b32 v180, a198
  v_mul_f32 v180, v180, v178
  v_accvgpr_write_b32 a198, v180
  v_accvgpr_read_b32 v182, a199
  v_mul_f32 v182, v182, v178
  v_accvgpr_write_b32 a199, v182
  v_accvgpr_read_b32 v183, a200
  v_mul_f32 v183, v183, v178
  v_accvgpr_write_b32 a200, v183
  v_accvgpr_read_b32 v176, a201
  v_mul_f32 v176, v176, v178
  v_accvgpr_write_b32 a201, v176
  v_accvgpr_read_b32 v179, a202
  v_mul_f32 v179, v179, v178
  v_accvgpr_write_b32 a202, v179
  v_accvgpr_read_b32 v180, a203
  v_mul_f32 v180, v180, v178
  v_accvgpr_write_b32 a203, v180
  v_accvgpr_read_b32 v182, a204
  v_mul_f32 v182, v182, v178
  v_accvgpr_write_b32 a204, v182
  v_accvgpr_read_b32 v183, a205
  v_mul_f32 v183, v183, v178
  v_accvgpr_write_b32 a205, v183
  v_accvgpr_read_b32 v176, a206
  v_mul_f32 v176, v176, v178
  v_accvgpr_write_b32 a206, v176
  v_accvgpr_read_b32 v179, a207
  v_mul_f32 v179, v179, v178
  v_accvgpr_write_b32 a207, v179
  v_accvgpr_read_b32 v180, a208
  v_mul_f32 v180, v180, v178
  v_accvgpr_write_b32 a208, v180
  v_accvgpr_read_b32 v182, a209
  v_mul_f32 v182, v182, v178
  v_accvgpr_write_b32 a209, v182
  v_accvgpr_read_b32 v183, a210
  v_mul_f32 v183, v183, v178
  v_accvgpr_write_b32 a210, v183
  v_accvgpr_read_b32 v176, a211
  v_mul_f32 v176, v176, v178
  v_accvgpr_write_b32 a211, v176
  v_accvgpr_read_b32 v179, a212
  v_mul_f32 v179, v179, v178
  v_accvgpr_write_b32 a212, v179
  v_accvgpr_read_b32 v180, a213
  v_mul_f32 v180, v180, v178
  v_accvgpr_write_b32 a213, v180
  v_accvgpr_read_b32 v182, a214
  v_mul_f32 v182, v182, v178
  v_accvgpr_write_b32 a214, v182
  v_accvgpr_read_b32 v183, a215
  v_mul_f32 v183, v183, v178
  v_accvgpr_write_b32 a215, v183
  v_accvgpr_read_b32 v176, a216
  v_mul_f32 v176, v176, v178
  v_accvgpr_write_b32 a216, v176
  v_accvgpr_read_b32 v179, a217
  v_mul_f32 v179, v179, v178
  v_accvgpr_write_b32 a217, v179
  v_accvgpr_read_b32 v180, a218
  v_mul_f32 v180, v180, v178
  v_accvgpr_write_b32 a218, v180
  v_accvgpr_read_b32 v182, a219
  v_mul_f32 v182, v182, v178
  v_accvgpr_write_b32 a219, v182
  v_accvgpr_read_b32 v183, a220
  v_mul_f32 v183, v183, v178
  v_accvgpr_write_b32 a220, v183
  v_accvgpr_read_b32 v176, a221
  v_mul_f32 v176, v176, v178
  v_accvgpr_write_b32 a221, v176
  v_accvgpr_read_b32 v179, a222
  v_mul_f32 v179, v179, v178
  v_accvgpr_write_b32 a222, v179
  v_accvgpr_read_b32 v180, a223
  v_mul_f32 v180, v180, v178
  v_accvgpr_write_b32 a223, v180
  v_accvgpr_read_b32 v182, a224
  v_mul_f32 v182, v182, v178
  v_accvgpr_write_b32 a224, v182
  v_accvgpr_read_b32 v183, a225
  v_mul_f32 v183, v183, v178
  v_accvgpr_write_b32 a225, v183
  v_accvgpr_read_b32 v176, a226
  v_mul_f32 v176, v176, v178
  v_accvgpr_write_b32 a226, v176
  v_accvgpr_read_b32 v179, a227
  v_mul_f32 v179, v179, v178
  v_accvgpr_write_b32 a227, v179
  v_accvgpr_read_b32 v180, a228
  v_mul_f32 v180, v180, v178
  v_accvgpr_write_b32 a228, v180
  v_accvgpr_read_b32 v182, a229
  v_mul_f32 v182, v182, v178
  v_accvgpr_write_b32 a229, v182
  v_accvgpr_read_b32 v183, a230
  v_mul_f32 v183, v183, v178
  v_accvgpr_write_b32 a230, v183
  v_accvgpr_read_b32 v176, a231
  v_mul_f32 v176, v176, v178
  v_accvgpr_write_b32 a231, v176
  v_accvgpr_read_b32 v179, a232
  v_mul_f32 v179, v179, v178
  v_accvgpr_write_b32 a232, v179
  v_accvgpr_read_b32 v180, a233
  v_mul_f32 v180, v180, v178
  v_accvgpr_write_b32 a233, v180
  v_accvgpr_read_b32 v182, a234
  v_mul_f32 v182, v182, v178
  v_accvgpr_write_b32 a234, v182
  v_accvgpr_read_b32 v183, a235
  v_mul_f32 v183, v183, v178
  v_accvgpr_write_b32 a235, v183
  v_accvgpr_read_b32 v176, a236
  v_mul_f32 v176, v176, v178
  v_accvgpr_write_b32 a236, v176
  v_accvgpr_read_b32 v179, a237
  v_mul_f32 v179, v179, v178
  v_accvgpr_write_b32 a237, v179
  v_accvgpr_read_b32 v180, a238
  v_mul_f32 v180, v180, v178
  v_accvgpr_write_b32 a238, v180
  v_accvgpr_read_b32 v182, a239
  v_mul_f32 v182, v182, v178
  v_accvgpr_write_b32 a239, v182
  v_accvgpr_read_b32 v183, a240
  v_mul_f32 v183, v183, v178
  v_accvgpr_write_b32 a240, v183
  v_accvgpr_read_b32 v176, a241
  v_mul_f32 v176, v176, v178
  v_accvgpr_write_b32 a241, v176
  v_accvgpr_read_b32 v179, a242
  v_mul_f32 v179, v179, v178
  v_accvgpr_write_b32 a242, v179
  v_accvgpr_read_b32 v180, a243
  v_mul_f32 v180, v180, v178
  v_accvgpr_write_b32 a243, v180
  v_accvgpr_read_b32 v182, a244
  v_mul_f32 v182, v182, v178
  v_accvgpr_write_b32 a244, v182
  v_accvgpr_read_b32 v183, a245
  v_mul_f32 v183, v183, v178
  v_accvgpr_write_b32 a245, v183
  v_accvgpr_read_b32 v176, a246
  v_mul_f32 v176, v176, v178
  v_accvgpr_write_b32 a246, v176
  v_accvgpr_read_b32 v179, a247
  v_mul_f32 v179, v179, v178
  v_accvgpr_write_b32 a247, v179
  v_accvgpr_read_b32 v180, a248
  v_mul_f32 v180, v180, v178
  v_accvgpr_write_b32 a248, v180
  v_accvgpr_read_b32 v182, a249
  v_mul_f32 v182, v182, v178
  v_accvgpr_write_b32 a249, v182
  v_accvgpr_read_b32 v183, a250
  v_mul_f32 v183, v183, v178
  v_accvgpr_write_b32 a250, v183
  v_accvgpr_read_b32 v176, a251
  v_mul_f32 v176, v176, v178
  v_accvgpr_write_b32 a251, v176
  v_accvgpr_read_b32 v179, a252
  v_mul_f32 v179, v179, v178
  v_accvgpr_write_b32 a252, v179
  v_accvgpr_read_b32 v180, a253
  v_mul_f32 v180, v180, v178
  v_accvgpr_write_b32 a253, v180
  v_accvgpr_read_b32 v182, a254
  v_mul_f32 v182, v182, v178
  v_accvgpr_write_b32 a254, v182
  v_accvgpr_read_b32 v183, a255
  v_mul_f32 v183, v183, v178
  v_accvgpr_write_b32 a255, v183
  v_fma_f32 v176, v144, v224, v230
  v_fma_f32 v177, v145, v225, v230
  v_fma_f32 v178, v146, v226, v230
  v_fma_f32 v179, v147, v227, v230
  v_fma_f32 v180, v148, v224, v231
  v_fma_f32 v181, v149, v225, v231
  v_fma_f32 v182, v150, v226, v231
  v_fma_f32 v183, v151, v227, v231
  v_exp_f32 v176, v176
  v_exp_f32 v177, v177
  v_exp_f32 v178, v178
  v_exp_f32 v179, v179
  v_exp_f32 v180, v180
  v_exp_f32 v181, v181
  v_exp_f32 v182, v182
  v_exp_f32 v183, v183
  s_nop 0
  v_add_f32 v238, v176, v177
  v_add_f32 v238, v238, v178
  v_add_f32 v238, v238, v179
  v_add_f32 v239, v180, v181
  v_add_f32 v239, v239, v182
  v_add_f32 v239, v239, v183
  s_nop 3
  s_cmp_eq_u32 s46, 0
  s_cbranch_scc1 L_ret_1_1
  s_cmp_eq_u32 s46, 1
  s_cbranch_scc1 L_ret_3_1
  s_cmp_eq_u32 s46, 2
  s_cbranch_scc1 L_ret_5_1
  s_cmp_eq_u32 s46, 3
  s_cbranch_scc1 L_ret_7_1
  s_cmp_eq_u32 s46, 4
  s_cbranch_scc1 L_ret_9_1
  s_cmp_eq_u32 s46, 5
  s_cbranch_scc1 L_ret_11_1
  s_cmp_eq_u32 s46, 6
  s_cbranch_scc1 L_ret_13_1
  s_branch L_ret_15_1
.globl m2f_combine_kernel
.p2align 8
.type m2f_combine_kernel,@function
m2f_combine_kernel:
  s_cmp_ge_u32 s2, 192
  s_cbranch_scc1 L_cend
  s_load_dwordx2 s[86:87], s[0:1], 88
  s_load_dwordx2 s[78:79], s[0:1], 56
  s_load_dwordx2 s[64:65], s[0:1], 0
  s_load_dwordx2 s[82:83], s[0:1], 72
  v_lshrrev_b32 v4, 6, v0
  v_and_b32 v1, 63, v0
  v_readfirstlane_b32 s26, v4
  s_and_b32 s24, s2, 15
  s_lshr_b32 s25, s2, 4
  v_lshlrev_b32 v7, 4, v0
  v_lshlrev_b32 v6, 4, v1
  s_lshl_b32 s40, s24, 12
  s_add_u32 s40, s40, 2097152
  s_mul_i32 s27, s24, 98304
  s_mul_i32 s42, s26, 24576
  s_add_u32 s27, s27, s42
  s_add_u32 s36, s25, 0
  s_and_b32 s36, s36, 3
  s_mul_i32 s66, s36, 6144
  s_add_u32 s66, s66, s27
  s_add_u32 s67, s66, 4096
  s_mov_b32 s10, 2162688
  s_mov_b32 s11, 0x20000
  s_waitcnt lgkmcnt(0)
  s_mov_b32 s8, s86
  s_and_b32 s9, s87, 0xffff
  buffer_load_dwordx4 v[16:19], v7, s[8:11], s40 offen
  buffer_load_dwordx4 v[40:43], v6, s[8:11], s66 offen
  buffer_load_dwordx4 v[44:47], v6, s[8:11], s66 offen offset:1024
  buffer_load_dwordx4 v[48:51], v6, s[8:11], s66 offen offset:2048
  buffer_load_dwordx4 v[52:55], v6, s[8:11], s66 offen offset:3072
  buffer_load_dwordx4 v[56:59], v6, s[8:11], s67 offen
  buffer_load_dwordx4 v[60:63], v6, s[8:11], s67 offen offset:1024
  v_lshrrev_b32 v4, 1, v1
  v_mul_u32_u24 v8, 384, v4
  v_and_b32 v4, 1, v1
  v_lshl_add_u32 v8, v4, 4, v8
  v_and_b32 v2, 15, v1
  v_lshrrev_b32 v3, 4, v1
  v_lshlrev_b32 v5, 1, v2
  s_mul_i32 s28, s26, 18432
  s_lshl_b32 s29, s25, 5
  s_add_u32 s28, s28, s29
  s_add_u32 s41, s28, 8448
  s_mul_i32 m0, s26, 1536
  s_mov_b32 s14, 73728
  s_mov_b32 s15, 0x20000
  s_mov_b32 s12, s78
  s_and_b32 s13, s79, 0xffff
  s_mov_b32 exec_hi, 0xffff
  buffer_load_dwordx4 v8, s[12:15], s28 offen lds
  buffer_load_dwordx4 v8, s[12:15], s41 offen offset:768 lds
  s_mov_b64 exec, -1
  s_add_u32 s37, s25, 1
  s_and_b32 s37, s37, 3
  s_mul_i32 s68, s37, 6144
  s_add_u32 s68, s68, s27
  s_add_u32 s69, s68, 4096
  s_add_u32 s38, s25, 2
  s_and_b32 s38, s38, 3
  s_mul_i32 s70, s38, 6144
  s_add_u32 s70, s70, s27
  s_add_u32 s71, s70, 4096
  s_add_u32 s39, s25, 3
  s_and_b32 s39, s39, 3
  s_mul_i32 s72, s39, 6144
  s_add_u32 s72, s72, s27
  s_add_u32 s73, s72, 4096
  s_mul_i32 s27, s24, 384
  s_add_u32 s29, s29, s27
  s_mov_b32 s18, 6144
  s_mov_b32 s19, 0x20000
  s_mov_b32 s22, 6144
  s_mov_b32 s23, 0x20000
  s_mov_b32 s16, s64
  s_and_b32 s17, s65, 0xffff
  s_mov_b32 s20, s82
  s_and_b32 s21, s83, 0xffff
L_cw0:
  v_mul_u32_u24 v10, 384, v3
  v_lshrrev_b32 v4, 2, v2
  v_lshl_add_u32 v10, v4, 5, v10
  v_and_b32 v4, 3, v1
  v_lshl_add_u32 v10, v4, 3, v10
  v_lshrrev_b32 v32, 2, v7
  s_lshl_b32 s27, s26, 8
  v_lshl_add_u32 v11, v3, 4, s27
  s_lshl_b32 s27, s26, 5
  v_lshlrev_b32 v12, 3, v3
  v_add_u32 v33, s27, v12
  v_lshlrev_b32 v13, 2, v1
  s_lshl_b32 s28, s36, 6
  v_add_u32 v34, s28, v11
  s_lshl_b32 s28, s37, 6
  v_add_u32 v35, s28, v11
  s_lshl_b32 s28, s38, 6
  v_add_u32 v36, s28, v11
  s_lshl_b32 s28, s39, 6
  v_add_u32 v37, s28, v11
  s_waitcnt vmcnt(8)
  v_mov_b32 v20, v16
  v_mov_b32 v21, v17
  v_mov_b32 v22, v18
  v_mov_b32 v23, v19
  buffer_load_dwordx4 v[64:67], v6, s[8:11], s68 offen
  v_permlane32_swap_b32 v20, v21
  v_permlane32_swap_b32 v22, v23
  v_max_f32 v20, v20, v21
  v_max_f32 v22, v22, v23
  buffer_load_dwordx4 v[68:71], v6, s[8:11], s68 offen offset:1024
  s_nop 0
  v_permlane16_swap_b32 v20, v22
  v_max_f32 v20, v20, v22
  s_nop 1
  v_max_f32_dpp v20, v20, v20 row_ror:8 row_mask:0xf bank_mask:0xf
  s_nop 1
  v_max_f32_dpp v20, v20, v20 row_ror:4 row_mask:0xf bank_mask:0xf
  buffer_load_dwordx4 v[72:75], v6, s[8:11], s68 offen offset:2048
  s_nop 0
  v_max_f32_dpp v20, v20, v20 row_ror:2 row_mask:0xf bank_mask:0xf
  s_nop 1
  v_max_f32_dpp v20, v20, v20 row_ror:1 row_mask:0xf bank_mask:0xf
  s_nop 0
  v_readlane_b32 s30, v20, 0
  v_readlane_b32 s31, v20, 32
  buffer_load_dwordx4 v[76:79], v6, s[8:11], s68 offen offset:3072
  v_readlane_b32 s32, v20, 16
  v_readlane_b32 s33, v20, 48
  v_mov_b32 v14, v20
  v_subrev_f32 v16, s30, v16
  buffer_load_dwordx4 v[80:83], v6, s[8:11], s69 offen
  v_subrev_f32 v17, s31, v17
  v_subrev_f32 v18, s32, v18
  v_subrev_f32 v19, s33, v19
  v_exp_f32 v16, v16
  buffer_load_dwordx4 v[84:87], v6, s[8:11], s69 offen offset:1024
  v_exp_f32 v17, v17
  v_exp_f32 v18, v18
  v_exp_f32 v19, v19
  ds_write_b32 v32, v16 offset:6400
  buffer_load_dwordx4 v[88:91], v6, s[8:11], s70 offen
  ds_write_b32 v32, v17 offset:7424
  ds_write_b32 v32, v18 offset:8448
  ds_write_b32 v32, v19 offset:9472
  ds_read_b128 v[136:139], v34 offset:6400
  buffer_load_dwordx4 v[92:95], v6, s[8:11], s70 offen offset:1024
  ds_read_b128 v[140:143], v34 offset:7424
  ds_read_b128 v[144:147], v34 offset:8448
  ds_read_b128 v[148:151], v34 offset:9472
  ds_read_b128 v[152:155], v35 offset:6400
  buffer_load_dwordx4 v[96:99], v6, s[8:11], s70 offen offset:2048
  ds_read_b128 v[156:159], v35 offset:7424
  ds_read_b128 v[160:163], v35 offset:8448
  ds_read_b128 v[164:167], v35 offset:9472
  ds_read_b128 v[168:171], v36 offset:6400
  buffer_load_dwordx4 v[100:103], v6, s[8:11], s70 offen offset:3072
  ds_read_b128 v[172:175], v36 offset:7424
  ds_read_b128 v[176:179], v36 offset:8448
  ds_read_b128 v[180:183], v36 offset:9472
  ds_read_b128 v[184:187], v37 offset:6400
  buffer_load_dwordx4 v[104:107], v6, s[8:11], s71 offen
  ds_read_b128 v[188:191], v37 offset:7424
  ds_read_b128 v[192:195], v37 offset:8448
  ds_read_b128 v[196:199], v37 offset:9472
  s_waitcnt vmcnt(11)
  buffer_load_dwordx4 v[108:111], v6, s[8:11], s71 offen offset:1024
  s_barrier
  ds_read_b64_tr_b16 v[200:201], v10 offset:0
  ds_read_b64_tr_b16 v[202:203], v10 offset:128
  ds_read_b64_tr_b16 v[204:205], v10 offset:256
  buffer_load_dwordx4 v[112:115], v6, s[8:11], s72 offen
  ds_read_b64_tr_b16 v[206:207], v10 offset:1536
  ds_read_b64_tr_b16 v[208:209], v10 offset:1664
  ds_read_b64_tr_b16 v[210:211], v10 offset:1792
  ds_read_b64_tr_b16 v[212:213], v10 offset:3072
  buffer_load_dwordx4 v[116:119], v6, s[8:11], s72 offen offset:1024
  ds_read_b64_tr_b16 v[214:215], v10 offset:3200
  ds_read_b64_tr_b16 v[216:217], v10 offset:3328
  ds_read_b64_tr_b16 v[218:219], v10 offset:4608
  ds_read_b64_tr_b16 v[220:221], v10 offset:4736
  buffer_load_dwordx4 v[120:123], v6, s[8:11], s72 offen offset:2048
  ds_read_b64_tr_b16 v[222:223], v10 offset:4864
  v_permlane32_swap_b32 v16, v17
  v_permlane32_swap_b32 v18, v19
  v_add_f32 v16, v16, v17
  buffer_load_dwordx4 v[124:127], v6, s[8:11], s72 offen offset:3072
  v_add_f32 v18, v18, v19
  s_nop 1
  v_permlane16_swap_b32 v16, v18
  v_add_f32 v16, v16, v18
  s_nop 1
  v_add_f32_dpp v16, v16, v16 row_ror:8 row_mask:0xf bank_mask:0xf
  buffer_load_dwordx4 v[128:131], v6, s[8:11], s73 offen
  s_nop 0
  v_add_f32_dpp v16, v16, v16 row_ror:4 row_mask:0xf bank_mask:0xf
  s_nop 1
  v_add_f32_dpp v16, v16, v16 row_ror:2 row_mask:0xf bank_mask:0xf
  s_nop 1
  v_add_f32_dpp v16, v16, v16 row_ror:1 row_mask:0xf bank_mask:0xf
  v_mov_b32 v15, v16
  buffer_load_dwordx4 v[132:135], v6, s[8:11], s73 offen offset:1024
  ds_write_b64 v33, v[14:15] offset:6144
  s_waitcnt lgkmcnt(11)
  v_mfma_f32_16x16x32_bf16 v[224:227], v[40:43], v[200:203], 0
  buffer_load_ushort v9, v5, s[16:19], s29 offen
  s_waitcnt lgkmcnt(8)
  v_mfma_f32_16x16x32_bf16 v[228:231], v[44:47], v[206:209], 0
  s_waitcnt lgkmcnt(5)
  v_mfma_f32_16x16x32_bf16 v[232:235], v[48:51], v[212:215], 0
  s_waitcnt lgkmcnt(2)
  v_mfma_f32_16x16x32_bf16 v[236:239], v[52:55], v[218:221], 0
  v_mfma_f32_16x16x16_bf16 v[224:227], v[56:57], v[204:205], v[224:227]
  v_mfma_f32_16x16x16_bf16 v[228:231], v[58:59], v[210:211], v[228:231]
  v_mfma_f32_16x16x16_bf16 v[232:235], v[60:61], v[216:217], v[232:235]
  s_waitcnt lgkmcnt(1)
  v_mfma_f32_16x16x16_bf16 v[236:239], v[62:63], v[222:223], v[236:239]
  s_waitcnt vmcnt(18)
  v_mfma_f32_16x16x32_bf16 v[240:243], v[64:67], v[200:203], 0
  s_waitcnt vmcnt(17)
  v_mfma_f32_16x16x32_bf16 v[244:247], v[68:71], v[206:209], 0
  s_waitcnt vmcnt(16)
  v_mfma_f32_16x16x32_bf16 v[248:251], v[72:75], v[212:215], 0
  s_waitcnt vmcnt(15)
  v_mfma_f32_16x16x32_bf16 v[252:255], v[76:79], v[218:221], 0
  s_waitcnt vmcnt(14)
  v_mfma_f32_16x16x16_bf16 v[240:243], v[80:81], v[204:205], v[240:243]
  v_mfma_f32_16x16x16_bf16 v[244:247], v[82:83], v[210:211], v[244:247]
  s_waitcnt vmcnt(13)
  v_mfma_f32_16x16x16_bf16 v[248:251], v[84:85], v[216:217], v[248:251]
  v_mfma_f32_16x16x16_bf16 v[252:255], v[86:87], v[222:223], v[252:255]
  v_pk_mul_f32 v[24:25], v[224:225], v[136:137]
  v_pk_mul_f32 v[26:27], v[228:229], v[140:141]
  v_pk_mul_f32 v[28:29], v[232:233], v[144:145]
  v_pk_mul_f32 v[30:31], v[236:237], v[148:149]
  v_pk_fma_f32 v[24:25], v[226:227], v[138:139], v[24:25]
  v_pk_fma_f32 v[26:27], v[230:231], v[142:143], v[26:27]
  v_pk_fma_f32 v[28:29], v[234:235], v[146:147], v[28:29]
  v_pk_fma_f32 v[30:31], v[238:239], v[150:151], v[30:31]
  s_waitcnt vmcnt(12)
  v_mfma_f32_16x16x32_bf16 v[224:227], v[88:91], v[200:203], 0
  s_waitcnt vmcnt(11)
  v_mfma_f32_16x16x32_bf16 v[228:231], v[92:95], v[206:209], 0
  s_waitcnt vmcnt(10)
  v_mfma_f32_16x16x32_bf16 v[232:235], v[96:99], v[212:215], 0
  s_waitcnt vmcnt(9)
  v_mfma_f32_16x16x32_bf16 v[236:239], v[100:103], v[218:221], 0
  s_waitcnt vmcnt(8)
  v_mfma_f32_16x16x16_bf16 v[224:227], v[104:105], v[204:205], v[224:227]
  v_mfma_f32_16x16x16_bf16 v[228:231], v[106:107], v[210:211], v[228:231]
  s_waitcnt vmcnt(7)
  v_mfma_f32_16x16x16_bf16 v[232:235], v[108:109], v[216:217], v[232:235]
  v_mfma_f32_16x16x16_bf16 v[236:239], v[110:111], v[222:223], v[236:239]
  v_pk_fma_f32 v[24:25], v[240:241], v[152:153], v[24:25]
  v_pk_fma_f32 v[26:27], v[244:245], v[156:157], v[26:27]
  v_pk_fma_f32 v[28:29], v[248:249], v[160:161], v[28:29]
  v_pk_fma_f32 v[30:31], v[252:253], v[164:165], v[30:31]
  v_pk_fma_f32 v[24:25], v[242:243], v[154:155], v[24:25]
  v_pk_fma_f32 v[26:27], v[246:247], v[158:159], v[26:27]
  v_pk_fma_f32 v[28:29], v[250:251], v[162:163], v[28:29]
  v_pk_fma_f32 v[30:31], v[254:255], v[166:167], v[30:31]
  s_waitcnt vmcnt(6)
  v_mfma_f32_16x16x32_bf16 v[240:243], v[112:115], v[200:203], 0
  s_waitcnt vmcnt(5)
  v_mfma_f32_16x16x32_bf16 v[244:247], v[116:119], v[206:209], 0
  s_waitcnt vmcnt(4)
  v_mfma_f32_16x16x32_bf16 v[248:251], v[120:123], v[212:215], 0
  s_waitcnt vmcnt(3)
  v_mfma_f32_16x16x32_bf16 v[252:255], v[124:127], v[218:221], 0
  s_waitcnt vmcnt(2)
  v_mfma_f32_16x16x16_bf16 v[240:243], v[128:129], v[204:205], v[240:243]
  v_mfma_f32_16x16x16_bf16 v[244:247], v[130:131], v[210:211], v[244:247]
  s_waitcnt vmcnt(1)
  v_mfma_f32_16x16x16_bf16 v[248:251], v[132:133], v[216:217], v[248:251]
  v_mfma_f32_16x16x16_bf16 v[252:255], v[134:135], v[222:223], v[252:255]
  v_pk_fma_f32 v[24:25], v[224:225], v[168:169], v[24:25]
  v_pk_fma_f32 v[26:27], v[228:229], v[172:173], v[26:27]
  v_pk_fma_f32 v[28:29], v[232:233], v[176:177], v[28:29]
  v_pk_fma_f32 v[30:31], v[236:237], v[180:181], v[30:31]
  v_pk_fma_f32 v[24:25], v[226:227], v[170:171], v[24:25]
  v_pk_fma_f32 v[26:27], v[230:231], v[174:175], v[26:27]
  v_pk_fma_f32 v[28:29], v[234:235], v[178:179], v[28:29]
  v_pk_fma_f32 v[30:31], v[238:239], v[182:183], v[30:31]
  v_pk_fma_f32 v[24:25], v[240:241], v[184:185], v[24:25]
  v_pk_fma_f32 v[26:27], v[244:245], v[188:189], v[26:27]
  v_pk_fma_f32 v[28:29], v[248:249], v[192:193], v[28:29]
  v_pk_fma_f32 v[30:31], v[252:253], v[196:197], v[30:31]
  v_pk_fma_f32 v[24:25], v[242:243], v[186:187], v[24:25]
  v_pk_fma_f32 v[26:27], v[246:247], v[190:191], v[26:27]
  v_pk_fma_f32 v[28:29], v[250:251], v[194:195], v[28:29]
  v_pk_fma_f32 v[30:31], v[254:255], v[198:199], v[30:31]
  v_add_f32 v20, v24, v25
  v_add_f32 v21, v26, v27
  v_add_f32 v22, v28, v29
  v_add_f32 v23, v30, v31
  v_permlane32_swap_b32 v20, v21
  s_nop 0
  v_permlane32_swap_b32 v22, v23
  v_add_f32 v20, v20, v21
  v_add_f32 v22, v22, v23
  s_nop 1
  v_permlane16_swap_b32 v20, v22
  v_add_f32 v20, v20, v22
  ds_write_b32 v32, v20 offset:10496
  s_waitcnt lgkmcnt(0)
  s_barrier
  s_cmp_lg_u32 s26, 0
  s_cbranch_scc1 L_cend
  ds_read_b64 v[40:41], v12 offset:6144
  ds_read_b64 v[42:43], v12 offset:6176
  ds_read_b64 v[44:45], v12 offset:6208
  ds_read_b64 v[46:47], v12 offset:6240
  ds_read_b32 v48, v13 offset:10496
  ds_read_b32 v49, v13 offset:10752
  ds_read_b32 v50, v13 offset:11008
  ds_read_b32 v51, v13 offset:11264
  s_waitcnt vmcnt(0)
  v_lshlrev_b32 v9, 16, v9
  s_waitcnt lgkmcnt(5)
  v_max3_f32 v52, v40, v42, v44
  s_waitcnt lgkmcnt(4)
  v_max_f32 v52, v52, v46
  v_sub_f32 v40, v40, v52
  v_sub_f32 v42, v42, v52
  v_sub_f32 v44, v44, v52
  v_sub_f32 v46, v46, v52
  v_exp_f32 v40, v40
  v_exp_f32 v42, v42
  v_exp_f32 v44, v44
  v_exp_f32 v46, v46
  v_mul_f32 v52, v40, v41
  s_waitcnt lgkmcnt(3)
  v_mul_f32 v53, v40, v48
  v_fma_f32 v52, v42, v43, v52
  s_waitcnt lgkmcnt(2)
  v_fma_f32 v53, v42, v49, v53
  v_fma_f32 v52, v44, v45, v52
  s_waitcnt lgkmcnt(1)
  v_fma_f32 v53, v44, v50, v53
  v_fma_f32 v52, v46, v47, v52
  s_waitcnt lgkmcnt(0)
  v_fma_f32 v53, v46, v51, v53
  v_rcp_f32 v52, v52
  s_nop 0
  v_mul_f32 v53, v53, v52
  v_mov_b32 v52, v53
  s_nop 1
  v_permlane32_swap_b32 v53, v52
  v_add_f32 v53, v53, v52
  v_mov_b32 v52, v53
  s_nop 1
  v_permlane16_swap_b32 v53, v52
  v_add_f32 v53, v53, v52
  v_add_f32 v53, v53, v9
  v_cvt_pk_bf16_f32 v53, v53, v53
  s_mov_b64 exec, 0xffff
  buffer_store_short v53, v5, s[20:23], s29 offen
L_cend:
  s_endpgm
L_codeend:
.section .rodata,"a"
.p2align 6
.amdhsa_kernel standalone__detection_seg_mask2former__vision_kernel
  .amdhsa_next_free_vgpr 512
  .amdhsa_next_free_sgpr 102
  .amdhsa_accum_offset 256
  .amdhsa_group_segment_fixed_size 0
  .amdhsa_kernarg_size 96
  .amdhsa_user_sgpr_count 2
  .amdhsa_user_sgpr_kernarg_segment_ptr 1
  .amdhsa_system_sgpr_workgroup_id_x 1
.end_amdhsa_kernel
.p2align 6
.amdhsa_kernel m2f_combine_kernel
  .amdhsa_next_free_vgpr 256
  .amdhsa_next_free_sgpr 102
  .amdhsa_accum_offset 256
  .amdhsa_group_segment_fixed_size 0
  .amdhsa_kernarg_size 96
  .amdhsa_user_sgpr_count 2
  .amdhsa_user_sgpr_kernarg_segment_ptr 1
  .amdhsa_system_sgpr_workgroup_id_x 1
.end_amdhsa_kernel
```
